```python
import torch

def _softmax(x, axis=-1):
    return torch.softmax(x, dim=axis)

def _gelu(x):
    return torch.nn.functional.gelu(x, approximate='tanh')

def _silu(x):
    return torch.nn.functional.silu(x)

def _sigmoid(x):
    return torch.sigmoid(x)

def _layernorm(x, axis=-1, eps=1e-05):
    m = x.mean(dim=axis, keepdim=True)
    v = x.var(dim=axis, keepdim=True, unbiased=False)
    return (x - m) / torch.sqrt(v + eps)

def _scatter_add(tgt, idx, src, axis=0):
    return tgt.clone().index_add_(axis, idx, src)

def _segment_sum(src, seg, n):
    out = torch.zeros((n,) + src.shape[1:], dtype=src.dtype)
    return out.index_add_(0, seg, src)

def _pad(x, pw):
    flat = tuple((v for pair in reversed(pw) for v in pair))
    return torch.nn.functional.pad(x, flat)
kernel_name = 'adaLN_cond__linear_kernel_hedgehog__glu_gated_swiglu__prompt'

def setup_inputs():

    _w = lambda a: (lambda t: t.to(torch.bfloat16) if t.is_floating_point() else t)(torch.as_tensor(a))

    def _A_setup():
        B, S, D, H = (1, 2048, 1024, 32)
        Dh = D // H
        return {'x': _w((lambda *s: torch.randn(*s, dtype=torch.bfloat16) * 0.05)(B, S, D)), 'wqkv': _w((lambda *s: torch.randn(*s, dtype=torch.bfloat16) * 0.4)(D, 3 * D)), 'w_phi': _w((lambda *s: torch.randn(*s, dtype=torch.bfloat16) * 0.4)(H, Dh, Dh) * Dh ** (-0.5)), 'wo': _w((lambda *s: torch.randn(*s, dtype=torch.bfloat16) * 0.1)(D, D))}
    _A_in = _A_setup()

    def _B_setup():
        B, S, D, F = (1, 2048, 1024, 3584)
        return {'x': _w((lambda *s: torch.randn(*s, dtype=torch.bfloat16) * 0.05)(B, S, D)), 'w1': _w((lambda *s: torch.randn(*s, dtype=torch.bfloat16) * 1.6)(D, F) * (2.0 / D) ** 0.5), 'w3': _w((lambda *s: torch.randn(*s, dtype=torch.bfloat16) * 1.6)(D, F) * (2.0 / D) ** 0.5), 'w2': _w((lambda *s: torch.randn(*s, dtype=torch.bfloat16) * 1.6)(F, D) * (2.0 / F) ** 0.5)}
    _B_in = _B_setup()
    return {'A_x': _A_in['x'], 'A_wqkv': _A_in['wqkv'], 'A_w_phi': _A_in['w_phi'], 'A_wo': _A_in['wo'], 'B_x': _B_in['x'], 'B_w1': _B_in['w1'], 'B_w3': _B_in['w3'], 'B_w2': _B_in['w2'], 'c': _w((lambda *s: torch.randn(*s, dtype=torch.bfloat16) * 0.1)(1, 1024) * 8.0), 'w_mod': _w((lambda *s: torch.randn(*s, dtype=torch.bfloat16) * 0.1)(1024, 6 * 1024) * 1024 ** (-0.5) * 8.0)}

def reference(A_x, A_wqkv, A_w_phi, A_wo, B_x, B_w1, B_w3, B_w2, c, w_mod):

    def _A_ref(x, wqkv, w_phi, wo):
        B, S, D = x.shape
        H = 32
        Dh = D // H
        qkv = (lambda x, *d: x.permute(*d))((x @ wqkv).reshape(B, S, 3, H, Dh), 2, 0, 3, 1, 4)
        q, k, v = (qkv[0], qkv[1], qkv[2])
        pq = torch.einsum('bhsd,hdf->bhsf', q, w_phi)
        pk = torch.einsum('bhsd,hdf->bhsf', k, w_phi)
        phi_q = torch.concatenate([_softmax(pq, axis=-1), _softmax(-pq, axis=-1)], axis=-1)
        phi_k = torch.concatenate([_softmax(pk, axis=-1), _softmax(-pk, axis=-1)], axis=-1)
        kv = torch.einsum('bhsf,bhsd->bhfd', phi_k, v)
        z = torch.einsum('bhsf->bhf', phi_k)
        num = torch.einsum('bhqf,bhfd->bhqd', phi_q, kv)
        den = torch.einsum('bhqf,bhf->bhq', phi_q, z)[..., None] + 1e-06
        o = num / den
        return (lambda x, *d: x.permute(*d))(o, 0, 2, 1, 3).reshape(B, S, D) @ wo

    def _B_ref(x, w1, w3, w2):
        gate = torch.einsum('bsd,df->bsf', x, w1)
        up = torch.einsum('bsd,df->bsf', x, w3)
        h = _silu(gate) * up
        out = torch.einsum('bsf,fd->bsd', h, w2)
        return out
    x = A_x
    mod = (_silu(c) @ w_mod).reshape(c.shape[0], 6, 1, -1)
    sa, ca, ga, sb, cb, gb = (mod[:, 0].clone(), mod[:, 1].clone(), mod[:, 2].clone(), mod[:, 3].clone(), mod[:, 4].clone(), mod[:, 5].clone())
    h = _layernorm(x, axis=-1) * (1 + ca) + sa
    x = x + ga * _A_ref(h, A_wqkv, A_w_phi, A_wo)
    h = _layernorm(x, axis=-1) * (1 + cb) + sb
    x = x + gb * _B_ref(h, B_w1, B_w3, B_w2)
    return x
```

```asm
; @launch grid=(256,1,1) block=(256,1,1) lds=163840
.amdgcn_target "amdgcn-amd-amdhsa--gfx950"
.text
.globl adaLN_cond__linear_kernel_hedgehog__glu_gated_swiglu__prompt_kernel
.p2align 8
.type adaLN_cond__linear_kernel_hedgehog__glu_gated_swiglu__prompt_kernel,@function
adaLN_cond__linear_kernel_hedgehog__glu_gated_swiglu__prompt_kernel:
    s_cmp_ge_u32 s2, 256
    s_cbranch_scc1 end_adaLN_cond__linear_kernel_hedgehog__glu_gated_swiglu__prompt_kernel_1
    s_load_dwordx16 s[64:79], s[0:1], 0
    s_load_dwordx8 s[80:87], s[0:1], 64
    s_load_dwordx2 s[4:5], s[0:1], 96
    v_lshrrev_b32 v3, 6, v0
    v_and_b32 v1, 63, v0
    v_readfirstlane_b32 s3, v3
    v_lshlrev_b32 v2, 4, v1
    s_and_b32 s6, s2, 7
    s_lshr_b32 s7, s2, 3
    v_and_b32 v3, 7, v0
    v_lshrrev_b32 v19, 3, v0
    v_mul_u32_u24 v16, 49152, v19
    v_lshl_add_u32 v16, v3, 4, v16
    v_lshlrev_b32 v17, 3, v0
    v_lshrrev_b32 v10, 3, v1
    v_lshlrev_b32 v18, 11, v3
    v_lshl_add_u32 v18, v10, 4, v18
    s_lshl_b32 s12, s3, 9
    v_add_u32 v18, s12, v18
    s_and_b32 s20, s2, 31
    s_lshl_b32 s20, s20, 7
    s_lshr_b32 s21, s2, 5
    s_mul_i32 s22, s21, 1572864
    s_add_u32 s22, s20, s22
    s_lshr_b32 s31, s7, 1
    s_lshl_b32 s31, s31, 3
    s_add_u32 s31, s31, s6
    s_and_b32 s57, s7, 1
    s_lshl_b32 s20, s31, 15
    s_cmp_eq_u32 s57, 0
    s_cselect_b32 s23, 32768, 0
    s_waitcnt lgkmcnt(0)
    s_mov_b32 s12, s82
    s_and_b32 s13, s83, 0xffff
    s_mov_b32 s14, 12582912
    s_mov_b32 s15, 0x20000
    s_mov_b32 s8, s80
    s_and_b32 s9, s81, 0xffff
    s_mov_b32 s10, 2048
    s_mov_b32 s11, 0x20000
    s_add_u32 s16, s64, s20
    s_addc_u32 s17, s65, 0
    s_and_b32 s17, s17, 0xffff
    s_mov_b32 s18, s23
    s_mov_b32 s19, 0x20000
    s_add_u32 s92, s4, 0
    s_addc_u32 s93, s5, 0
    s_and_b32 s93, s93, 0xffff
    s_mov_b32 s94, 65536
    s_mov_b32 s95, 0x20000
    s_lshl_b32 s20, s2, 2
    s_add_u32 s20, s20, s3
    s_cmp_lg_u32 s20, 35
    s_cbranch_scc1 nz_adaLN_cond__linear_kernel_hedgehog__glu_gated_swiglu__prompt_kernel_2
    v_mov_b32 v22, 0
    v_lshlrev_b32 v23, 8, v1
    s_mov_b32 s20, 16384
    buffer_store_dword v22, v23, s[92:95], 0 offen sc1
    buffer_store_dword v22, v23, s[92:95], s20 offen sc1
    s_mov_b32 s20, 32768
    buffer_store_dword v22, v23, s[92:95], s20 offen sc1
    s_mov_b32 s20, 49152
    buffer_store_dword v22, v23, s[92:95], s20 offen sc1
    s_mov_b32 s24, s86
    s_and_b32 s25, s87, 0xffff
    s_mov_b32 s26, 256
    s_mov_b32 s27, 0x20000
    v_mov_b32 v24, 1
    s_waitcnt vmcnt(0)
    buffer_store_dword v24, v22, s[24:27], 0 offen sc1
nz_adaLN_cond__linear_kernel_hedgehog__glu_gated_swiglu__prompt_kernel_2:
    buffer_load_dwordx2 v[20:21], v17, s[8:11], 0 offen
    buffer_load_dwordx4 v[32:35], v16, s[12:15], s22 offen nt
    s_add_u32 s22, s22, 12288
    buffer_load_dwordx4 v[36:39], v16, s[12:15], s22 offen nt
    s_add_u32 s22, s22, 12288
    buffer_load_dwordx4 v[40:43], v16, s[12:15], s22 offen nt
    s_add_u32 s22, s22, 12288
    buffer_load_dwordx4 v[44:47], v16, s[12:15], s22 offen nt
    s_mov_b32 s20, 16384
    buffer_load_dwordx4 v[48:51], v18, s[16:19], 0 offen offset:0 nt
    buffer_load_dwordx4 v[52:55], v18, s[16:19], 0 offen offset:128 nt
    buffer_load_dwordx4 v[56:59], v18, s[16:19], 0 offen offset:256 nt
    buffer_load_dwordx4 v[60:63], v18, s[16:19], 0 offen offset:384 nt
    buffer_load_dwordx4 v[64:67], v18, s[16:19], s20 offen offset:0 nt
    buffer_load_dwordx4 v[68:71], v18, s[16:19], s20 offen offset:128 nt
    buffer_load_dwordx4 v[72:75], v18, s[16:19], s20 offen offset:256 nt
    buffer_load_dwordx4 v[76:79], v18, s[16:19], s20 offen offset:384 nt
    s_getpc_b64 s[24:25]
adaLN_cond__linear_kernel_hedgehog__glu_gated_swiglu__prompt_kernel_pc0:
    s_sub_u32 s24, s24, adaLN_cond__linear_kernel_hedgehog__glu_gated_swiglu__prompt_kernel_pc0-adaLN_cond__linear_kernel_hedgehog__glu_gated_swiglu__prompt_kernel
    s_subb_u32 s25, s25, 0
    s_and_b32 s25, s25, 0xffff
    s_mov_b32 s26, end_adaLN_cond__linear_kernel_hedgehog__glu_gated_swiglu__prompt_kernel_1-adaLN_cond__linear_kernel_hedgehog__glu_gated_swiglu__prompt_kernel
    s_mov_b32 s27, 0x20000
    s_lshr_b32 s20, s7, 1
    s_lshl_b32 s20, s20, 13
    s_lshl_b32 s22, s57, 2
    s_add_u32 s22, s22, s3
    s_cmp_eq_u32 s22, 6
    s_cselect_b32 s20, s20, 0x1000000
    v_lshlrev_b32 v22, 7, v1
    buffer_load_dword a253, v22, s[24:27], s20 offen
    s_and_b32 s58, s7, 7
    s_lshr_b32 s59, s7, 3
    s_and_b32 s61, s6, 1
    s_lshl_b32 s61, s61, 3
    s_add_u32 s62, s61, s58
    s_lshr_b32 s61, s6, 1
    s_lshl_b32 s61, s61, 2
    s_add_u32 s63, s61, s59
    s_lshl_b32 s60, s59, 1
    s_add_u32 s60, s60, s58
    s_and_b32 s60, s60, 3
    s_lshl_b32 s61, s3, 11
    v_add_u32 v4, s61, v2
    s_lshl_b32 s61, s3, 10
    v_add_u32 v12, s61, v2
    v_lshrrev_b32 v6, 3, v1
    v_and_b32 v7, 7, v1
    v_bfe_u32 v8, v1, 4, 1
    v_lshlrev_b32 v8, 1, v8
    v_xor_b32 v7, v7, v8
    s_lshl_b32 s61, s3, 3
    v_add_u32 v6, s61, v6
    v_mul_u32_u24 v6, 6144, v6
    v_lshl_add_u32 v5, v7, 4, v6
    v_lshrrev_b32 v11, 4, v1
    v_bfe_u32 v14, v1, 2, 2
    v_and_b32 v15, 3, v1
    v_mul_u32_u24 v9, 3136, v11
    v_lshl_add_u32 v9, v14, 7, v9
    v_lshl_add_u32 v9, v15, 3, v9
    v_lshrrev_b32 v8, 1, v14
    v_lshl_add_u32 v6, v8, 5, v9
    v_xor_b32 v8, 1, v8
    v_lshl_add_u32 v7, v8, 5, v9
    v_add_u32 v8, 50176, v6
    v_add_u32 v9, 50176, v7
    s_lshl_b32 s61, s62, 13
    s_sub_u32 s53, 4194304, s61
    s_add_u32 s61, s61, 1048576
    s_add_u32 s32, s4, s61
    s_addc_u32 s33, s5, 0
    s_and_b32 s33, s33, 0xffff
    s_mov_b32 s34, s53
    s_mov_b32 s35, 0x20000
    s_lshl_b32 s61, s63, 7
    s_add_u32 s61, s61, 0
    s_sub_u32 s53, 6291456, s61
    s_add_u32 s36, s66, s61
    s_addc_u32 s37, s67, 0
    s_and_b32 s37, s37, 0xffff
    s_mov_b32 s38, s53
    s_mov_b32 s39, 0x20000
    s_lshl_b32 s61, s63, 7
    s_add_u32 s61, s61, 1024
    s_sub_u32 s53, 6291456, s61
    s_add_u32 s40, s66, s61
    s_addc_u32 s41, s67, 0
    s_and_b32 s41, s41, 0xffff
    s_mov_b32 s42, s53
    s_mov_b32 s43, 0x20000
    s_lshl_b32 s61, s63, 7
    s_add_u32 s61, s61, 2048
    s_sub_u32 s53, 6291456, s61
    s_add_u32 s44, s66, s61
    s_addc_u32 s45, s67, 0
    s_and_b32 s45, s45, 0xffff
    s_mov_b32 s46, s53
    s_mov_b32 s47, 0x20000
    s_lshl_b32 s61, s63, 12
    s_add_u32 s48, s68, s61
    s_addc_u32 s49, s69, 0
    s_and_b32 s49, s49, 0xffff
    s_mov_b32 s50, 4096
    s_mov_b32 s51, 0x20000
    s_mul_i32 s52, s3, 3136
    s_mov_b32 s58, 0
    s_mov_b32 s59, s60
    s_waitcnt vmcnt(13)
    v_lshlrev_b32 v112, 16, v20
    v_and_b32 v113, 0xffff0000, v20
    v_lshlrev_b32 v114, 16, v21
    v_and_b32 v115, 0xffff0000, v21
    s_mov_b32 s20, 3216550459
    v_mul_f32 v116, s20, v112
    v_mul_f32 v117, s20, v113
    v_mul_f32 v118, s20, v114
    v_mul_f32 v119, s20, v115
    v_exp_f32 v116, v116
    v_exp_f32 v117, v117
    v_exp_f32 v118, v118
    v_exp_f32 v119, v119
    s_nop 0
    v_add_f32 v116, 1.0, v116
    v_add_f32 v117, 1.0, v117
    v_add_f32 v118, 1.0, v118
    v_add_f32 v119, 1.0, v119
    v_rcp_f32 v116, v116
    v_rcp_f32 v117, v117
    v_rcp_f32 v118, v118
    v_rcp_f32 v119, v119
    s_nop 0
    v_mul_f32 v112, v112, v116
    v_mul_f32 v113, v113, v117
    v_mul_f32 v114, v114, v118
    v_mul_f32 v115, v115, v119
    v_cvt_pk_bf16_f32 v113, v112, v113
    v_lshlrev_b32 v112, 16, v113
    v_and_b32 v113, 0xffff0000, v113
    v_cvt_pk_bf16_f32 v115, v114, v115
    v_lshlrev_b32 v114, 16, v115
    v_and_b32 v115, 0xffff0000, v115
    v_lshlrev_b32 v16, 4, v0
    v_add_u32 v16, 104448, v16
    ds_write_b128 v16, v[112:115]
    s_lshl_b32 s20, s21, 9
    s_add_u32 s20, s20, 104448
    v_lshlrev_b32 v16, 4, v19
    v_add_u32 v16, s20, v16
    s_waitcnt lgkmcnt(0)
    s_barrier
    ds_read_b128 v[112:115], v16
    v_bfe_u32 v13, v0, 4, 2
    v_lshlrev_b32 v13, 3, v13
    v_lshl_add_u32 v13, v3, 5, v13
    s_lshl_b32 s20, s3, 8
    s_add_u32 s20, s20, 108544
    v_add_u32 v13, s20, v13
    s_waitcnt vmcnt(9) lgkmcnt(0)
    s_cmp_lg_u32 s3, 0
    s_cbranch_scc1 nk_adaLN_cond__linear_kernel_hedgehog__glu_gated_swiglu__prompt_kernel_3
    s_lshl_b32 s20, s62, 5
    s_lshl_b32 s22, s63, 1
    s_add_u32 s20, s20, s22
    s_mul_i32 s20, s20, 4352
    s_add_u32 s20, s20, 17825792
    s_add_u32 s24, s4, s20
    s_addc_u32 s25, s5, 0
    s_and_b32 s25, s25, 0xffff
    s_mov_b32 s26, 8704
    s_mov_b32 s27, 0x20000
    v_mov_b32 v20, -1
    v_mov_b32 v21, -1
    v_mov_b32 v22, -1
    v_mov_b32 v23, -1
    s_mov_b32 s20, 0
    buffer_store_dwordx4 v[20:23], v2, s[24:27], s20 offen offset:0 sc1
    buffer_store_dwordx4 v[20:23], v2, s[24:27], s20 offen offset:1024 sc1
    buffer_store_dwordx4 v[20:23], v2, s[24:27], s20 offen offset:2048 sc1
    buffer_store_dwordx4 v[20:23], v2, s[24:27], s20 offen offset:3072 sc1
    s_mov_b32 s20, 4096
    buffer_store_dwordx4 v[20:23], v2, s[24:27], s20 offen offset:0 sc1
    buffer_store_dwordx4 v[20:23], v2, s[24:27], s20 offen offset:1024 sc1
    buffer_store_dwordx4 v[20:23], v2, s[24:27], s20 offen offset:2048 sc1
    buffer_store_dwordx4 v[20:23], v2, s[24:27], s20 offen offset:3072 sc1
    s_mov_b32 s20, 8192
    buffer_store_dwordx4 v[20:23], v2, s[24:27], s20 offen offset:0 sc1
nk_adaLN_cond__linear_kernel_hedgehog__glu_gated_swiglu__prompt_kernel_3:
    v_lshlrev_b32 v116, 16, v32
    v_and_b32 v117, 0xffff0000, v32
    v_lshlrev_b32 v118, 16, v33
    v_and_b32 v119, 0xffff0000, v33
    v_lshlrev_b32 v120, 16, v34
    v_and_b32 v121, 0xffff0000, v34
    v_lshlrev_b32 v122, 16, v35
    v_and_b32 v123, 0xffff0000, v35
    v_pk_mul_f32 v[124:125], v[116:117], v[112:113] op_sel_hi:[1,0]
    v_pk_mul_f32 v[126:127], v[118:119], v[112:113] op_sel_hi:[1,0]
    v_pk_mul_f32 v[128:129], v[120:121], v[112:113] op_sel_hi:[1,0]
    v_pk_mul_f32 v[130:131], v[122:123], v[112:113] op_sel_hi:[1,0]
    v_lshlrev_b32 v116, 16, v36
    v_and_b32 v117, 0xffff0000, v36
    v_lshlrev_b32 v118, 16, v37
    v_and_b32 v119, 0xffff0000, v37
    v_lshlrev_b32 v120, 16, v38
    v_and_b32 v121, 0xffff0000, v38
    v_lshlrev_b32 v122, 16, v39
    v_and_b32 v123, 0xffff0000, v39
    v_pk_fma_f32 v[124:125], v[116:117], v[112:113], v[124:125] op_sel:[0,1,0]
    v_pk_fma_f32 v[126:127], v[118:119], v[112:113], v[126:127] op_sel:[0,1,0]
    v_pk_fma_f32 v[128:129], v[120:121], v[112:113], v[128:129] op_sel:[0,1,0]
    v_pk_fma_f32 v[130:131], v[122:123], v[112:113], v[130:131] op_sel:[0,1,0]
    v_lshlrev_b32 v116, 16, v40
    v_and_b32 v117, 0xffff0000, v40
    v_lshlrev_b32 v118, 16, v41
    v_and_b32 v119, 0xffff0000, v41
    v_lshlrev_b32 v120, 16, v42
    v_and_b32 v121, 0xffff0000, v42
    v_lshlrev_b32 v122, 16, v43
    v_and_b32 v123, 0xffff0000, v43
    v_pk_fma_f32 v[124:125], v[116:117], v[114:115], v[124:125] op_sel_hi:[1,0,1]
    v_pk_fma_f32 v[126:127], v[118:119], v[114:115], v[126:127] op_sel_hi:[1,0,1]
    v_pk_fma_f32 v[128:129], v[120:121], v[114:115], v[128:129] op_sel_hi:[1,0,1]
    v_pk_fma_f32 v[130:131], v[122:123], v[114:115], v[130:131] op_sel_hi:[1,0,1]
    v_lshlrev_b32 v116, 16, v44
    v_and_b32 v117, 0xffff0000, v44
    v_lshlrev_b32 v118, 16, v45
    v_and_b32 v119, 0xffff0000, v45
    v_lshlrev_b32 v120, 16, v46
    v_and_b32 v121, 0xffff0000, v46
    v_lshlrev_b32 v122, 16, v47
    v_and_b32 v123, 0xffff0000, v47
    v_pk_fma_f32 v[124:125], v[116:117], v[114:115], v[124:125] op_sel:[0,1,0]
    v_pk_fma_f32 v[126:127], v[118:119], v[114:115], v[126:127] op_sel:[0,1,0]
    v_pk_fma_f32 v[128:129], v[120:121], v[114:115], v[128:129] op_sel:[0,1,0]
    v_pk_fma_f32 v[130:131], v[122:123], v[114:115], v[130:131] op_sel:[0,1,0]
    s_nop 1
    v_permlane32_swap_b32 v124, v128
    v_permlane32_swap_b32 v125, v129
    v_permlane32_swap_b32 v126, v130
    v_permlane32_swap_b32 v127, v131
    v_add_f32 v124, v124, v128
    v_add_f32 v125, v125, v129
    v_add_f32 v126, v126, v130
    v_add_f32 v127, v127, v131
    s_nop 1
    v_permlane16_swap_b32 v124, v126
    v_permlane16_swap_b32 v125, v127
    v_add_f32 v124, v124, v126
    v_add_f32 v125, v125, v127
    s_nop 1
    v_add_f32_dpp v126, v124, v124 row_ror:8 row_mask:0xf bank_mask:0xf
    v_add_f32_dpp v127, v125, v125 row_ror:8 row_mask:0xf bank_mask:0xf
    ds_write_b64 v13, v[126:127]
    s_waitcnt lgkmcnt(0)
    s_barrier
    s_cmp_lg_u32 s3, 0
    s_cbranch_scc1 nw_adaLN_cond__linear_kernel_hedgehog__glu_gated_swiglu__prompt_kernel_4
    v_lshlrev_b32 v18, 2, v1
    v_add_u32 v17, 108544, v18
    ds_read_b32 v20, v17 offset:0
    ds_read_b32 v21, v17 offset:256
    ds_read_b32 v22, v17 offset:512
    ds_read_b32 v23, v17 offset:768
    s_mov_b32 s24, s86
    s_and_b32 s25, s87, 0xffff
    s_mov_b32 s26, 256
    s_mov_b32 s27, 0x20000
    s_lshl_b32 s20, s21, 13
    s_and_b32 s22, s2, 31
    s_lshl_b32 s22, s22, 8
    s_add_u32 s20, s20, s22
    s_add_u32 s20, s20, 65536
    s_add_u32 s8, s4, s20
    s_addc_u32 s9, s5, 0
    s_and_b32 s9, s9, 0xffff
    s_mov_b32 s10, 256
    s_mov_b32 s11, 0x20000
    v_mov_b32 v24, 0
    s_waitcnt lgkmcnt(0)
    v_add_f32 v20, v20, v21
    v_add_f32 v22, v22, v23
    v_add_f32 v20, v20, v22
    buffer_store_dword v20, v18, s[8:11], 0 offen sc1
    s_mov_b32 s97, 0
rdy_adaLN_cond__linear_kernel_hedgehog__glu_gated_swiglu__prompt_kernel_5:
    buffer_load_dword v25, v24, s[24:27], 0 offen sc1
    s_waitcnt vmcnt(0)
    v_cmp_ne_u32 vcc, 1, v25
    s_cbranch_vccz rdyd_adaLN_cond__linear_kernel_hedgehog__glu_gated_swiglu__prompt_kernel_6
    s_add_u32 s97, s97, 1
    s_cmp_lt_u32 s97, 100000
    s_cbranch_scc1 rdy_adaLN_cond__linear_kernel_hedgehog__glu_gated_swiglu__prompt_kernel_5
rdyd_adaLN_cond__linear_kernel_hedgehog__glu_gated_swiglu__prompt_kernel_6:
    s_and_b32 s20, s2, 15
    s_nop 0
    s_cmp_lg_u32 s3, 0
    s_cbranch_scc1 arr_adaLN_cond__linear_kernel_hedgehog__glu_gated_swiglu__prompt_kernel_7
    s_lshl_b32 s96, s20, 8
    v_mov_b32 v28, 1
    v_mov_b32 v29, 0
    s_mov_b64 exec, 1
    buffer_atomic_add v28, v29, s[92:95], s96 offen sc1
    s_mov_b64 exec, -1
arr_adaLN_cond__linear_kernel_hedgehog__glu_gated_swiglu__prompt_kernel_7:
nw_adaLN_cond__linear_kernel_hedgehog__glu_gated_swiglu__prompt_kernel_4:
    s_cmp_lg_u32 s57, 0
    s_cbranch_scc1 prole_adaLN_cond__linear_kernel_hedgehog__glu_gated_swiglu__prompt_kernel_8
    s_waitcnt vmcnt(1)
    v_lshlrev_b32 v128, 16, v48
    v_and_b32 v129, 0xffff0000, v48
    v_lshlrev_b32 v130, 16, v49
    v_and_b32 v131, 0xffff0000, v49
    v_lshlrev_b32 v132, 16, v50
    v_and_b32 v133, 0xffff0000, v50
    v_lshlrev_b32 v134, 16, v51
    v_and_b32 v135, 0xffff0000, v51
    v_lshlrev_b32 v136, 16, v52
    s_add_u32 s61, s58, s59
    s_lshl_b32 s53, s61, 18
    s_mul_i32 s54, s61, 393216
    s_add_u32 s55, s53, 0x20000
    s_add_u32 s56, s54, 196608
    s_add_u32 s59, s59, 1
    s_and_b32 s59, s59, 3
    s_cmp_eq_u32 s59, s60
    s_cselect_b32 s61, 4, 0
    s_add_u32 s58, s58, s61
    s_mov_b32 s28, s53
    v_and_b32 v137, 0xffff0000, v52
    v_lshlrev_b32 v138, 16, v53
    v_and_b32 v139, 0xffff0000, v53
    v_lshlrev_b32 v140, 16, v54
    v_and_b32 v141, 0xffff0000, v54
    v_lshlrev_b32 v142, 16, v55
    v_and_b32 v143, 0xffff0000, v55
    v_lshlrev_b32 v144, 16, v56
    v_and_b32 v145, 0xffff0000, v56
    s_add_u32 m0, s52, 0
    s_nop 0
    v_lshlrev_b32 v146, 16, v57
    v_and_b32 v147, 0xffff0000, v57
    v_lshlrev_b32 v148, 16, v58
    v_and_b32 v149, 0xffff0000, v58
    v_lshlrev_b32 v150, 16, v59
    v_and_b32 v151, 0xffff0000, v59
    v_lshlrev_b32 v152, 16, v60
    v_and_b32 v153, 0xffff0000, v60
    v_lshlrev_b32 v154, 16, v61
    buffer_load_dwordx4 v5, s[36:39], s54 offen offset:0 lds
    v_and_b32 v155, 0xffff0000, v61
    v_lshlrev_b32 v156, 16, v62
    v_and_b32 v157, 0xffff0000, v62
    v_lshlrev_b32 v158, 16, v63
    v_and_b32 v159, 0xffff0000, v63
    v_lshlrev_b32 v160, 16, v64
    v_and_b32 v161, 0xffff0000, v64
    v_lshlrev_b32 v162, 16, v65
    v_and_b32 v163, 0xffff0000, v65
    buffer_load_dwordx4 v5, s[40:43], s54 offen offset:1024 lds
    v_lshlrev_b32 v164, 16, v66
    v_and_b32 v165, 0xffff0000, v66
    v_lshlrev_b32 v166, 16, v67
    v_and_b32 v167, 0xffff0000, v67
    v_lshlrev_b32 v168, 16, v68
    v_and_b32 v169, 0xffff0000, v68
    v_lshlrev_b32 v170, 16, v69
    v_and_b32 v171, 0xffff0000, v69
    v_lshlrev_b32 v172, 16, v70
    buffer_load_dwordx4 v5, s[44:47], s54 offen offset:2048 lds
    v_and_b32 v173, 0xffff0000, v70
    v_lshlrev_b32 v174, 16, v71
    v_and_b32 v175, 0xffff0000, v71
    v_lshlrev_b32 v176, 16, v72
    v_and_b32 v177, 0xffff0000, v72
    v_lshlrev_b32 v178, 16, v73
    v_and_b32 v179, 0xffff0000, v73
    v_lshlrev_b32 v180, 16, v74
    v_and_b32 v181, 0xffff0000, v74
    s_add_u32 m0, s52, 12544
    s_nop 0
    v_lshlrev_b32 v182, 16, v75
    v_and_b32 v183, 0xffff0000, v75
    v_lshlrev_b32 v184, 16, v76
    v_and_b32 v185, 0xffff0000, v76
    v_lshlrev_b32 v186, 16, v77
    v_and_b32 v187, 0xffff0000, v77
    v_lshlrev_b32 v188, 16, v78
    v_and_b32 v189, 0xffff0000, v78
    v_lshlrev_b32 v190, 16, v79
    buffer_load_dwordx4 v5, s[36:39], s56 offen offset:0 lds
    v_and_b32 v191, 0xffff0000, v79
    v_pk_add_f32 v[192:193], v[128:129], v[130:131]
    v_pk_add_f32 v[194:195], v[132:133], v[134:135]
    v_pk_add_f32 v[196:197], v[136:137], v[138:139]
    v_pk_add_f32 v[198:199], v[140:141], v[142:143]
    v_pk_add_f32 v[200:201], v[144:145], v[146:147]
    v_pk_add_f32 v[202:203], v[148:149], v[150:151]
    v_pk_add_f32 v[204:205], v[152:153], v[154:155]
    v_pk_add_f32 v[206:207], v[156:157], v[158:159]
    buffer_load_dwordx4 v5, s[40:43], s56 offen offset:1024 lds
    v_pk_add_f32 v[192:193], v[192:193], v[200:201]
    v_pk_add_f32 v[194:195], v[194:195], v[202:203]
    v_pk_add_f32 v[196:197], v[196:197], v[204:205]
    v_pk_add_f32 v[198:199], v[198:199], v[206:207]
    v_pk_add_f32 v[192:193], v[192:193], v[196:197]
    v_pk_add_f32 v[194:195], v[194:195], v[198:199]
    v_pk_add_f32 v[192:193], v[192:193], v[194:195]
    v_add_f32 v16, v192, v193
    v_pk_add_f32 v[224:225], v[160:161], v[162:163]
    buffer_load_dwordx4 v5, s[44:47], s56 offen offset:2048 lds
    v_pk_add_f32 v[226:227], v[164:165], v[166:167]
    v_pk_add_f32 v[228:229], v[168:169], v[170:171]
    v_pk_add_f32 v[230:231], v[172:173], v[174:175]
    v_pk_add_f32 v[232:233], v[176:177], v[178:179]
    v_pk_add_f32 v[234:235], v[180:181], v[182:183]
    v_pk_add_f32 v[236:237], v[184:185], v[186:187]
    v_pk_add_f32 v[238:239], v[188:189], v[190:191]
    v_pk_add_f32 v[224:225], v[224:225], v[232:233]
    v_pk_add_f32 v[226:227], v[226:227], v[234:235]
    s_add_u32 s61, s58, s59
    s_lshl_b32 s53, s61, 18
    s_mul_i32 s54, s61, 393216
    s_add_u32 s55, s53, 0x20000
    s_add_u32 s56, s54, 196608
    s_add_u32 s59, s59, 1
    s_and_b32 s59, s59, 3
    s_cmp_eq_u32 s59, s60
    s_cselect_b32 s61, 4, 0
    s_add_u32 s58, s58, s61
    s_mov_b32 s29, s53
    v_pk_add_f32 v[228:229], v[228:229], v[236:237]
    v_pk_add_f32 v[230:231], v[230:231], v[238:239]
    v_pk_add_f32 v[224:225], v[224:225], v[228:229]
    v_pk_add_f32 v[226:227], v[226:227], v[230:231]
    v_pk_add_f32 v[224:225], v[224:225], v[226:227]
    v_add_f32 v20, v224, v225
    s_nop 1
    v_add_f32_dpp v16, v16, v16 row_ror:8 row_mask:0xf bank_mask:0xf
    v_add_f32_dpp v20, v20, v20 row_ror:8 row_mask:0xf bank_mask:0xf
    s_add_u32 m0, s52, 25088
    s_nop 0
    v_mov_b32 v18, v16
    v_mov_b32 v22, v20
    s_nop 1
    v_permlane16_swap_b32 v16, v18
    v_permlane16_swap_b32 v20, v22
    v_add_f32 v16, v16, v18
    v_add_f32 v20, v20, v22
    v_mov_b32 v18, v16
    v_mov_b32 v22, v20
    buffer_load_dwordx4 v5, s[36:39], s54 offen offset:0 lds
    s_nop 1
    v_permlane32_swap_b32 v16, v18
    v_permlane32_swap_b32 v20, v22
    v_add_f32 v16, v16, v18
    v_add_f32 v20, v20, v22
    v_mul_f32 v16, 0x3b800000, v16
    v_mul_f32 v20, 0x3b800000, v20
    v_pk_add_f32 v[192:193], v[128:129], v[16:17] op_sel_hi:[1,0] neg_lo:[0,1] neg_hi:[0,1]
    v_pk_add_f32 v[194:195], v[130:131], v[16:17] op_sel_hi:[1,0] neg_lo:[0,1] neg_hi:[0,1]
    v_pk_add_f32 v[196:197], v[132:133], v[16:17] op_sel_hi:[1,0] neg_lo:[0,1] neg_hi:[0,1]
    buffer_load_dwordx4 v5, s[40:43], s54 offen offset:1024 lds
    v_pk_add_f32 v[198:199], v[134:135], v[16:17] op_sel_hi:[1,0] neg_lo:[0,1] neg_hi:[0,1]
    v_pk_add_f32 v[200:201], v[136:137], v[16:17] op_sel_hi:[1,0] neg_lo:[0,1] neg_hi:[0,1]
    v_pk_add_f32 v[202:203], v[138:139], v[16:17] op_sel_hi:[1,0] neg_lo:[0,1] neg_hi:[0,1]
    v_pk_add_f32 v[204:205], v[140:141], v[16:17] op_sel_hi:[1,0] neg_lo:[0,1] neg_hi:[0,1]
    v_pk_add_f32 v[206:207], v[142:143], v[16:17] op_sel_hi:[1,0] neg_lo:[0,1] neg_hi:[0,1]
    v_pk_add_f32 v[208:209], v[144:145], v[16:17] op_sel_hi:[1,0] neg_lo:[0,1] neg_hi:[0,1]
    v_pk_add_f32 v[210:211], v[146:147], v[16:17] op_sel_hi:[1,0] neg_lo:[0,1] neg_hi:[0,1]
    v_pk_add_f32 v[212:213], v[148:149], v[16:17] op_sel_hi:[1,0] neg_lo:[0,1] neg_hi:[0,1]
    v_pk_add_f32 v[214:215], v[150:151], v[16:17] op_sel_hi:[1,0] neg_lo:[0,1] neg_hi:[0,1]
    buffer_load_dwordx4 v5, s[44:47], s54 offen offset:2048 lds
    v_pk_add_f32 v[216:217], v[152:153], v[16:17] op_sel_hi:[1,0] neg_lo:[0,1] neg_hi:[0,1]
    v_pk_add_f32 v[218:219], v[154:155], v[16:17] op_sel_hi:[1,0] neg_lo:[0,1] neg_hi:[0,1]
    v_pk_add_f32 v[220:221], v[156:157], v[16:17] op_sel_hi:[1,0] neg_lo:[0,1] neg_hi:[0,1]
    v_pk_add_f32 v[222:223], v[158:159], v[16:17] op_sel_hi:[1,0] neg_lo:[0,1] neg_hi:[0,1]
    v_pk_mul_f32 v[24:25], v[192:193], v[192:193]
    v_pk_mul_f32 v[26:27], v[194:195], v[194:195]
    v_pk_fma_f32 v[24:25], v[196:197], v[196:197], v[24:25]
    v_pk_fma_f32 v[26:27], v[198:199], v[198:199], v[26:27]
    v_pk_fma_f32 v[24:25], v[200:201], v[200:201], v[24:25]
    v_pk_fma_f32 v[26:27], v[202:203], v[202:203], v[26:27]
    s_add_u32 m0, s52, 37632
    s_nop 0
    v_pk_fma_f32 v[24:25], v[204:205], v[204:205], v[24:25]
    v_pk_fma_f32 v[26:27], v[206:207], v[206:207], v[26:27]
    v_pk_fma_f32 v[24:25], v[208:209], v[208:209], v[24:25]
    v_pk_fma_f32 v[26:27], v[210:211], v[210:211], v[26:27]
    v_pk_fma_f32 v[24:25], v[212:213], v[212:213], v[24:25]
    v_pk_fma_f32 v[26:27], v[214:215], v[214:215], v[26:27]
    v_pk_fma_f32 v[24:25], v[216:217], v[216:217], v[24:25]
    v_pk_fma_f32 v[26:27], v[218:219], v[218:219], v[26:27]
    v_pk_fma_f32 v[24:25], v[220:221], v[220:221], v[24:25]
    buffer_load_dwordx4 v5, s[36:39], s56 offen offset:0 lds
    v_pk_fma_f32 v[26:27], v[222:223], v[222:223], v[26:27]
    v_pk_add_f32 v[24:25], v[24:25], v[26:27]
    v_add_f32 v17, v24, v25
    v_pk_add_f32 v[224:225], v[160:161], v[20:21] op_sel_hi:[1,0] neg_lo:[0,1] neg_hi:[0,1]
    v_pk_add_f32 v[226:227], v[162:163], v[20:21] op_sel_hi:[1,0] neg_lo:[0,1] neg_hi:[0,1]
    v_pk_add_f32 v[228:229], v[164:165], v[20:21] op_sel_hi:[1,0] neg_lo:[0,1] neg_hi:[0,1]
    v_pk_add_f32 v[230:231], v[166:167], v[20:21] op_sel_hi:[1,0] neg_lo:[0,1] neg_hi:[0,1]
    v_pk_add_f32 v[232:233], v[168:169], v[20:21] op_sel_hi:[1,0] neg_lo:[0,1] neg_hi:[0,1]
    v_pk_add_f32 v[234:235], v[170:171], v[20:21] op_sel_hi:[1,0] neg_lo:[0,1] neg_hi:[0,1]
    v_pk_add_f32 v[236:237], v[172:173], v[20:21] op_sel_hi:[1,0] neg_lo:[0,1] neg_hi:[0,1]
    buffer_load_dwordx4 v5, s[40:43], s56 offen offset:1024 lds
    v_pk_add_f32 v[238:239], v[174:175], v[20:21] op_sel_hi:[1,0] neg_lo:[0,1] neg_hi:[0,1]
    v_pk_add_f32 v[240:241], v[176:177], v[20:21] op_sel_hi:[1,0] neg_lo:[0,1] neg_hi:[0,1]
    v_pk_add_f32 v[242:243], v[178:179], v[20:21] op_sel_hi:[1,0] neg_lo:[0,1] neg_hi:[0,1]
    v_pk_add_f32 v[244:245], v[180:181], v[20:21] op_sel_hi:[1,0] neg_lo:[0,1] neg_hi:[0,1]
    v_pk_add_f32 v[246:247], v[182:183], v[20:21] op_sel_hi:[1,0] neg_lo:[0,1] neg_hi:[0,1]
    v_pk_add_f32 v[248:249], v[184:185], v[20:21] op_sel_hi:[1,0] neg_lo:[0,1] neg_hi:[0,1]
    v_pk_add_f32 v[250:251], v[186:187], v[20:21] op_sel_hi:[1,0] neg_lo:[0,1] neg_hi:[0,1]
    v_pk_add_f32 v[252:253], v[188:189], v[20:21] op_sel_hi:[1,0] neg_lo:[0,1] neg_hi:[0,1]
    v_pk_add_f32 v[254:255], v[190:191], v[20:21] op_sel_hi:[1,0] neg_lo:[0,1] neg_hi:[0,1]
    buffer_load_dwordx4 v5, s[44:47], s56 offen offset:2048 lds
    v_pk_mul_f32 v[24:25], v[224:225], v[224:225]
    v_pk_mul_f32 v[26:27], v[226:227], v[226:227]
    v_pk_fma_f32 v[24:25], v[228:229], v[228:229], v[24:25]
    v_pk_fma_f32 v[26:27], v[230:231], v[230:231], v[26:27]
    v_pk_fma_f32 v[24:25], v[232:233], v[232:233], v[24:25]
    v_pk_fma_f32 v[26:27], v[234:235], v[234:235], v[26:27]
    v_pk_fma_f32 v[24:25], v[236:237], v[236:237], v[24:25]
    v_pk_fma_f32 v[26:27], v[238:239], v[238:239], v[26:27]
    v_pk_fma_f32 v[24:25], v[240:241], v[240:241], v[24:25]
    v_pk_fma_f32 v[26:27], v[242:243], v[242:243], v[26:27]
    s_add_u32 s61, s58, s59
    s_lshl_b32 s53, s61, 18
    s_mul_i32 s54, s61, 393216
    s_add_u32 s55, s53, 0x20000
    s_add_u32 s56, s54, 196608
    s_add_u32 s59, s59, 1
    s_and_b32 s59, s59, 3
    s_cmp_eq_u32 s59, s60
    s_cselect_b32 s61, 4, 0
    s_add_u32 s58, s58, s61
    s_mov_b32 s30, s53
    v_pk_fma_f32 v[24:25], v[244:245], v[244:245], v[24:25]
    v_pk_fma_f32 v[26:27], v[246:247], v[246:247], v[26:27]
    v_pk_fma_f32 v[24:25], v[248:249], v[248:249], v[24:25]
    v_pk_fma_f32 v[26:27], v[250:251], v[250:251], v[26:27]
    v_pk_fma_f32 v[24:25], v[252:253], v[252:253], v[24:25]
    v_pk_fma_f32 v[26:27], v[254:255], v[254:255], v[26:27]
    v_pk_add_f32 v[24:25], v[24:25], v[26:27]
    v_add_f32 v21, v24, v25
    s_nop 1
    v_add_f32_dpp v17, v17, v17 row_ror:8 row_mask:0xf bank_mask:0xf
    s_add_u32 m0, s52, 50176
    s_nop 0
    v_add_f32_dpp v21, v21, v21 row_ror:8 row_mask:0xf bank_mask:0xf
    v_mov_b32 v18, v17
    v_mov_b32 v22, v21
    s_nop 1
    v_permlane16_swap_b32 v17, v18
    v_permlane16_swap_b32 v21, v22
    v_add_f32 v17, v17, v18
    v_add_f32 v21, v21, v22
    v_mov_b32 v18, v17
    buffer_load_dwordx4 v5, s[36:39], s54 offen offset:0 lds
    v_mov_b32 v22, v21
    s_nop 1
    v_permlane32_swap_b32 v17, v18
    v_permlane32_swap_b32 v21, v22
    v_add_f32 v17, v17, v18
    v_add_f32 v21, v21, v22
    v_lshlrev_b32 v13, 5, v3
    v_add_u32 v13, 110592, v13
    s_lshl_b32 s20, s3, 3
    v_add_u32 v18, s20, v13
    ds_write_b64 v18, v[16:17]
    ds_write_b64 v18, v[20:21] offset:256
    buffer_load_dwordx4 v5, s[40:43], s54 offen offset:1024 lds
    s_waitcnt lgkmcnt(0)
    s_barrier
    ds_read_b128 v[32:35], v13 offset:0
    ds_read_b128 v[36:39], v13 offset:16
    ds_read_b128 v[40:43], v13 offset:256
    ds_read_b128 v[44:47], v13 offset:272
    s_waitcnt lgkmcnt(0)
    v_pk_add_f32 v[16:17], v[32:33], v[34:35]
    v_pk_add_f32 v[26:27], v[36:37], v[38:39]
    v_pk_add_f32 v[16:17], v[16:17], v[26:27]
    v_mul_f32 v16, 0x3e800000, v16
    v_mov_b32 v26, 0
    v_sub_f32 v27, v32, v16
    v_fmac_f32 v26, v27, v27
    v_sub_f32 v27, v34, v16
    v_fmac_f32 v26, v27, v27
    buffer_load_dwordx4 v5, s[44:47], s54 offen offset:2048 lds
    v_sub_f32 v27, v36, v16
    v_fmac_f32 v26, v27, v27
    v_sub_f32 v27, v38, v16
    v_fmac_f32 v26, v27, v27
    v_fmac_f32 v17, 0x43800000, v26
    v_mul_f32 v17, 0x3a800000, v17
    v_cvt_pk_bf16_f32 v17, v16, v17
    v_lshlrev_b32 v16, 16, v17
    v_and_b32 v17, 0xffff0000, v17
    v_add_f32 v17, 0x3727c5ac, v17
    v_cvt_pk_bf16_f32 v17, v17, v17
    s_add_u32 m0, s52, 62720
    s_nop 0
    v_and_b32 v17, 0xffff0000, v17
    v_sqrt_f32 v17, v17
    s_nop 0
    v_cvt_pk_bf16_f32 v17, v17, v17
    v_and_b32 v17, 0xffff0000, v17
    v_rcp_f32 v18, v17
    v_pk_add_f32 v[20:21], v[40:41], v[42:43]
    v_pk_add_f32 v[26:27], v[44:45], v[46:47]
    v_pk_add_f32 v[20:21], v[20:21], v[26:27]
    v_mul_f32 v20, 0x3e800000, v20
    v_mov_b32 v26, 0
    v_sub_f32 v27, v40, v20
    v_fmac_f32 v26, v27, v27
    buffer_load_dwordx4 v5, s[36:39], s56 offen offset:0 lds
    v_sub_f32 v27, v42, v20
    v_fmac_f32 v26, v27, v27
    v_sub_f32 v27, v44, v20
    v_fmac_f32 v26, v27, v27
    v_sub_f32 v27, v46, v20
    v_fmac_f32 v26, v27, v27
    v_fmac_f32 v21, 0x43800000, v26
    v_mul_f32 v21, 0x3a800000, v21
    v_cvt_pk_bf16_f32 v21, v20, v21
    v_lshlrev_b32 v20, 16, v21
    v_and_b32 v21, 0xffff0000, v21
    v_add_f32 v21, 0x3727c5ac, v21
    buffer_load_dwordx4 v5, s[40:43], s56 offen offset:1024 lds
    v_cvt_pk_bf16_f32 v21, v21, v21
    v_and_b32 v21, 0xffff0000, v21
    v_sqrt_f32 v21, v21
    s_nop 0
    v_cvt_pk_bf16_f32 v21, v21, v21
    v_and_b32 v21, 0xffff0000, v21
    v_rcp_f32 v22, v21
    v_pk_add_f32 v[128:129], v[128:129], v[16:17] op_sel_hi:[1,0] neg_lo:[0,1] neg_hi:[0,1]
    v_pk_add_f32 v[130:131], v[130:131], v[16:17] op_sel_hi:[1,0] neg_lo:[0,1] neg_hi:[0,1]
    v_pk_add_f32 v[132:133], v[132:133], v[16:17] op_sel_hi:[1,0] neg_lo:[0,1] neg_hi:[0,1]
    buffer_load_dwordx4 v5, s[44:47], s56 offen offset:2048 lds
    v_pk_add_f32 v[134:135], v[134:135], v[16:17] op_sel_hi:[1,0] neg_lo:[0,1] neg_hi:[0,1]
    v_pk_add_f32 v[136:137], v[136:137], v[16:17] op_sel_hi:[1,0] neg_lo:[0,1] neg_hi:[0,1]
    v_pk_add_f32 v[138:139], v[138:139], v[16:17] op_sel_hi:[1,0] neg_lo:[0,1] neg_hi:[0,1]
    v_pk_add_f32 v[140:141], v[140:141], v[16:17] op_sel_hi:[1,0] neg_lo:[0,1] neg_hi:[0,1]
    v_pk_add_f32 v[142:143], v[142:143], v[16:17] op_sel_hi:[1,0] neg_lo:[0,1] neg_hi:[0,1]
    v_pk_add_f32 v[144:145], v[144:145], v[16:17] op_sel_hi:[1,0] neg_lo:[0,1] neg_hi:[0,1]
    v_pk_add_f32 v[146:147], v[146:147], v[16:17] op_sel_hi:[1,0] neg_lo:[0,1] neg_hi:[0,1]
    v_pk_add_f32 v[148:149], v[148:149], v[16:17] op_sel_hi:[1,0] neg_lo:[0,1] neg_hi:[0,1]
    v_pk_add_f32 v[150:151], v[150:151], v[16:17] op_sel_hi:[1,0] neg_lo:[0,1] neg_hi:[0,1]
    s_lshl_b32 s61, s3, 10
    s_add_u32 m0, s61, 100352
    s_nop 0
    buffer_load_dwordx4 v12, s[48:51], 0 offen lds
    v_pk_add_f32 v[152:153], v[152:153], v[16:17] op_sel_hi:[1,0] neg_lo:[0,1] neg_hi:[0,1]
    v_pk_add_f32 v[154:155], v[154:155], v[16:17] op_sel_hi:[1,0] neg_lo:[0,1] neg_hi:[0,1]
    v_pk_add_f32 v[156:157], v[156:157], v[16:17] op_sel_hi:[1,0] neg_lo:[0,1] neg_hi:[0,1]
    v_pk_add_f32 v[158:159], v[158:159], v[16:17] op_sel_hi:[1,0] neg_lo:[0,1] neg_hi:[0,1]
    v_pk_mul_f32 v[128:129], v[128:129], v[18:19] op_sel_hi:[1,0]
    v_pk_mul_f32 v[130:131], v[130:131], v[18:19] op_sel_hi:[1,0]
    v_pk_mul_f32 v[132:133], v[132:133], v[18:19] op_sel_hi:[1,0]
    v_pk_mul_f32 v[134:135], v[134:135], v[18:19] op_sel_hi:[1,0]
    v_pk_mul_f32 v[136:137], v[136:137], v[18:19] op_sel_hi:[1,0]
    v_pk_mul_f32 v[138:139], v[138:139], v[18:19] op_sel_hi:[1,0]
    v_pk_mul_f32 v[140:141], v[140:141], v[18:19] op_sel_hi:[1,0]
    v_pk_mul_f32 v[142:143], v[142:143], v[18:19] op_sel_hi:[1,0]
    v_pk_mul_f32 v[144:145], v[144:145], v[18:19] op_sel_hi:[1,0]
    v_pk_mul_f32 v[146:147], v[146:147], v[18:19] op_sel_hi:[1,0]
    v_pk_mul_f32 v[148:149], v[148:149], v[18:19] op_sel_hi:[1,0]
    v_pk_mul_f32 v[150:151], v[150:151], v[18:19] op_sel_hi:[1,0]
    v_pk_mul_f32 v[152:153], v[152:153], v[18:19] op_sel_hi:[1,0]
    v_pk_mul_f32 v[154:155], v[154:155], v[18:19] op_sel_hi:[1,0]
    v_pk_mul_f32 v[156:157], v[156:157], v[18:19] op_sel_hi:[1,0]
    v_pk_mul_f32 v[158:159], v[158:159], v[18:19] op_sel_hi:[1,0]
    s_add_u32 s8, s4, 65536
    s_addc_u32 s9, s5, 0
    s_and_b32 s9, s9, 0xffff
    s_mov_b32 s10, 65536
    s_mov_b32 s11, 0x20000
    v_add_u32 v16, 4096, v2
    s_lshl_b32 s20, s3, 11
    s_add_u32 s20, s20, 111104
    v_add_u32 v18, s20, v2
    v_lshlrev_b32 v24, 5, v10
    v_add_u32 v24, s20, v24
    s_add_u32 s24, s4, 1048576
    s_addc_u32 s25, s5, 0
    s_and_b32 s25, s25, 0xffff
    s_mov_b32 s26, 4194304
    s_mov_b32 s27, 0x20000
    v_lshrrev_b32 v19, 2, v10
    v_lshlrev_b32 v19, 17, v19
    v_and_b32 v25, 3, v10
    v_lshl_add_u32 v19, v25, 8, v19
    v_lshl_add_u32 v19, v3, 4, v19
    s_lshl_b32 s22, s3, 20
    s_lshl_b32 s21, s31, 10
    s_add_u32 s22, s22, s21
    s_lshl_b32 s21, s3, 10
    s_mov_b32 s20, 0
    s_cmp_lg_u32 s3, 0
    s_cbranch_scc1 wt_adaLN_cond__linear_kernel_hedgehog__glu_gated_swiglu__prompt_kernel_10
    s_lshl_b32 s96, s20, 8
    v_and_b32 v29, 15, v1
    v_lshlrev_b32 v29, 8, v29
    s_mov_b32 s97, 0
    s_mov_b64 exec, 65535
poll_adaLN_cond__linear_kernel_hedgehog__glu_gated_swiglu__prompt_kernel_11:
    buffer_load_dword v28, v29, s[92:95], s96 offen sc1
    s_waitcnt vmcnt(0)
    v_cmp_ne_u32 vcc, 16, v28
    s_cbranch_vccz pdone_adaLN_cond__linear_kernel_hedgehog__glu_gated_swiglu__prompt_kernel_12
    s_add_u32 s97, s97, 1
    s_cmp_lt_u32 s97, 100000
    s_cbranch_scc1 poll_adaLN_cond__linear_kernel_hedgehog__glu_gated_swiglu__prompt_kernel_11
pdone_adaLN_cond__linear_kernel_hedgehog__glu_gated_swiglu__prompt_kernel_12:
    s_mov_b64 exec, -1
wt_adaLN_cond__linear_kernel_hedgehog__glu_gated_swiglu__prompt_kernel_10:
    s_barrier
    buffer_load_dwordx4 v[32:35], v2, s[8:11], s21 offen sc1
    buffer_load_dwordx4 v[36:39], v16, s[8:11], s21 offen sc1
    s_add_u32 s21, s21, 8192
    buffer_load_dwordx4 v[40:43], v2, s[8:11], s21 offen sc1
    buffer_load_dwordx4 v[44:47], v16, s[8:11], s21 offen sc1
    s_add_u32 s21, s21, 8192
    buffer_load_dwordx4 v[48:51], v2, s[8:11], s21 offen sc1
    buffer_load_dwordx4 v[52:55], v16, s[8:11], s21 offen sc1
    s_add_u32 s21, s21, 8192
    buffer_load_dwordx4 v[56:59], v2, s[8:11], s21 offen sc1
    buffer_load_dwordx4 v[60:63], v16, s[8:11], s21 offen sc1
    s_add_u32 s21, s21, 8192
    buffer_load_dwordx4 v[64:67], v2, s[8:11], s21 offen sc1
    buffer_load_dwordx4 v[68:71], v16, s[8:11], s21 offen sc1
    s_add_u32 s21, s21, 8192
    buffer_load_dwordx4 v[72:75], v2, s[8:11], s21 offen sc1
    buffer_load_dwordx4 v[76:79], v16, s[8:11], s21 offen sc1
    s_add_u32 s21, s21, 8192
    buffer_load_dwordx4 v[80:83], v2, s[8:11], s21 offen sc1
    buffer_load_dwordx4 v[84:87], v16, s[8:11], s21 offen sc1
    s_add_u32 s21, s21, 8192
    buffer_load_dwordx4 v[88:91], v2, s[8:11], s21 offen sc1
    buffer_load_dwordx4 v[92:95], v16, s[8:11], s21 offen sc1
    v_pk_add_f32 v[160:161], v[160:161], v[20:21] op_sel_hi:[1,0] neg_lo:[0,1] neg_hi:[0,1]
    v_pk_add_f32 v[162:163], v[162:163], v[20:21] op_sel_hi:[1,0] neg_lo:[0,1] neg_hi:[0,1]
    v_pk_add_f32 v[164:165], v[164:165], v[20:21] op_sel_hi:[1,0] neg_lo:[0,1] neg_hi:[0,1]
    v_pk_add_f32 v[166:167], v[166:167], v[20:21] op_sel_hi:[1,0] neg_lo:[0,1] neg_hi:[0,1]
    v_pk_add_f32 v[168:169], v[168:169], v[20:21] op_sel_hi:[1,0] neg_lo:[0,1] neg_hi:[0,1]
    v_pk_add_f32 v[170:171], v[170:171], v[20:21] op_sel_hi:[1,0] neg_lo:[0,1] neg_hi:[0,1]
    v_pk_add_f32 v[172:173], v[172:173], v[20:21] op_sel_hi:[1,0] neg_lo:[0,1] neg_hi:[0,1]
    v_pk_add_f32 v[174:175], v[174:175], v[20:21] op_sel_hi:[1,0] neg_lo:[0,1] neg_hi:[0,1]
    v_pk_add_f32 v[176:177], v[176:177], v[20:21] op_sel_hi:[1,0] neg_lo:[0,1] neg_hi:[0,1]
    v_pk_add_f32 v[178:179], v[178:179], v[20:21] op_sel_hi:[1,0] neg_lo:[0,1] neg_hi:[0,1]
    v_pk_add_f32 v[180:181], v[180:181], v[20:21] op_sel_hi:[1,0] neg_lo:[0,1] neg_hi:[0,1]
    v_pk_add_f32 v[182:183], v[182:183], v[20:21] op_sel_hi:[1,0] neg_lo:[0,1] neg_hi:[0,1]
    v_pk_add_f32 v[184:185], v[184:185], v[20:21] op_sel_hi:[1,0] neg_lo:[0,1] neg_hi:[0,1]
    v_pk_add_f32 v[186:187], v[186:187], v[20:21] op_sel_hi:[1,0] neg_lo:[0,1] neg_hi:[0,1]
    v_pk_add_f32 v[188:189], v[188:189], v[20:21] op_sel_hi:[1,0] neg_lo:[0,1] neg_hi:[0,1]
    v_pk_add_f32 v[190:191], v[190:191], v[20:21] op_sel_hi:[1,0] neg_lo:[0,1] neg_hi:[0,1]
    v_pk_mul_f32 v[160:161], v[160:161], v[22:23] op_sel_hi:[1,0]
    v_pk_mul_f32 v[162:163], v[162:163], v[22:23] op_sel_hi:[1,0]
    v_pk_mul_f32 v[164:165], v[164:165], v[22:23] op_sel_hi:[1,0]
    v_pk_mul_f32 v[166:167], v[166:167], v[22:23] op_sel_hi:[1,0]
    v_pk_mul_f32 v[168:169], v[168:169], v[22:23] op_sel_hi:[1,0]
    v_pk_mul_f32 v[170:171], v[170:171], v[22:23] op_sel_hi:[1,0]
    v_pk_mul_f32 v[172:173], v[172:173], v[22:23] op_sel_hi:[1,0]
    v_pk_mul_f32 v[174:175], v[174:175], v[22:23] op_sel_hi:[1,0]
    v_pk_mul_f32 v[176:177], v[176:177], v[22:23] op_sel_hi:[1,0]
    v_pk_mul_f32 v[178:179], v[178:179], v[22:23] op_sel_hi:[1,0]
    v_pk_mul_f32 v[180:181], v[180:181], v[22:23] op_sel_hi:[1,0]
    v_pk_mul_f32 v[182:183], v[182:183], v[22:23] op_sel_hi:[1,0]
    v_pk_mul_f32 v[184:185], v[184:185], v[22:23] op_sel_hi:[1,0]
    v_pk_mul_f32 v[186:187], v[186:187], v[22:23] op_sel_hi:[1,0]
    v_pk_mul_f32 v[188:189], v[188:189], v[22:23] op_sel_hi:[1,0]
    v_pk_mul_f32 v[190:191], v[190:191], v[22:23] op_sel_hi:[1,0]
    s_waitcnt vmcnt(12)
    v_pk_add_f32 v[32:33], v[32:33], v[40:41]
    v_pk_add_f32 v[34:35], v[34:35], v[42:43]
    v_pk_add_f32 v[36:37], v[36:37], v[44:45]
    v_pk_add_f32 v[38:39], v[38:39], v[46:47]
    s_waitcnt vmcnt(10)
    v_pk_add_f32 v[32:33], v[32:33], v[48:49]
    v_pk_add_f32 v[34:35], v[34:35], v[50:51]
    v_pk_add_f32 v[36:37], v[36:37], v[52:53]
    v_pk_add_f32 v[38:39], v[38:39], v[54:55]
    s_waitcnt vmcnt(8)
    v_pk_add_f32 v[32:33], v[32:33], v[56:57]
    v_pk_add_f32 v[34:35], v[34:35], v[58:59]
    v_pk_add_f32 v[36:37], v[36:37], v[60:61]
    v_pk_add_f32 v[38:39], v[38:39], v[62:63]
    s_waitcnt vmcnt(6)
    v_pk_add_f32 v[32:33], v[32:33], v[64:65]
    v_pk_add_f32 v[34:35], v[34:35], v[66:67]
    v_pk_add_f32 v[36:37], v[36:37], v[68:69]
    v_pk_add_f32 v[38:39], v[38:39], v[70:71]
    s_waitcnt vmcnt(4)
    v_pk_add_f32 v[32:33], v[32:33], v[72:73]
    v_pk_add_f32 v[34:35], v[34:35], v[74:75]
    v_pk_add_f32 v[36:37], v[36:37], v[76:77]
    v_pk_add_f32 v[38:39], v[38:39], v[78:79]
    s_waitcnt vmcnt(2)
    v_pk_add_f32 v[32:33], v[32:33], v[80:81]
    v_pk_add_f32 v[34:35], v[34:35], v[82:83]
    v_pk_add_f32 v[36:37], v[36:37], v[84:85]
    v_pk_add_f32 v[38:39], v[38:39], v[86:87]
    s_waitcnt vmcnt(0)
    v_pk_add_f32 v[32:33], v[32:33], v[88:89]
    v_pk_add_f32 v[34:35], v[34:35], v[90:91]
    v_pk_add_f32 v[36:37], v[36:37], v[92:93]
    v_pk_add_f32 v[38:39], v[38:39], v[94:95]
    v_cvt_pk_bf16_f32 v33, v32, v33
    v_lshlrev_b32 v32, 16, v33
    v_and_b32 v33, 0xffff0000, v33
    v_cvt_pk_bf16_f32 v35, v34, v35
    v_lshlrev_b32 v34, 16, v35
    v_and_b32 v35, 0xffff0000, v35
    v_cvt_pk_bf16_f32 v37, v36, v37
    v_lshlrev_b32 v36, 16, v37
    v_and_b32 v37, 0xffff0000, v37
    v_cvt_pk_bf16_f32 v39, v38, v39
    v_lshlrev_b32 v38, 16, v39
    v_and_b32 v39, 0xffff0000, v39
    v_add_f32 v36, 1.0, v36
    v_add_f32 v37, 1.0, v37
    v_add_f32 v38, 1.0, v38
    v_add_f32 v39, 1.0, v39
    v_cvt_pk_bf16_f32 v37, v36, v37
    v_lshlrev_b32 v36, 16, v37
    v_and_b32 v37, 0xffff0000, v37
    v_cvt_pk_bf16_f32 v39, v38, v39
    v_lshlrev_b32 v38, 16, v39
    v_and_b32 v39, 0xffff0000, v39
    ds_write_b128 v18, v[32:35]
    ds_write_b128 v18, v[36:39] offset:1024
    s_waitcnt lgkmcnt(0)
    ds_read_b128 v[64:67], v24 offset:1024
    ds_read_b128 v[68:71], v24 offset:1040
    ds_read_b128 v[32:35], v24 offset:0
    ds_read_b128 v[36:39], v24 offset:16
    ds_read_b128 v[72:75], v24 offset:1280
    ds_read_b128 v[76:79], v24 offset:1296
    ds_read_b128 v[40:43], v24 offset:256
    ds_read_b128 v[44:47], v24 offset:272
    ds_read_b128 v[80:83], v24 offset:1536
    ds_read_b128 v[84:87], v24 offset:1552
    ds_read_b128 v[48:51], v24 offset:512
    ds_read_b128 v[52:55], v24 offset:528
    ds_read_b128 v[88:91], v24 offset:1792
    ds_read_b128 v[92:95], v24 offset:1808
    ds_read_b128 v[56:59], v24 offset:768
    ds_read_b128 v[60:63], v24 offset:784
    s_waitcnt lgkmcnt(12)
    v_pk_fma_f32 v[128:129], v[128:129], v[64:65], v[32:33]
    v_pk_fma_f32 v[130:131], v[130:131], v[66:67], v[34:35]
    v_pk_fma_f32 v[132:133], v[132:133], v[68:69], v[36:37]
    v_pk_fma_f32 v[134:135], v[134:135], v[70:71], v[38:39]
    v_cvt_pk_bf16_f32 v96, v128, v129
    v_cvt_pk_bf16_f32 v97, v130, v131
    v_cvt_pk_bf16_f32 v98, v132, v133
    v_cvt_pk_bf16_f32 v99, v134, v135
    buffer_store_dwordx4 v[96:99], v19, s[24:27], s22 offen offset:0 sc1
    v_pk_fma_f32 v[160:161], v[160:161], v[64:65], v[32:33]
    v_pk_fma_f32 v[162:163], v[162:163], v[66:67], v[34:35]
    v_pk_fma_f32 v[164:165], v[164:165], v[68:69], v[36:37]
    v_pk_fma_f32 v[166:167], v[166:167], v[70:71], v[38:39]
    v_cvt_pk_bf16_f32 v112, v160, v161
    v_cvt_pk_bf16_f32 v113, v162, v163
    v_cvt_pk_bf16_f32 v114, v164, v165
    v_cvt_pk_bf16_f32 v115, v166, v167
    buffer_store_dwordx4 v[112:115], v19, s[24:27], s22 offen offset:128 sc1
    s_add_u32 s22, s22, 0x40000
    s_waitcnt lgkmcnt(8)
    v_pk_fma_f32 v[136:137], v[136:137], v[72:73], v[40:41]
    v_pk_fma_f32 v[138:139], v[138:139], v[74:75], v[42:43]
    v_pk_fma_f32 v[140:141], v[140:141], v[76:77], v[44:45]
    v_pk_fma_f32 v[142:143], v[142:143], v[78:79], v[46:47]
    v_cvt_pk_bf16_f32 v100, v136, v137
    v_cvt_pk_bf16_f32 v101, v138, v139
    v_cvt_pk_bf16_f32 v102, v140, v141
    v_cvt_pk_bf16_f32 v103, v142, v143
    buffer_store_dwordx4 v[100:103], v19, s[24:27], s22 offen offset:0 sc1
    v_pk_fma_f32 v[168:169], v[168:169], v[72:73], v[40:41]
    v_pk_fma_f32 v[170:171], v[170:171], v[74:75], v[42:43]
    v_pk_fma_f32 v[172:173], v[172:173], v[76:77], v[44:45]
    v_pk_fma_f32 v[174:175], v[174:175], v[78:79], v[46:47]
    v_cvt_pk_bf16_f32 v116, v168, v169
    v_cvt_pk_bf16_f32 v117, v170, v171
    v_cvt_pk_bf16_f32 v118, v172, v173
    v_cvt_pk_bf16_f32 v119, v174, v175
    buffer_store_dwordx4 v[116:119], v19, s[24:27], s22 offen offset:128 sc1
    s_add_u32 s22, s22, 0x40000
    s_waitcnt lgkmcnt(4)
    v_pk_fma_f32 v[144:145], v[144:145], v[80:81], v[48:49]
    v_pk_fma_f32 v[146:147], v[146:147], v[82:83], v[50:51]
    v_pk_fma_f32 v[148:149], v[148:149], v[84:85], v[52:53]
    v_pk_fma_f32 v[150:151], v[150:151], v[86:87], v[54:55]
    v_cvt_pk_bf16_f32 v104, v144, v145
    v_cvt_pk_bf16_f32 v105, v146, v147
    v_cvt_pk_bf16_f32 v106, v148, v149
    v_cvt_pk_bf16_f32 v107, v150, v151
    buffer_store_dwordx4 v[104:107], v19, s[24:27], s22 offen offset:0 sc1
    v_pk_fma_f32 v[176:177], v[176:177], v[80:81], v[48:49]
    v_pk_fma_f32 v[178:179], v[178:179], v[82:83], v[50:51]
    v_pk_fma_f32 v[180:181], v[180:181], v[84:85], v[52:53]
    v_pk_fma_f32 v[182:183], v[182:183], v[86:87], v[54:55]
    v_cvt_pk_bf16_f32 v120, v176, v177
    v_cvt_pk_bf16_f32 v121, v178, v179
    v_cvt_pk_bf16_f32 v122, v180, v181
    v_cvt_pk_bf16_f32 v123, v182, v183
    buffer_store_dwordx4 v[120:123], v19, s[24:27], s22 offen offset:128 sc1
    s_add_u32 s22, s22, 0x40000
    s_waitcnt lgkmcnt(0)
    v_pk_fma_f32 v[152:153], v[152:153], v[88:89], v[56:57]
    v_pk_fma_f32 v[154:155], v[154:155], v[90:91], v[58:59]
    v_pk_fma_f32 v[156:157], v[156:157], v[92:93], v[60:61]
    v_pk_fma_f32 v[158:159], v[158:159], v[94:95], v[62:63]
    v_cvt_pk_bf16_f32 v108, v152, v153
    v_cvt_pk_bf16_f32 v109, v154, v155
    v_cvt_pk_bf16_f32 v110, v156, v157
    v_cvt_pk_bf16_f32 v111, v158, v159
    buffer_store_dwordx4 v[108:111], v19, s[24:27], s22 offen offset:0 sc1
    v_pk_fma_f32 v[184:185], v[184:185], v[88:89], v[56:57]
    v_pk_fma_f32 v[186:187], v[186:187], v[90:91], v[58:59]
    v_pk_fma_f32 v[188:189], v[188:189], v[92:93], v[60:61]
    v_pk_fma_f32 v[190:191], v[190:191], v[94:95], v[62:63]
    v_cvt_pk_bf16_f32 v124, v184, v185
    v_cvt_pk_bf16_f32 v125, v186, v187
    v_cvt_pk_bf16_f32 v126, v188, v189
    v_cvt_pk_bf16_f32 v127, v190, v191
    buffer_store_dwordx4 v[124:127], v19, s[24:27], s22 offen offset:128 sc1
    v_lshrrev_b32 v13, 2, v1
    v_lshlrev_b32 v13, 6, v13
    v_lshl_add_u32 v13, v15, 3, v13
    v_add_u32 v13, 100352, v13
    v_and_b32 v16, 15, v1
    s_lshl_b32 s61, s3, 5
    v_add_u32 v17, s61, v16
    v_mul_u32_u24 v18, 144, v17
    v_lshl_add_u32 v18, v11, 4, v18
    v_add_u32 v18, 104448, v18
    v_mul_u32_u24 v19, 80, v17
    v_lshl_add_u32 v19, v11, 3, v19
    v_add_u32 v19, 141312, v19
    v_lshl_add_u32 v17, v11, 3, v14
    s_lshr_b32 s12, s3, 1
    s_and_b32 s13, s3, 1
    s_mul_i32 s14, s12, 18432
    s_lshl_b32 s15, s13, 6
    s_add_u32 s14, s14, s15
    s_add_u32 s14, s14, 104448
    v_mul_u32_u24 v20, 144, v17
    v_lshl_add_u32 v20, v15, 4, v20
    v_add_u32 v20, s14, v20
    s_mul_i32 s14, s12, 10240
    s_add_u32 s14, s14, 141312
    v_mul_u32_u24 v21, 80, v17
    v_lshl_add_u32 v21, v15, 3, v21
    v_add_u32 v21, s14, v21
    s_lshl_b32 s14, s62, 5
    s_lshl_b32 s15, s63, 1
    s_add_u32 s14, s14, s15
    s_add_u32 s14, s14, s12
    s_mul_i32 s14, s14, 4352
    s_add_u32 s14, s14, 17825792
    s_add_u32 s16, s4, s14
    s_addc_u32 s17, s5, 0
    s_and_b32 s17, s17, 0xffff
    s_mov_b32 s18, 4352
    s_mov_b32 s19, 0x20000
    s_lshl_b32 s14, s13, 11
    v_add_u32 v22, s14, v2
    v_lshlrev_b32 v23, 13, v16
    v_lshl_add_u32 v23, v11, 4, v23
    s_lshl_b32 s14, s13, 6
    s_add_u32 s14, s14, 4096
    v_add_u32 v23, s14, v23
    s_mov_b32 s8, 1069066811
    s_mov_b32 s9, 1069066811
    s_mov_b32 s10, 3216550459
    s_mov_b32 s11, 3216550459
    v_mov_b32 v24, 0x3f803f80
    v_mov_b32 v25, 0x3f803f80
    v_mov_b32 v26, 0x3f803f80
    v_mov_b32 v27, 0x3f803f80
    s_lshl_b32 s20, s7, 2
    s_add_u32 s20, s20, s3
    s_lshl_b32 s20, s20, 3
    v_lshrrev_b32 v56, 3, v1
    v_add_u32 v56, s20, v56
    v_mul_u32_u24 v57, 7168, v56
    v_lshl_add_u32 v57, v3, 7, v57
    v_lshlrev_b32 v56, 11, v56
    v_lshl_add_u32 v56, v3, 7, v56
    v_lshlrev_b32 v55, 7, v1
    s_and_b32 s12, s7, 7
    s_lshr_b32 s13, s7, 3
    s_lshr_b32 s14, s6, 2
    s_lshl_b32 s14, s14, 4
    s_lshl_b32 s22, s12, 1
    s_add_u32 s22, s22, s14
    s_and_b32 s14, s6, 1
    s_add_u32 s22, s22, s14
    s_and_b32 s14, s6, 2
    s_lshl_b32 s14, s14, 1
    s_add_u32 s23, s14, s13
    s_lshl_b32 s12, s23, 8
    s_sub_u32 s13, 2097152, s12
    s_add_u32 s24, s70, s12
    s_addc_u32 s25, s71, 0
    s_and_b32 s25, s25, 0xffff
    s_mov_b32 s26, s13
    s_mov_b32 s27, 0x20000
    s_lshl_b32 s21, s22, 17
    s_add_u32 s21, s21, s12
    v_lshlrev_b32 v58, 2, v11
    v_xor_b32 v58, v16, v58
    v_lshlrev_b32 v58, 4, v58
    v_lshl_add_u32 v58, v11, 11, v58
    s_lshl_b32 s12, s3, 16
    v_add_u32 v60, s12, v58
    v_add_u32 v61, 7168, v60
    v_add_u32 v62, 14336, v60
    v_add_u32 v63, 21504, v60
    s_lshl_b32 s12, s3, 4
    v_add_u32 v59, s12, v16
    v_lshlrev_b32 v59, 11, v59
    v_lshl_add_u32 v59, v11, 4, v59
    s_lshr_b32 s20, s31, 3
    s_add_u32 s20, s20, 16
    s_waitcnt vmcnt(0) lgkmcnt(0)
    s_barrier
    s_cmp_lg_u32 s3, 0
    s_cbranch_scc1 arr_adaLN_cond__linear_kernel_hedgehog__glu_gated_swiglu__prompt_kernel_13
    s_lshl_b32 s96, s20, 8
    v_mov_b32 v28, 1
    v_mov_b32 v29, 0
    s_mov_b64 exec, 1
    buffer_atomic_add v28, v29, s[92:95], s96 offen sc1
    s_mov_b64 exec, -1
arr_adaLN_cond__linear_kernel_hedgehog__glu_gated_swiglu__prompt_kernel_13:
    s_branch join_adaLN_cond__linear_kernel_hedgehog__glu_gated_swiglu__prompt_kernel_9
prole_adaLN_cond__linear_kernel_hedgehog__glu_gated_swiglu__prompt_kernel_8:
    s_barrier
    s_add_u32 s61, s58, s59
    s_lshl_b32 s53, s61, 18
    s_mul_i32 s54, s61, 393216
    s_add_u32 s55, s53, 0x20000
    s_add_u32 s56, s54, 196608
    s_add_u32 s59, s59, 1
    s_and_b32 s59, s59, 3
    s_cmp_eq_u32 s59, s60
    s_cselect_b32 s61, 4, 0
    s_add_u32 s58, s58, s61
    s_mov_b32 s28, s53
    s_add_u32 m0, s52, 0
    s_nop 0
    buffer_load_dwordx4 v5, s[36:39], s54 offen offset:0 lds
    buffer_load_dwordx4 v5, s[40:43], s54 offen offset:1024 lds
    buffer_load_dwordx4 v5, s[44:47], s54 offen offset:2048 lds
    s_add_u32 m0, s52, 12544
    s_nop 0
    buffer_load_dwordx4 v5, s[36:39], s56 offen offset:0 lds
    buffer_load_dwordx4 v5, s[40:43], s56 offen offset:1024 lds
    buffer_load_dwordx4 v5, s[44:47], s56 offen offset:2048 lds
    s_add_u32 s61, s58, s59
    s_lshl_b32 s53, s61, 18
    s_mul_i32 s54, s61, 393216
    s_add_u32 s55, s53, 0x20000
    s_add_u32 s56, s54, 196608
    s_add_u32 s59, s59, 1
    s_and_b32 s59, s59, 3
    s_cmp_eq_u32 s59, s60
    s_cselect_b32 s61, 4, 0
    s_add_u32 s58, s58, s61
    s_mov_b32 s29, s53
    s_add_u32 m0, s52, 25088
    s_nop 0
    buffer_load_dwordx4 v5, s[36:39], s54 offen offset:0 lds
    buffer_load_dwordx4 v5, s[40:43], s54 offen offset:1024 lds
    buffer_load_dwordx4 v5, s[44:47], s54 offen offset:2048 lds
    s_add_u32 m0, s52, 37632
    s_nop 0
    buffer_load_dwordx4 v5, s[36:39], s56 offen offset:0 lds
    buffer_load_dwordx4 v5, s[40:43], s56 offen offset:1024 lds
    buffer_load_dwordx4 v5, s[44:47], s56 offen offset:2048 lds
    s_add_u32 s61, s58, s59
    s_lshl_b32 s53, s61, 18
    s_mul_i32 s54, s61, 393216
    s_add_u32 s55, s53, 0x20000
    s_add_u32 s56, s54, 196608
    s_add_u32 s59, s59, 1
    s_and_b32 s59, s59, 3
    s_cmp_eq_u32 s59, s60
    s_cselect_b32 s61, 4, 0
    s_add_u32 s58, s58, s61
    s_mov_b32 s30, s53
    s_add_u32 m0, s52, 50176
    s_nop 0
    buffer_load_dwordx4 v5, s[36:39], s54 offen offset:0 lds
    buffer_load_dwordx4 v5, s[40:43], s54 offen offset:1024 lds
    buffer_load_dwordx4 v5, s[44:47], s54 offen offset:2048 lds
    s_add_u32 m0, s52, 62720
    s_nop 0
    buffer_load_dwordx4 v5, s[36:39], s56 offen offset:0 lds
    buffer_load_dwordx4 v5, s[40:43], s56 offen offset:1024 lds
    buffer_load_dwordx4 v5, s[44:47], s56 offen offset:2048 lds
    s_lshl_b32 s61, s3, 10
    s_add_u32 m0, s61, 100352
    s_nop 0
    buffer_load_dwordx4 v12, s[48:51], 0 offen lds
    s_and_b32 s20, s31, 63
    s_lshl_b32 s20, s20, 7
    s_lshr_b32 s23, s31, 6
    s_mul_i32 s22, s23, 6291456
    s_add_u32 s22, s22, s20
    s_add_u32 s22, s22, 4096
    v_mul_u32_u24 v16, 12288, v19
    v_lshl_add_u32 v16, v3, 4, v16
    buffer_load_dwordx4 v[132:135], v16, s[12:15], s22 offen nt
    s_add_u32 s22, s22, 393216
    buffer_load_dwordx4 v[136:139], v16, s[12:15], s22 offen nt
    s_add_u32 s22, s22, 393216
    buffer_load_dwordx4 v[140:143], v16, s[12:15], s22 offen nt
    s_add_u32 s22, s22, 393216
    buffer_load_dwordx4 v[144:147], v16, s[12:15], s22 offen nt
    s_add_u32 s22, s22, 393216
    buffer_load_dwordx4 v[148:151], v16, s[12:15], s22 offen nt
    s_add_u32 s22, s22, 393216
    buffer_load_dwordx4 v[152:155], v16, s[12:15], s22 offen nt
    s_add_u32 s22, s22, 393216
    buffer_load_dwordx4 v[156:159], v16, s[12:15], s22 offen nt
    s_add_u32 s22, s22, 393216
    buffer_load_dwordx4 v[160:163], v16, s[12:15], s22 offen nt
    s_add_u32 s22, s22, 393216
    buffer_load_dwordx4 v[164:167], v16, s[12:15], s22 offen nt
    s_add_u32 s22, s22, 393216
    buffer_load_dwordx4 v[168:171], v16, s[12:15], s22 offen nt
    s_add_u32 s22, s22, 393216
    buffer_load_dwordx4 v[172:175], v16, s[12:15], s22 offen nt
    s_add_u32 s22, s22, 393216
    buffer_load_dwordx4 v[176:179], v16, s[12:15], s22 offen nt
    s_add_u32 s22, s22, 393216
    buffer_load_dwordx4 v[180:183], v16, s[12:15], s22 offen nt
    s_add_u32 s22, s22, 393216
    buffer_load_dwordx4 v[184:187], v16, s[12:15], s22 offen nt
    s_add_u32 s22, s22, 393216
    buffer_load_dwordx4 v[188:191], v16, s[12:15], s22 offen nt
    s_add_u32 s22, s22, 393216
    buffer_load_dwordx4 v[192:195], v16, s[12:15], s22 offen nt
    s_mov_b32 s8, s70
    s_and_b32 s9, s71, 0xffff
    s_mov_b32 s10, 2097152
    s_mov_b32 s11, 0x20000
    s_lshl_b32 s20, s31, 2
    s_add_u32 s20, s20, s3
    s_lshl_b32 s20, s20, 12
    v_lshlrev_b32 v17, 6, v1
    buffer_load_dword a249, v17, s[8:11], s20 offen
    s_lshl_b32 s20, s23, 11
    s_add_u32 s20, s20, 104448
    v_lshlrev_b32 v16, 2, v19
    v_add_u32 v16, s20, v16
    ds_read_b32 v96, v16 offset:0
    ds_read_b32 v97, v16 offset:128
    ds_read_b32 v98, v16 offset:256
    ds_read_b32 v99, v16 offset:384
    ds_read_b32 v100, v16 offset:512
    ds_read_b32 v101, v16 offset:640
    ds_read_b32 v102, v16 offset:768
    ds_read_b32 v103, v16 offset:896
    ds_read_b32 v104, v16 offset:1024
    ds_read_b32 v105, v16 offset:1152
    ds_read_b32 v106, v16 offset:1280
    ds_read_b32 v107, v16 offset:1408
    ds_read_b32 v108, v16 offset:1536
    ds_read_b32 v109, v16 offset:1664
    ds_read_b32 v110, v16 offset:1792
    ds_read_b32 v111, v16 offset:1920
    s_cmp_lg_u32 s3, 2
    s_cbranch_scc1 n2_adaLN_cond__linear_kernel_hedgehog__glu_gated_swiglu__prompt_kernel_14
    s_lshl_b32 s20, s31, 10
    s_add_u32 s20, s20, 524288
    s_add_u32 s24, s4, s20
    s_addc_u32 s25, s5, 0
    s_and_b32 s25, s25, 0xffff
    s_mov_b32 s26, 1024
    s_mov_b32 s27, 0x20000
    v_mov_b32 v20, 0
    v_mov_b32 v21, 3212836864
    v_mov_b32 v22, 0
    v_mov_b32 v23, 3212836864
    buffer_store_dwordx4 v[20:23], v2, s[24:27], 0 offen sc1
n2_adaLN_cond__linear_kernel_hedgehog__glu_gated_swiglu__prompt_kernel_14:
    s_waitcnt lgkmcnt(0)
    s_waitcnt vmcnt(16)
    v_lshlrev_b32 v116, 16, v132
    v_and_b32 v117, 0xffff0000, v132
    v_lshlrev_b32 v118, 16, v133
    v_and_b32 v119, 0xffff0000, v133
    v_lshlrev_b32 v120, 16, v134
    v_and_b32 v121, 0xffff0000, v134
    v_lshlrev_b32 v122, 16, v135
    v_and_b32 v123, 0xffff0000, v135
    v_pk_mul_f32 v[124:125], v[116:117], v[96:97] op_sel_hi:[1,0]
    v_pk_mul_f32 v[126:127], v[118:119], v[96:97] op_sel_hi:[1,0]
    v_pk_mul_f32 v[128:129], v[120:121], v[96:97] op_sel_hi:[1,0]
    v_pk_mul_f32 v[130:131], v[122:123], v[96:97] op_sel_hi:[1,0]
    s_waitcnt vmcnt(15)
    v_lshlrev_b32 v116, 16, v136
    v_and_b32 v117, 0xffff0000, v136
    v_lshlrev_b32 v118, 16, v137
    v_and_b32 v119, 0xffff0000, v137
    v_lshlrev_b32 v120, 16, v138
    v_and_b32 v121, 0xffff0000, v138
    v_lshlrev_b32 v122, 16, v139
    v_and_b32 v123, 0xffff0000, v139
    v_pk_fma_f32 v[124:125], v[116:117], v[96:97], v[124:125] op_sel:[0,1,0]
    v_pk_fma_f32 v[126:127], v[118:119], v[96:97], v[126:127] op_sel:[0,1,0]
    v_pk_fma_f32 v[128:129], v[120:121], v[96:97], v[128:129] op_sel:[0,1,0]
    v_pk_fma_f32 v[130:131], v[122:123], v[96:97], v[130:131] op_sel:[0,1,0]
    s_waitcnt vmcnt(14)
    v_lshlrev_b32 v116, 16, v140
    v_and_b32 v117, 0xffff0000, v140
    v_lshlrev_b32 v118, 16, v141
    v_and_b32 v119, 0xffff0000, v141
    v_lshlrev_b32 v120, 16, v142
    v_and_b32 v121, 0xffff0000, v142
    v_lshlrev_b32 v122, 16, v143
    v_and_b32 v123, 0xffff0000, v143
    v_pk_fma_f32 v[124:125], v[116:117], v[98:99], v[124:125] op_sel_hi:[1,0,1]
    v_pk_fma_f32 v[126:127], v[118:119], v[98:99], v[126:127] op_sel_hi:[1,0,1]
    v_pk_fma_f32 v[128:129], v[120:121], v[98:99], v[128:129] op_sel_hi:[1,0,1]
    v_pk_fma_f32 v[130:131], v[122:123], v[98:99], v[130:131] op_sel_hi:[1,0,1]
    s_waitcnt vmcnt(13)
    v_lshlrev_b32 v116, 16, v144
    v_and_b32 v117, 0xffff0000, v144
    v_lshlrev_b32 v118, 16, v145
    v_and_b32 v119, 0xffff0000, v145
    v_lshlrev_b32 v120, 16, v146
    v_and_b32 v121, 0xffff0000, v146
    v_lshlrev_b32 v122, 16, v147
    v_and_b32 v123, 0xffff0000, v147
    v_pk_fma_f32 v[124:125], v[116:117], v[98:99], v[124:125] op_sel:[0,1,0]
    v_pk_fma_f32 v[126:127], v[118:119], v[98:99], v[126:127] op_sel:[0,1,0]
    v_pk_fma_f32 v[128:129], v[120:121], v[98:99], v[128:129] op_sel:[0,1,0]
    v_pk_fma_f32 v[130:131], v[122:123], v[98:99], v[130:131] op_sel:[0,1,0]
    s_waitcnt vmcnt(12)
    v_lshlrev_b32 v116, 16, v148
    v_and_b32 v117, 0xffff0000, v148
    v_lshlrev_b32 v118, 16, v149
    v_and_b32 v119, 0xffff0000, v149
    v_lshlrev_b32 v120, 16, v150
    v_and_b32 v121, 0xffff0000, v150
    v_lshlrev_b32 v122, 16, v151
    v_and_b32 v123, 0xffff0000, v151
    v_pk_fma_f32 v[124:125], v[116:117], v[100:101], v[124:125] op_sel_hi:[1,0,1]
    v_pk_fma_f32 v[126:127], v[118:119], v[100:101], v[126:127] op_sel_hi:[1,0,1]
    v_pk_fma_f32 v[128:129], v[120:121], v[100:101], v[128:129] op_sel_hi:[1,0,1]
    v_pk_fma_f32 v[130:131], v[122:123], v[100:101], v[130:131] op_sel_hi:[1,0,1]
    s_waitcnt vmcnt(11)
    v_lshlrev_b32 v116, 16, v152
    v_and_b32 v117, 0xffff0000, v152
    v_lshlrev_b32 v118, 16, v153
    v_and_b32 v119, 0xffff0000, v153
    v_lshlrev_b32 v120, 16, v154
    v_and_b32 v121, 0xffff0000, v154
    v_lshlrev_b32 v122, 16, v155
    v_and_b32 v123, 0xffff0000, v155
    v_pk_fma_f32 v[124:125], v[116:117], v[100:101], v[124:125] op_sel:[0,1,0]
    v_pk_fma_f32 v[126:127], v[118:119], v[100:101], v[126:127] op_sel:[0,1,0]
    v_pk_fma_f32 v[128:129], v[120:121], v[100:101], v[128:129] op_sel:[0,1,0]
    v_pk_fma_f32 v[130:131], v[122:123], v[100:101], v[130:131] op_sel:[0,1,0]
    s_waitcnt vmcnt(10)
    v_lshlrev_b32 v116, 16, v156
    v_and_b32 v117, 0xffff0000, v156
    v_lshlrev_b32 v118, 16, v157
    v_and_b32 v119, 0xffff0000, v157
    v_lshlrev_b32 v120, 16, v158
    v_and_b32 v121, 0xffff0000, v158
    v_lshlrev_b32 v122, 16, v159
    v_and_b32 v123, 0xffff0000, v159
    v_pk_fma_f32 v[124:125], v[116:117], v[102:103], v[124:125] op_sel_hi:[1,0,1]
    v_pk_fma_f32 v[126:127], v[118:119], v[102:103], v[126:127] op_sel_hi:[1,0,1]
    v_pk_fma_f32 v[128:129], v[120:121], v[102:103], v[128:129] op_sel_hi:[1,0,1]
    v_pk_fma_f32 v[130:131], v[122:123], v[102:103], v[130:131] op_sel_hi:[1,0,1]
    s_waitcnt vmcnt(9)
    v_lshlrev_b32 v116, 16, v160
    v_and_b32 v117, 0xffff0000, v160
    v_lshlrev_b32 v118, 16, v161
    v_and_b32 v119, 0xffff0000, v161
    v_lshlrev_b32 v120, 16, v162
    v_and_b32 v121, 0xffff0000, v162
    v_lshlrev_b32 v122, 16, v163
    v_and_b32 v123, 0xffff0000, v163
    v_pk_fma_f32 v[124:125], v[116:117], v[102:103], v[124:125] op_sel:[0,1,0]
    v_pk_fma_f32 v[126:127], v[118:119], v[102:103], v[126:127] op_sel:[0,1,0]
    v_pk_fma_f32 v[128:129], v[120:121], v[102:103], v[128:129] op_sel:[0,1,0]
    v_pk_fma_f32 v[130:131], v[122:123], v[102:103], v[130:131] op_sel:[0,1,0]
    s_waitcnt vmcnt(8)
    v_lshlrev_b32 v116, 16, v164
    v_and_b32 v117, 0xffff0000, v164
    v_lshlrev_b32 v118, 16, v165
    v_and_b32 v119, 0xffff0000, v165
    v_lshlrev_b32 v120, 16, v166
    v_and_b32 v121, 0xffff0000, v166
    v_lshlrev_b32 v122, 16, v167
    v_and_b32 v123, 0xffff0000, v167
    v_pk_fma_f32 v[124:125], v[116:117], v[104:105], v[124:125] op_sel_hi:[1,0,1]
    v_pk_fma_f32 v[126:127], v[118:119], v[104:105], v[126:127] op_sel_hi:[1,0,1]
    v_pk_fma_f32 v[128:129], v[120:121], v[104:105], v[128:129] op_sel_hi:[1,0,1]
    v_pk_fma_f32 v[130:131], v[122:123], v[104:105], v[130:131] op_sel_hi:[1,0,1]
    s_waitcnt vmcnt(7)
    v_lshlrev_b32 v116, 16, v168
    v_and_b32 v117, 0xffff0000, v168
    v_lshlrev_b32 v118, 16, v169
    v_and_b32 v119, 0xffff0000, v169
    v_lshlrev_b32 v120, 16, v170
    v_and_b32 v121, 0xffff0000, v170
    v_lshlrev_b32 v122, 16, v171
    v_and_b32 v123, 0xffff0000, v171
    v_pk_fma_f32 v[124:125], v[116:117], v[104:105], v[124:125] op_sel:[0,1,0]
    v_pk_fma_f32 v[126:127], v[118:119], v[104:105], v[126:127] op_sel:[0,1,0]
    v_pk_fma_f32 v[128:129], v[120:121], v[104:105], v[128:129] op_sel:[0,1,0]
    v_pk_fma_f32 v[130:131], v[122:123], v[104:105], v[130:131] op_sel:[0,1,0]
    s_waitcnt vmcnt(6)
    v_lshlrev_b32 v116, 16, v172
    v_and_b32 v117, 0xffff0000, v172
    v_lshlrev_b32 v118, 16, v173
    v_and_b32 v119, 0xffff0000, v173
    v_lshlrev_b32 v120, 16, v174
    v_and_b32 v121, 0xffff0000, v174
    v_lshlrev_b32 v122, 16, v175
    v_and_b32 v123, 0xffff0000, v175
    v_pk_fma_f32 v[124:125], v[116:117], v[106:107], v[124:125] op_sel_hi:[1,0,1]
    v_pk_fma_f32 v[126:127], v[118:119], v[106:107], v[126:127] op_sel_hi:[1,0,1]
    v_pk_fma_f32 v[128:129], v[120:121], v[106:107], v[128:129] op_sel_hi:[1,0,1]
    v_pk_fma_f32 v[130:131], v[122:123], v[106:107], v[130:131] op_sel_hi:[1,0,1]
    s_waitcnt vmcnt(5)
    v_lshlrev_b32 v116, 16, v176
    v_and_b32 v117, 0xffff0000, v176
    v_lshlrev_b32 v118, 16, v177
    v_and_b32 v119, 0xffff0000, v177
    v_lshlrev_b32 v120, 16, v178
    v_and_b32 v121, 0xffff0000, v178
    v_lshlrev_b32 v122, 16, v179
    v_and_b32 v123, 0xffff0000, v179
    v_pk_fma_f32 v[124:125], v[116:117], v[106:107], v[124:125] op_sel:[0,1,0]
    v_pk_fma_f32 v[126:127], v[118:119], v[106:107], v[126:127] op_sel:[0,1,0]
    v_pk_fma_f32 v[128:129], v[120:121], v[106:107], v[128:129] op_sel:[0,1,0]
    v_pk_fma_f32 v[130:131], v[122:123], v[106:107], v[130:131] op_sel:[0,1,0]
    s_waitcnt vmcnt(4)
    v_lshlrev_b32 v116, 16, v180
    v_and_b32 v117, 0xffff0000, v180
    v_lshlrev_b32 v118, 16, v181
    v_and_b32 v119, 0xffff0000, v181
    v_lshlrev_b32 v120, 16, v182
    v_and_b32 v121, 0xffff0000, v182
    v_lshlrev_b32 v122, 16, v183
    v_and_b32 v123, 0xffff0000, v183
    v_pk_fma_f32 v[124:125], v[116:117], v[108:109], v[124:125] op_sel_hi:[1,0,1]
    v_pk_fma_f32 v[126:127], v[118:119], v[108:109], v[126:127] op_sel_hi:[1,0,1]
    v_pk_fma_f32 v[128:129], v[120:121], v[108:109], v[128:129] op_sel_hi:[1,0,1]
    v_pk_fma_f32 v[130:131], v[122:123], v[108:109], v[130:131] op_sel_hi:[1,0,1]
    s_waitcnt vmcnt(3)
    v_lshlrev_b32 v116, 16, v184
    v_and_b32 v117, 0xffff0000, v184
    v_lshlrev_b32 v118, 16, v185
    v_and_b32 v119, 0xffff0000, v185
    v_lshlrev_b32 v120, 16, v186
    v_and_b32 v121, 0xffff0000, v186
    v_lshlrev_b32 v122, 16, v187
    v_and_b32 v123, 0xffff0000, v187
    v_pk_fma_f32 v[124:125], v[116:117], v[108:109], v[124:125] op_sel:[0,1,0]
    v_pk_fma_f32 v[126:127], v[118:119], v[108:109], v[126:127] op_sel:[0,1,0]
    v_pk_fma_f32 v[128:129], v[120:121], v[108:109], v[128:129] op_sel:[0,1,0]
    v_pk_fma_f32 v[130:131], v[122:123], v[108:109], v[130:131] op_sel:[0,1,0]
    s_waitcnt vmcnt(2)
    v_lshlrev_b32 v116, 16, v188
    v_and_b32 v117, 0xffff0000, v188
    v_lshlrev_b32 v118, 16, v189
    v_and_b32 v119, 0xffff0000, v189
    v_lshlrev_b32 v120, 16, v190
    v_and_b32 v121, 0xffff0000, v190
    v_lshlrev_b32 v122, 16, v191
    v_and_b32 v123, 0xffff0000, v191
    v_pk_fma_f32 v[124:125], v[116:117], v[110:111], v[124:125] op_sel_hi:[1,0,1]
    v_pk_fma_f32 v[126:127], v[118:119], v[110:111], v[126:127] op_sel_hi:[1,0,1]
    v_pk_fma_f32 v[128:129], v[120:121], v[110:111], v[128:129] op_sel_hi:[1,0,1]
    v_pk_fma_f32 v[130:131], v[122:123], v[110:111], v[130:131] op_sel_hi:[1,0,1]
    s_waitcnt vmcnt(1)
    v_lshlrev_b32 v116, 16, v192
    v_and_b32 v117, 0xffff0000, v192
    v_lshlrev_b32 v118, 16, v193
    v_and_b32 v119, 0xffff0000, v193
    v_lshlrev_b32 v120, 16, v194
    v_and_b32 v121, 0xffff0000, v194
    v_lshlrev_b32 v122, 16, v195
    v_and_b32 v123, 0xffff0000, v195
    v_pk_fma_f32 v[124:125], v[116:117], v[110:111], v[124:125] op_sel:[0,1,0]
    v_pk_fma_f32 v[126:127], v[118:119], v[110:111], v[126:127] op_sel:[0,1,0]
    v_pk_fma_f32 v[128:129], v[120:121], v[110:111], v[128:129] op_sel:[0,1,0]
    v_pk_fma_f32 v[130:131], v[122:123], v[110:111], v[130:131] op_sel:[0,1,0]
    s_nop 1
    v_permlane32_swap_b32 v124, v128
    v_permlane32_swap_b32 v125, v129
    v_permlane32_swap_b32 v126, v130
    v_permlane32_swap_b32 v127, v131
    v_add_f32 v124, v124, v128
    v_add_f32 v125, v125, v129
    v_add_f32 v126, v126, v130
    v_add_f32 v127, v127, v131
    s_nop 1
    v_permlane16_swap_b32 v124, v126
    v_permlane16_swap_b32 v125, v127
    v_add_f32 v124, v124, v126
    v_add_f32 v125, v125, v127
    s_nop 1
    v_add_f32_dpp v126, v124, v124 row_ror:8 row_mask:0xf bank_mask:0xf
    v_add_f32_dpp v127, v125, v125 row_ror:8 row_mask:0xf bank_mask:0xf
    ds_write_b64 v13, v[126:127] offset:1024
    s_waitcnt lgkmcnt(0)
    s_barrier
    s_cmp_lg_u32 s3, 1
    s_cbranch_scc1 n1_adaLN_cond__linear_kernel_hedgehog__glu_gated_swiglu__prompt_kernel_15
    v_lshlrev_b32 v18, 2, v1
    v_add_u32 v17, 109568, v18
    ds_read_b32 v20, v17 offset:0
    ds_read_b32 v21, v17 offset:256
    ds_read_b32 v22, v17 offset:512
    ds_read_b32 v23, v17 offset:768
    s_lshl_b32 s20, s31, 8
    s_add_u32 s20, s20, 196608
    s_add_u32 s24, s4, s20
    s_addc_u32 s25, s5, 0
    s_and_b32 s25, s25, 0xffff
    s_mov_b32 s26, 256
    s_mov_b32 s27, 0x20000
    s_waitcnt lgkmcnt(0)
    v_add_f32 v20, v20, v21
    v_add_f32 v22, v22, v23
    v_add_f32 v20, v20, v22
    buffer_store_dword v20, v18, s[24:27], 0 offen sc1
n1_adaLN_cond__linear_kernel_hedgehog__glu_gated_swiglu__prompt_kernel_15:
    v_lshrrev_b32 v13, 2, v1
    v_lshlrev_b32 v13, 6, v13
    v_lshl_add_u32 v13, v15, 3, v13
    v_add_u32 v13, 100352, v13
    v_and_b32 v16, 15, v1
    s_lshl_b32 s61, s3, 5
    v_add_u32 v17, s61, v16
    v_mul_u32_u24 v18, 144, v17
    v_lshl_add_u32 v18, v11, 4, v18
    v_add_u32 v18, 104448, v18
    v_mul_u32_u24 v19, 80, v17
    v_lshl_add_u32 v19, v11, 3, v19
    v_add_u32 v19, 141312, v19
    v_lshl_add_u32 v17, v11, 3, v14
    s_lshr_b32 s12, s3, 1
    s_and_b32 s13, s3, 1
    s_mul_i32 s14, s12, 18432
    s_lshl_b32 s15, s13, 6
    s_add_u32 s14, s14, s15
    s_add_u32 s14, s14, 104448
    v_mul_u32_u24 v20, 144, v17
    v_lshl_add_u32 v20, v15, 4, v20
    v_add_u32 v20, s14, v20
    s_mul_i32 s14, s12, 10240
    s_add_u32 s14, s14, 141312
    v_mul_u32_u24 v21, 80, v17
    v_lshl_add_u32 v21, v15, 3, v21
    v_add_u32 v21, s14, v21
    s_lshl_b32 s14, s62, 5
    s_lshl_b32 s15, s63, 1
    s_add_u32 s14, s14, s15
    s_add_u32 s14, s14, s12
    s_mul_i32 s14, s14, 4352
    s_add_u32 s14, s14, 17825792
    s_add_u32 s16, s4, s14
    s_addc_u32 s17, s5, 0
    s_and_b32 s17, s17, 0xffff
    s_mov_b32 s18, 4352
    s_mov_b32 s19, 0x20000
    s_lshl_b32 s14, s13, 11
    v_add_u32 v22, s14, v2
    v_lshlrev_b32 v23, 13, v16
    v_lshl_add_u32 v23, v11, 4, v23
    s_lshl_b32 s14, s13, 6
    s_add_u32 s14, s14, 4096
    v_add_u32 v23, s14, v23
    s_mov_b32 s8, 1069066811
    s_mov_b32 s9, 1069066811
    s_mov_b32 s10, 3216550459
    s_mov_b32 s11, 3216550459
    v_mov_b32 v24, 0x3f803f80
    v_mov_b32 v25, 0x3f803f80
    v_mov_b32 v26, 0x3f803f80
    v_mov_b32 v27, 0x3f803f80
    s_lshl_b32 s20, s7, 2
    s_add_u32 s20, s20, s3
    s_lshl_b32 s20, s20, 3
    v_lshrrev_b32 v56, 3, v1
    v_add_u32 v56, s20, v56
    v_mul_u32_u24 v57, 7168, v56
    v_lshl_add_u32 v57, v3, 7, v57
    v_lshlrev_b32 v56, 11, v56
    v_lshl_add_u32 v56, v3, 7, v56
    v_lshlrev_b32 v55, 7, v1
    s_and_b32 s12, s7, 7
    s_lshr_b32 s13, s7, 3
    s_lshr_b32 s14, s6, 2
    s_lshl_b32 s14, s14, 4
    s_lshl_b32 s22, s12, 1
    s_add_u32 s22, s22, s14
    s_and_b32 s14, s6, 1
    s_add_u32 s22, s22, s14
    s_and_b32 s14, s6, 2
    s_lshl_b32 s14, s14, 1
    s_add_u32 s23, s14, s13
    s_lshl_b32 s12, s23, 8
    s_sub_u32 s13, 2097152, s12
    s_add_u32 s24, s70, s12
    s_addc_u32 s25, s71, 0
    s_and_b32 s25, s25, 0xffff
    s_mov_b32 s26, s13
    s_mov_b32 s27, 0x20000
    s_lshl_b32 s21, s22, 17
    s_add_u32 s21, s21, s12
    v_lshlrev_b32 v58, 2, v11
    v_xor_b32 v58, v16, v58
    v_lshlrev_b32 v58, 4, v58
    v_lshl_add_u32 v58, v11, 11, v58
    s_lshl_b32 s12, s3, 16
    v_add_u32 v60, s12, v58
    v_add_u32 v61, 7168, v60
    v_add_u32 v62, 14336, v60
    v_add_u32 v63, 21504, v60
    s_lshl_b32 s12, s3, 4
    v_add_u32 v59, s12, v16
    v_lshlrev_b32 v59, 11, v59
    v_lshl_add_u32 v59, v11, 4, v59
join_adaLN_cond__linear_kernel_hedgehog__glu_gated_swiglu__prompt_kernel_9:
    s_add_u32 s20, s62, 16
    s_waitcnt vmcnt(0)
    s_cmp_lg_u32 s3, 0
    s_cbranch_scc1 wt_adaLN_cond__linear_kernel_hedgehog__glu_gated_swiglu__prompt_kernel_16
    s_lshl_b32 s96, s20, 8
    v_and_b32 v29, 0, v1
    v_lshlrev_b32 v29, 8, v29
    s_mov_b32 s97, 0
    s_mov_b64 exec, 1
poll_adaLN_cond__linear_kernel_hedgehog__glu_gated_swiglu__prompt_kernel_17:
    buffer_load_dword v28, v29, s[92:95], s96 offen sc1
    s_waitcnt vmcnt(0)
    v_cmp_ne_u32 vcc, 8, v28
    s_cbranch_vccz pdone_adaLN_cond__linear_kernel_hedgehog__glu_gated_swiglu__prompt_kernel_18
    s_add_u32 s97, s97, 1
    s_cmp_lt_u32 s97, 100000
    s_cbranch_scc1 poll_adaLN_cond__linear_kernel_hedgehog__glu_gated_swiglu__prompt_kernel_17
pdone_adaLN_cond__linear_kernel_hedgehog__glu_gated_swiglu__prompt_kernel_18:
    s_mov_b64 exec, -1
wt_adaLN_cond__linear_kernel_hedgehog__glu_gated_swiglu__prompt_kernel_16:
    s_barrier
    s_add_u32 s61, s28, 0x20000
    buffer_load_dwordx4 a[64:67], v4, s[32:35], s28 offen sc1
    buffer_load_dwordx4 a[68:71], v4, s[32:35], s28 offen offset:1024 sc1
    buffer_load_dwordx4 a[72:75], v4, s[32:35], s61 offen sc1
    buffer_load_dwordx4 a[76:79], v4, s[32:35], s61 offen offset:1024 sc1
    s_add_u32 s61, s29, 0x20000
    buffer_load_dwordx4 a[80:83], v4, s[32:35], s29 offen sc1
    buffer_load_dwordx4 a[84:87], v4, s[32:35], s29 offen offset:1024 sc1
    buffer_load_dwordx4 a[88:91], v4, s[32:35], s61 offen sc1
    buffer_load_dwordx4 a[92:95], v4, s[32:35], s61 offen offset:1024 sc1
    s_add_u32 s61, s30, 0x20000
    buffer_load_dwordx4 a[96:99], v4, s[32:35], s30 offen sc1
    buffer_load_dwordx4 a[100:103], v4, s[32:35], s30 offen offset:1024 sc1
    buffer_load_dwordx4 a[104:107], v4, s[32:35], s61 offen sc1
    buffer_load_dwordx4 a[108:111], v4, s[32:35], s61 offen offset:1024 sc1
    ds_read_b64_tr_b16 a[0:1], v6 offset:0
    ds_read_b64_tr_b16 a[2:3], v6 offset:512
    ds_read_b64_tr_b16 a[4:5], v7 offset:0
    ds_read_b64_tr_b16 a[6:7], v7 offset:512
    ds_read_b64_tr_b16 a[8:9], v6 offset:64
    ds_read_b64_tr_b16 a[10:11], v6 offset:576
    ds_read_b64_tr_b16 a[12:13], v7 offset:64
    ds_read_b64_tr_b16 a[14:15], v7 offset:576
    ds_read_b64_tr_b16 a[16:17], v6 offset:1024
    ds_read_b64_tr_b16 a[18:19], v6 offset:1536
    ds_read_b64_tr_b16 a[20:21], v7 offset:1024
    ds_read_b64_tr_b16 a[22:23], v7 offset:1536
    ds_read_b64_tr_b16 a[24:25], v6 offset:1088
    ds_read_b64_tr_b16 a[26:27], v6 offset:1600
    ds_read_b64_tr_b16 a[28:29], v7 offset:1088
    ds_read_b64_tr_b16 a[30:31], v7 offset:1600
    ds_read_b64_tr_b16 a[32:33], v6 offset:2048
    ds_read_b64_tr_b16 a[34:35], v6 offset:2560
    ds_read_b64_tr_b16 a[36:37], v7 offset:2048
    ds_read_b64_tr_b16 a[38:39], v7 offset:2560
    ds_read_b64_tr_b16 a[40:41], v6 offset:2112
    ds_read_b64_tr_b16 a[42:43], v6 offset:2624
    ds_read_b64_tr_b16 a[44:45], v7 offset:2112
    ds_read_b64_tr_b16 a[46:47], v7 offset:2624
    ds_read_b64_tr_b16 a[48:49], v13 offset:0
    ds_read_b64_tr_b16 a[50:51], v13 offset:1024
    ds_read_b64_tr_b16 a[52:53], v13 offset:32
    ds_read_b64_tr_b16 a[54:55], v13 offset:1056
    ds_read_b64_tr_b16 a[56:57], v13 offset:2048
    ds_read_b64_tr_b16 a[58:59], v13 offset:3072
    ds_read_b64_tr_b16 a[60:61], v13 offset:2080
    ds_read_b64_tr_b16 a[62:63], v13 offset:3104
    s_waitcnt vmcnt(10) lgkmcnt(0)
    s_waitcnt lgkmcnt(15)
    v_mfma_f32_16x16x32_bf16 v[160:163], a[0:3], a[64:67], 0
    v_mfma_f32_16x16x32_bf16 v[164:167], a[0:3], a[68:71], 0
    v_mfma_f32_16x16x32_bf16 v[172:175], a[4:7], a[68:71], 0
    ds_read_b64_tr_b16 a[0:1], v6 offset:12544
    v_mfma_f32_16x16x32_bf16 v[168:171], a[4:7], a[64:67], 0
    ds_read_b64_tr_b16 a[2:3], v6 offset:13056
    v_mfma_f32_16x16x32_bf16 v[176:179], a[8:11], a[64:67], 0
    ds_read_b64_tr_b16 a[4:5], v7 offset:12544
    v_mfma_f32_16x16x32_bf16 v[180:183], a[8:11], a[68:71], 0
    ds_read_b64_tr_b16 a[6:7], v7 offset:13056
    s_waitcnt lgkmcnt(15)
    v_mfma_f32_16x16x32_bf16 v[188:191], a[12:15], a[68:71], 0
    ds_read_b64_tr_b16 a[8:9], v6 offset:12608
    v_mfma_f32_16x16x32_bf16 v[184:187], a[12:15], a[64:67], 0
    ds_read_b64_tr_b16 a[10:11], v6 offset:13120
    v_mfma_f32_16x16x32_bf16 v[192:195], a[16:19], a[64:67], 0
    ds_read_b64_tr_b16 a[12:13], v7 offset:12608
    v_mfma_f32_16x16x32_bf16 v[196:199], a[16:19], a[68:71], 0
    ds_read_b64_tr_b16 a[14:15], v7 offset:13120
    v_mfma_f32_16x16x32_bf16 v[204:207], a[20:23], a[68:71], 0
    ds_read_b64_tr_b16 a[16:17], v6 offset:13568
    v_mfma_f32_16x16x32_bf16 v[200:203], a[20:23], a[64:67], 0
    ds_read_b64_tr_b16 a[18:19], v6 offset:14080
    s_waitcnt lgkmcnt(15)
    v_mfma_f32_16x16x32_bf16 v[208:211], a[24:27], a[64:67], 0
    ds_read_b64_tr_b16 a[20:21], v7 offset:13568
    v_mfma_f32_16x16x32_bf16 v[212:215], a[24:27], a[68:71], 0
    ds_read_b64_tr_b16 a[22:23], v7 offset:14080
    v_mfma_f32_16x16x32_bf16 v[220:223], a[28:31], a[68:71], 0
    ds_read_b64_tr_b16 a[24:25], v6 offset:13632
    v_mfma_f32_16x16x32_bf16 v[216:219], a[28:31], a[64:67], 0
    ds_read_b64_tr_b16 a[26:27], v6 offset:14144
    v_mfma_f32_16x16x32_bf16 v[224:227], a[32:35], a[64:67], 0
    ds_read_b64_tr_b16 a[28:29], v7 offset:13632
    v_mfma_f32_16x16x32_bf16 v[228:231], a[32:35], a[68:71], 0
    ds_read_b64_tr_b16 a[30:31], v7 offset:14144
    s_waitcnt lgkmcnt(15)
    v_mfma_f32_16x16x32_bf16 v[236:239], a[36:39], a[68:71], 0
    ds_read_b64_tr_b16 a[32:33], v6 offset:14592
    v_mfma_f32_16x16x32_bf16 v[232:235], a[36:39], a[64:67], 0
    ds_read_b64_tr_b16 a[34:35], v6 offset:15104
    v_mfma_f32_16x16x32_bf16 v[240:243], a[40:43], a[64:67], 0
    ds_read_b64_tr_b16 a[36:37], v7 offset:14592
    v_mfma_f32_16x16x32_bf16 v[244:247], a[40:43], a[68:71], 0
    ds_read_b64_tr_b16 a[38:39], v7 offset:15104
    v_mfma_f32_16x16x32_bf16 v[252:255], a[44:47], a[68:71], 0
    ds_read_b64_tr_b16 a[40:41], v6 offset:14656
    v_mfma_f32_16x16x32_bf16 v[248:251], a[44:47], a[64:67], 0
    ds_read_b64_tr_b16 a[42:43], v6 offset:15168
    s_waitcnt vmcnt(4)
    s_mov_b32 s57, 3
    .p2align 6
qloop_adaLN_cond__linear_kernel_hedgehog__glu_gated_swiglu__prompt_kernel_19:
    s_waitcnt lgkmcnt(15)
    v_mfma_f32_16x16x32_bf16 v[160:163], a[0:3], a[72:75], v[160:163]
    ds_read_b64_tr_b16 a[44:45], v7 offset:14656
    v_mfma_f32_16x16x32_bf16 v[164:167], a[0:3], a[76:79], v[164:167]
    ds_read_b64_tr_b16 a[46:47], v7 offset:15168
    s_waitcnt vmcnt(10)
    s_barrier
    v_mfma_f32_16x16x32_bf16 v[172:175], a[4:7], a[76:79], v[172:175]
    ds_read_b64_tr_b16 a[0:1], v6 offset:25088
    v_mfma_f32_16x16x32_bf16 v[168:171], a[4:7], a[72:75], v[168:171]
    ds_read_b64_tr_b16 a[2:3], v6 offset:25600
    s_add_u32 s61, s58, s59
    s_lshl_b32 s53, s61, 18
    s_mul_i32 s54, s61, 393216
    v_mfma_f32_16x16x32_bf16 v[176:179], a[8:11], a[72:75], v[176:179]
    ds_read_b64_tr_b16 a[4:5], v7 offset:25088
    v_mfma_f32_16x16x32_bf16 v[180:183], a[8:11], a[76:79], v[180:183]
    ds_read_b64_tr_b16 a[6:7], v7 offset:25600
    s_add_u32 s55, s53, 0x20000
    s_add_u32 s56, s54, 196608
    s_waitcnt lgkmcnt(15)
    v_mfma_f32_16x16x32_bf16 v[188:191], a[12:15], a[76:79], v[188:191]
    ds_read_b64_tr_b16 a[8:9], v6 offset:25152
    v_mfma_f32_16x16x32_bf16 v[184:187], a[12:15], a[72:75], v[184:187]
    ds_read_b64_tr_b16 a[10:11], v6 offset:25664
    s_add_u32 m0, s52, 75264
    v_mfma_f32_16x16x32_bf16 v[192:195], a[16:19], a[72:75], v[192:195]
    ds_read_b64_tr_b16 a[12:13], v7 offset:25152
    v_mfma_f32_16x16x32_bf16 v[196:199], a[16:19], a[76:79], v[196:199]
    ds_read_b64_tr_b16 a[14:15], v7 offset:25664
    buffer_load_dwordx4 a[112:115], v4, s[32:35], s53 offen sc1
    v_mfma_f32_16x16x32_bf16 v[204:207], a[20:23], a[76:79], v[204:207]
    ds_read_b64_tr_b16 a[16:17], v6 offset:26112
    v_mfma_f32_16x16x32_bf16 v[200:203], a[20:23], a[72:75], v[200:203]
    ds_read_b64_tr_b16 a[18:19], v6 offset:26624
    buffer_load_dwordx4 v5, s[36:39], s54 offen offset:0 lds
    s_waitcnt lgkmcnt(15)
    v_mfma_f32_16x16x32_bf16 v[208:211], a[24:27], a[72:75], v[208:211]
    ds_read_b64_tr_b16 a[20:21], v7 offset:26112
    v_mfma_f32_16x16x32_bf16 v[212:215], a[24:27], a[76:79], v[212:215]
    ds_read_b64_tr_b16 a[22:23], v7 offset:26624
    buffer_load_dwordx4 v5, s[40:43], s54 offen offset:1024 lds
    v_mfma_f32_16x16x32_bf16 v[220:223], a[28:31], a[76:79], v[220:223]
    ds_read_b64_tr_b16 a[24:25], v6 offset:26176
    v_mfma_f32_16x16x32_bf16 v[216:219], a[28:31], a[72:75], v[216:219]
    ds_read_b64_tr_b16 a[26:27], v6 offset:26688
    buffer_load_dwordx4 v5, s[44:47], s54 offen offset:2048 lds
    v_mfma_f32_16x16x32_bf16 v[224:227], a[32:35], a[72:75], v[224:227]
    ds_read_b64_tr_b16 a[28:29], v7 offset:26176
    v_mfma_f32_16x16x32_bf16 v[228:231], a[32:35], a[76:79], v[228:231]
    ds_read_b64_tr_b16 a[30:31], v7 offset:26688
    buffer_load_dwordx4 a[116:119], v4, s[32:35], s53 offen offset:1024 sc1
    s_waitcnt lgkmcnt(15)
    v_mfma_f32_16x16x32_bf16 v[236:239], a[36:39], a[76:79], v[236:239]
    ds_read_b64_tr_b16 a[32:33], v6 offset:27136
    v_mfma_f32_16x16x32_bf16 v[232:235], a[36:39], a[72:75], v[232:235]
    ds_read_b64_tr_b16 a[34:35], v6 offset:27648
    s_add_u32 s59, s59, 1
    s_and_b32 s59, s59, 3
    v_mfma_f32_16x16x32_bf16 v[240:243], a[40:43], a[72:75], v[240:243]
    ds_read_b64_tr_b16 a[36:37], v7 offset:27136
    s_cmp_eq_u32 s59, s60
    s_cselect_b32 s61, 4, 0
    s_add_u32 s58, s58, s61
    v_mfma_f32_16x16x32_bf16 v[244:247], a[40:43], a[76:79], v[244:247]
    ds_read_b64_tr_b16 a[38:39], v7 offset:27648
    v_mfma_f32_16x16x32_bf16 v[252:255], a[44:47], a[76:79], v[252:255]
    ds_read_b64_tr_b16 a[40:41], v6 offset:27200
    v_mfma_f32_16x16x32_bf16 v[248:251], a[44:47], a[72:75], v[248:251]
    ds_read_b64_tr_b16 a[42:43], v6 offset:27712
    s_waitcnt lgkmcnt(15)
    v_mfma_f32_16x16x32_bf16 v[160:163], a[0:3], a[80:83], v[160:163]
    ds_read_b64_tr_b16 a[44:45], v7 offset:27200
    v_mfma_f32_16x16x32_bf16 v[164:167], a[0:3], a[84:87], v[164:167]
    ds_read_b64_tr_b16 a[46:47], v7 offset:27712
    s_add_u32 m0, s52, 87808
    v_mfma_f32_16x16x32_bf16 v[172:175], a[4:7], a[84:87], v[172:175]
    ds_read_b64_tr_b16 a[0:1], v6 offset:37632
    v_mfma_f32_16x16x32_bf16 v[168:171], a[4:7], a[80:83], v[168:171]
    ds_read_b64_tr_b16 a[2:3], v6 offset:38144
    buffer_load_dwordx4 a[120:123], v4, s[32:35], s55 offen sc1
    v_mfma_f32_16x16x32_bf16 v[176:179], a[8:11], a[80:83], v[176:179]
    ds_read_b64_tr_b16 a[4:5], v7 offset:37632
    v_mfma_f32_16x16x32_bf16 v[180:183], a[8:11], a[84:87], v[180:183]
    ds_read_b64_tr_b16 a[6:7], v7 offset:38144
    buffer_load_dwordx4 v5, s[36:39], s56 offen offset:0 lds
    s_waitcnt lgkmcnt(15)
    v_mfma_f32_16x16x32_bf16 v[188:191], a[12:15], a[84:87], v[188:191]
    ds_read_b64_tr_b16 a[8:9], v6 offset:37696
    v_mfma_f32_16x16x32_bf16 v[184:187], a[12:15], a[80:83], v[184:187]
    ds_read_b64_tr_b16 a[10:11], v6 offset:38208
    buffer_load_dwordx4 v5, s[40:43], s56 offen offset:1024 lds
    v_mfma_f32_16x16x32_bf16 v[192:195], a[16:19], a[80:83], v[192:195]
    ds_read_b64_tr_b16 a[12:13], v7 offset:37696
    v_mfma_f32_16x16x32_bf16 v[196:199], a[16:19], a[84:87], v[196:199]
    ds_read_b64_tr_b16 a[14:15], v7 offset:38208
    buffer_load_dwordx4 v5, s[44:47], s56 offen offset:2048 lds
    v_mfma_f32_16x16x32_bf16 v[204:207], a[20:23], a[84:87], v[204:207]
    ds_read_b64_tr_b16 a[16:17], v6 offset:38656
    v_mfma_f32_16x16x32_bf16 v[200:203], a[20:23], a[80:83], v[200:203]
    ds_read_b64_tr_b16 a[18:19], v6 offset:39168
    buffer_load_dwordx4 a[124:127], v4, s[32:35], s55 offen offset:1024 sc1
    s_waitcnt lgkmcnt(15)
    v_mfma_f32_16x16x32_bf16 v[208:211], a[24:27], a[80:83], v[208:211]
    ds_read_b64_tr_b16 a[20:21], v7 offset:38656
    v_mfma_f32_16x16x32_bf16 v[212:215], a[24:27], a[84:87], v[212:215]
    ds_read_b64_tr_b16 a[22:23], v7 offset:39168
    v_mfma_f32_16x16x32_bf16 v[220:223], a[28:31], a[84:87], v[220:223]
    ds_read_b64_tr_b16 a[24:25], v6 offset:38720
    v_mfma_f32_16x16x32_bf16 v[216:219], a[28:31], a[80:83], v[216:219]
    ds_read_b64_tr_b16 a[26:27], v6 offset:39232
    v_mfma_f32_16x16x32_bf16 v[224:227], a[32:35], a[80:83], v[224:227]
    ds_read_b64_tr_b16 a[28:29], v7 offset:38720
    v_mfma_f32_16x16x32_bf16 v[228:231], a[32:35], a[84:87], v[228:231]
    ds_read_b64_tr_b16 a[30:31], v7 offset:39232
    s_waitcnt lgkmcnt(15)
    v_mfma_f32_16x16x32_bf16 v[236:239], a[36:39], a[84:87], v[236:239]
    ds_read_b64_tr_b16 a[32:33], v6 offset:39680
    v_mfma_f32_16x16x32_bf16 v[232:235], a[36:39], a[80:83], v[232:235]
    ds_read_b64_tr_b16 a[34:35], v6 offset:40192
    v_mfma_f32_16x16x32_bf16 v[240:243], a[40:43], a[80:83], v[240:243]
    ds_read_b64_tr_b16 a[36:37], v7 offset:39680
    v_mfma_f32_16x16x32_bf16 v[244:247], a[40:43], a[84:87], v[244:247]
    ds_read_b64_tr_b16 a[38:39], v7 offset:40192
    v_mfma_f32_16x16x32_bf16 v[252:255], a[44:47], a[84:87], v[252:255]
    ds_read_b64_tr_b16 a[40:41], v6 offset:39744
    v_mfma_f32_16x16x32_bf16 v[248:251], a[44:47], a[80:83], v[248:251]
    ds_read_b64_tr_b16 a[42:43], v6 offset:40256
    s_waitcnt lgkmcnt(15)
    v_mfma_f32_16x16x32_bf16 v[160:163], a[0:3], a[88:91], v[160:163]
    ds_read_b64_tr_b16 a[44:45], v7 offset:39744
    v_mfma_f32_16x16x32_bf16 v[164:167], a[0:3], a[92:95], v[164:167]
    ds_read_b64_tr_b16 a[46:47], v7 offset:40256
    s_waitcnt vmcnt(10)
    s_barrier
    v_mfma_f32_16x16x32_bf16 v[172:175], a[4:7], a[92:95], v[172:175]
    ds_read_b64_tr_b16 a[0:1], v8 offset:0
    v_mfma_f32_16x16x32_bf16 v[168:171], a[4:7], a[88:91], v[168:171]
    ds_read_b64_tr_b16 a[2:3], v8 offset:512
    s_add_u32 s61, s58, s59
    s_lshl_b32 s53, s61, 18
    s_mul_i32 s54, s61, 393216
    v_mfma_f32_16x16x32_bf16 v[176:179], a[8:11], a[88:91], v[176:179]
    ds_read_b64_tr_b16 a[4:5], v9 offset:0
    v_mfma_f32_16x16x32_bf16 v[180:183], a[8:11], a[92:95], v[180:183]
    ds_read_b64_tr_b16 a[6:7], v9 offset:512
    s_add_u32 s55, s53, 0x20000
    s_add_u32 s56, s54, 196608
    s_waitcnt lgkmcnt(15)
    v_mfma_f32_16x16x32_bf16 v[188:191], a[12:15], a[92:95], v[188:191]
    ds_read_b64_tr_b16 a[8:9], v8 offset:64
    v_mfma_f32_16x16x32_bf16 v[184:187], a[12:15], a[88:91], v[184:187]
    ds_read_b64_tr_b16 a[10:11], v8 offset:576
    s_add_u32 m0, s52, 0
    v_mfma_f32_16x16x32_bf16 v[192:195], a[16:19], a[88:91], v[192:195]
    ds_read_b64_tr_b16 a[12:13], v9 offset:64
    v_mfma_f32_16x16x32_bf16 v[196:199], a[16:19], a[92:95], v[196:199]
    ds_read_b64_tr_b16 a[14:15], v9 offset:576
    buffer_load_dwordx4 a[64:67], v4, s[32:35], s53 offen sc1
    v_mfma_f32_16x16x32_bf16 v[204:207], a[20:23], a[92:95], v[204:207]
    ds_read_b64_tr_b16 a[16:17], v8 offset:1024
    v_mfma_f32_16x16x32_bf16 v[200:203], a[20:23], a[88:91], v[200:203]
    ds_read_b64_tr_b16 a[18:19], v8 offset:1536
    buffer_load_dwordx4 v5, s[36:39], s54 offen offset:0 lds
    s_waitcnt lgkmcnt(15)
    v_mfma_f32_16x16x32_bf16 v[208:211], a[24:27], a[88:91], v[208:211]
    ds_read_b64_tr_b16 a[20:21], v9 offset:1024
    v_mfma_f32_16x16x32_bf16 v[212:215], a[24:27], a[92:95], v[212:215]
    ds_read_b64_tr_b16 a[22:23], v9 offset:1536
    buffer_load_dwordx4 v5, s[40:43], s54 offen offset:1024 lds
    v_mfma_f32_16x16x32_bf16 v[220:223], a[28:31], a[92:95], v[220:223]
    ds_read_b64_tr_b16 a[24:25], v8 offset:1088
    v_mfma_f32_16x16x32_bf16 v[216:219], a[28:31], a[88:91], v[216:219]
    ds_read_b64_tr_b16 a[26:27], v8 offset:1600
    buffer_load_dwordx4 v5, s[44:47], s54 offen offset:2048 lds
    v_mfma_f32_16x16x32_bf16 v[224:227], a[32:35], a[88:91], v[224:227]
    ds_read_b64_tr_b16 a[28:29], v9 offset:1088
    v_mfma_f32_16x16x32_bf16 v[228:231], a[32:35], a[92:95], v[228:231]
    ds_read_b64_tr_b16 a[30:31], v9 offset:1600
    buffer_load_dwordx4 a[68:71], v4, s[32:35], s53 offen offset:1024 sc1
    s_waitcnt lgkmcnt(15)
    v_mfma_f32_16x16x32_bf16 v[236:239], a[36:39], a[92:95], v[236:239]
    ds_read_b64_tr_b16 a[32:33], v8 offset:2048
    v_mfma_f32_16x16x32_bf16 v[232:235], a[36:39], a[88:91], v[232:235]
    ds_read_b64_tr_b16 a[34:35], v8 offset:2560
    s_add_u32 s59, s59, 1
    s_and_b32 s59, s59, 3
    v_mfma_f32_16x16x32_bf16 v[240:243], a[40:43], a[88:91], v[240:243]
    ds_read_b64_tr_b16 a[36:37], v9 offset:2048
    s_cmp_eq_u32 s59, s60
    s_cselect_b32 s61, 4, 0
    s_add_u32 s58, s58, s61
    v_mfma_f32_16x16x32_bf16 v[244:247], a[40:43], a[92:95], v[244:247]
    ds_read_b64_tr_b16 a[38:39], v9 offset:2560
    v_mfma_f32_16x16x32_bf16 v[252:255], a[44:47], a[92:95], v[252:255]
    ds_read_b64_tr_b16 a[40:41], v8 offset:2112
    v_mfma_f32_16x16x32_bf16 v[248:251], a[44:47], a[88:91], v[248:251]
    ds_read_b64_tr_b16 a[42:43], v8 offset:2624
    s_waitcnt lgkmcnt(15)
    v_mfma_f32_16x16x32_bf16 v[160:163], a[0:3], a[96:99], v[160:163]
    ds_read_b64_tr_b16 a[44:45], v9 offset:2112
    v_mfma_f32_16x16x32_bf16 v[164:167], a[0:3], a[100:103], v[164:167]
    ds_read_b64_tr_b16 a[46:47], v9 offset:2624
    s_add_u32 m0, s52, 12544
    v_mfma_f32_16x16x32_bf16 v[172:175], a[4:7], a[100:103], v[172:175]
    ds_read_b64_tr_b16 a[0:1], v8 offset:12544
    v_mfma_f32_16x16x32_bf16 v[168:171], a[4:7], a[96:99], v[168:171]
    ds_read_b64_tr_b16 a[2:3], v8 offset:13056
    buffer_load_dwordx4 a[72:75], v4, s[32:35], s55 offen sc1
    v_mfma_f32_16x16x32_bf16 v[176:179], a[8:11], a[96:99], v[176:179]
    ds_read_b64_tr_b16 a[4:5], v9 offset:12544
    v_mfma_f32_16x16x32_bf16 v[180:183], a[8:11], a[100:103], v[180:183]
    ds_read_b64_tr_b16 a[6:7], v9 offset:13056
    buffer_load_dwordx4 v5, s[36:39], s56 offen offset:0 lds
    s_waitcnt lgkmcnt(15)
    v_mfma_f32_16x16x32_bf16 v[188:191], a[12:15], a[100:103], v[188:191]
    ds_read_b64_tr_b16 a[8:9], v8 offset:12608
    v_mfma_f32_16x16x32_bf16 v[184:187], a[12:15], a[96:99], v[184:187]
    ds_read_b64_tr_b16 a[10:11], v8 offset:13120
    buffer_load_dwordx4 v5, s[40:43], s56 offen offset:1024 lds
    v_mfma_f32_16x16x32_bf16 v[192:195], a[16:19], a[96:99], v[192:195]
    ds_read_b64_tr_b16 a[12:13], v9 offset:12608
    v_mfma_f32_16x16x32_bf16 v[196:199], a[16:19], a[100:103], v[196:199]
    ds_read_b64_tr_b16 a[14:15], v9 offset:13120
    buffer_load_dwordx4 v5, s[44:47], s56 offen offset:2048 lds
    v_mfma_f32_16x16x32_bf16 v[204:207], a[20:23], a[100:103], v[204:207]
    ds_read_b64_tr_b16 a[16:17], v8 offset:13568
    v_mfma_f32_16x16x32_bf16 v[200:203], a[20:23], a[96:99], v[200:203]
    ds_read_b64_tr_b16 a[18:19], v8 offset:14080
    buffer_load_dwordx4 a[76:79], v4, s[32:35], s55 offen offset:1024 sc1
    s_waitcnt lgkmcnt(15)
    v_mfma_f32_16x16x32_bf16 v[208:211], a[24:27], a[96:99], v[208:211]
    ds_read_b64_tr_b16 a[20:21], v9 offset:13568
    v_mfma_f32_16x16x32_bf16 v[212:215], a[24:27], a[100:103], v[212:215]
    ds_read_b64_tr_b16 a[22:23], v9 offset:14080
    v_mfma_f32_16x16x32_bf16 v[220:223], a[28:31], a[100:103], v[220:223]
    ds_read_b64_tr_b16 a[24:25], v8 offset:13632
    v_mfma_f32_16x16x32_bf16 v[216:219], a[28:31], a[96:99], v[216:219]
    ds_read_b64_tr_b16 a[26:27], v8 offset:14144
    v_mfma_f32_16x16x32_bf16 v[224:227], a[32:35], a[96:99], v[224:227]
    ds_read_b64_tr_b16 a[28:29], v9 offset:13632
    v_mfma_f32_16x16x32_bf16 v[228:231], a[32:35], a[100:103], v[228:231]
    ds_read_b64_tr_b16 a[30:31], v9 offset:14144
    s_waitcnt lgkmcnt(15)
    v_mfma_f32_16x16x32_bf16 v[236:239], a[36:39], a[100:103], v[236:239]
    ds_read_b64_tr_b16 a[32:33], v8 offset:14592
    v_mfma_f32_16x16x32_bf16 v[232:235], a[36:39], a[96:99], v[232:235]
    ds_read_b64_tr_b16 a[34:35], v8 offset:15104
    v_mfma_f32_16x16x32_bf16 v[240:243], a[40:43], a[96:99], v[240:243]
    ds_read_b64_tr_b16 a[36:37], v9 offset:14592
    v_mfma_f32_16x16x32_bf16 v[244:247], a[40:43], a[100:103], v[244:247]
    ds_read_b64_tr_b16 a[38:39], v9 offset:15104
    v_mfma_f32_16x16x32_bf16 v[252:255], a[44:47], a[100:103], v[252:255]
    ds_read_b64_tr_b16 a[40:41], v8 offset:14656
    v_mfma_f32_16x16x32_bf16 v[248:251], a[44:47], a[96:99], v[248:251]
    ds_read_b64_tr_b16 a[42:43], v8 offset:15168
    s_waitcnt lgkmcnt(15)
    v_mfma_f32_16x16x32_bf16 v[160:163], a[0:3], a[104:107], v[160:163]
    ds_read_b64_tr_b16 a[44:45], v9 offset:14656
    v_mfma_f32_16x16x32_bf16 v[164:167], a[0:3], a[108:111], v[164:167]
    ds_read_b64_tr_b16 a[46:47], v9 offset:15168
    s_waitcnt vmcnt(10)
    s_barrier
    v_mfma_f32_16x16x32_bf16 v[172:175], a[4:7], a[108:111], v[172:175]
    ds_read_b64_tr_b16 a[0:1], v8 offset:25088
    v_mfma_f32_16x16x32_bf16 v[168:171], a[4:7], a[104:107], v[168:171]
    ds_read_b64_tr_b16 a[2:3], v8 offset:25600
    s_add_u32 s61, s58, s59
    s_lshl_b32 s53, s61, 18
    s_mul_i32 s54, s61, 393216
    v_mfma_f32_16x16x32_bf16 v[176:179], a[8:11], a[104:107], v[176:179]
    ds_read_b64_tr_b16 a[4:5], v9 offset:25088
    v_mfma_f32_16x16x32_bf16 v[180:183], a[8:11], a[108:111], v[180:183]
    ds_read_b64_tr_b16 a[6:7], v9 offset:25600
    s_add_u32 s55, s53, 0x20000
    s_add_u32 s56, s54, 196608
    s_waitcnt lgkmcnt(15)
    v_mfma_f32_16x16x32_bf16 v[188:191], a[12:15], a[108:111], v[188:191]
    ds_read_b64_tr_b16 a[8:9], v8 offset:25152
    v_mfma_f32_16x16x32_bf16 v[184:187], a[12:15], a[104:107], v[184:187]
    ds_read_b64_tr_b16 a[10:11], v8 offset:25664
    s_add_u32 m0, s52, 25088
    v_mfma_f32_16x16x32_bf16 v[192:195], a[16:19], a[104:107], v[192:195]
    ds_read_b64_tr_b16 a[12:13], v9 offset:25152
    v_mfma_f32_16x16x32_bf16 v[196:199], a[16:19], a[108:111], v[196:199]
    ds_read_b64_tr_b16 a[14:15], v9 offset:25664
    buffer_load_dwordx4 a[80:83], v4, s[32:35], s53 offen sc1
    v_mfma_f32_16x16x32_bf16 v[204:207], a[20:23], a[108:111], v[204:207]
    ds_read_b64_tr_b16 a[16:17], v8 offset:26112
    v_mfma_f32_16x16x32_bf16 v[200:203], a[20:23], a[104:107], v[200:203]
    ds_read_b64_tr_b16 a[18:19], v8 offset:26624
    buffer_load_dwordx4 v5, s[36:39], s54 offen offset:0 lds
    s_waitcnt lgkmcnt(15)
    v_mfma_f32_16x16x32_bf16 v[208:211], a[24:27], a[104:107], v[208:211]
    ds_read_b64_tr_b16 a[20:21], v9 offset:26112
    v_mfma_f32_16x16x32_bf16 v[212:215], a[24:27], a[108:111], v[212:215]
    ds_read_b64_tr_b16 a[22:23], v9 offset:26624
    buffer_load_dwordx4 v5, s[40:43], s54 offen offset:1024 lds
    v_mfma_f32_16x16x32_bf16 v[220:223], a[28:31], a[108:111], v[220:223]
    ds_read_b64_tr_b16 a[24:25], v8 offset:26176
    v_mfma_f32_16x16x32_bf16 v[216:219], a[28:31], a[104:107], v[216:219]
    ds_read_b64_tr_b16 a[26:27], v8 offset:26688
    buffer_load_dwordx4 v5, s[44:47], s54 offen offset:2048 lds
    v_mfma_f32_16x16x32_bf16 v[224:227], a[32:35], a[104:107], v[224:227]
    ds_read_b64_tr_b16 a[28:29], v9 offset:26176
    v_mfma_f32_16x16x32_bf16 v[228:231], a[32:35], a[108:111], v[228:231]
    ds_read_b64_tr_b16 a[30:31], v9 offset:26688
    buffer_load_dwordx4 a[84:87], v4, s[32:35], s53 offen offset:1024 sc1
    s_waitcnt lgkmcnt(15)
    v_mfma_f32_16x16x32_bf16 v[236:239], a[36:39], a[108:111], v[236:239]
    ds_read_b64_tr_b16 a[32:33], v8 offset:27136
    v_mfma_f32_16x16x32_bf16 v[232:235], a[36:39], a[104:107], v[232:235]
    ds_read_b64_tr_b16 a[34:35], v8 offset:27648
    s_add_u32 s59, s59, 1
    s_and_b32 s59, s59, 3
    v_mfma_f32_16x16x32_bf16 v[240:243], a[40:43], a[104:107], v[240:243]
    ds_read_b64_tr_b16 a[36:37], v9 offset:27136
    s_cmp_eq_u32 s59, s60
    s_cselect_b32 s61, 4, 0
    s_add_u32 s58, s58, s61
    v_mfma_f32_16x16x32_bf16 v[244:247], a[40:43], a[108:111], v[244:247]
    ds_read_b64_tr_b16 a[38:39], v9 offset:27648
    v_mfma_f32_16x16x32_bf16 v[252:255], a[44:47], a[108:111], v[252:255]
    ds_read_b64_tr_b16 a[40:41], v8 offset:27200
    v_mfma_f32_16x16x32_bf16 v[248:251], a[44:47], a[104:107], v[248:251]
    ds_read_b64_tr_b16 a[42:43], v8 offset:27712
    s_waitcnt lgkmcnt(15)
    v_mfma_f32_16x16x32_bf16 v[160:163], a[0:3], a[112:115], v[160:163]
    ds_read_b64_tr_b16 a[44:45], v9 offset:27200
    v_mfma_f32_16x16x32_bf16 v[164:167], a[0:3], a[116:119], v[164:167]
    ds_read_b64_tr_b16 a[46:47], v9 offset:27712
    s_add_u32 m0, s52, 37632
    v_mfma_f32_16x16x32_bf16 v[172:175], a[4:7], a[116:119], v[172:175]
    ds_read_b64_tr_b16 a[0:1], v8 offset:37632
    v_mfma_f32_16x16x32_bf16 v[168:171], a[4:7], a[112:115], v[168:171]
    ds_read_b64_tr_b16 a[2:3], v8 offset:38144
    buffer_load_dwordx4 a[88:91], v4, s[32:35], s55 offen sc1
    v_mfma_f32_16x16x32_bf16 v[176:179], a[8:11], a[112:115], v[176:179]
    ds_read_b64_tr_b16 a[4:5], v9 offset:37632
    v_mfma_f32_16x16x32_bf16 v[180:183], a[8:11], a[116:119], v[180:183]
    ds_read_b64_tr_b16 a[6:7], v9 offset:38144
    buffer_load_dwordx4 v5, s[36:39], s56 offen offset:0 lds
    s_waitcnt lgkmcnt(15)
    v_mfma_f32_16x16x32_bf16 v[188:191], a[12:15], a[116:119], v[188:191]
    ds_read_b64_tr_b16 a[8:9], v8 offset:37696
    v_mfma_f32_16x16x32_bf16 v[184:187], a[12:15], a[112:115], v[184:187]
    ds_read_b64_tr_b16 a[10:11], v8 offset:38208
    buffer_load_dwordx4 v5, s[40:43], s56 offen offset:1024 lds
    v_mfma_f32_16x16x32_bf16 v[192:195], a[16:19], a[112:115], v[192:195]
    ds_read_b64_tr_b16 a[12:13], v9 offset:37696
    v_mfma_f32_16x16x32_bf16 v[196:199], a[16:19], a[116:119], v[196:199]
    ds_read_b64_tr_b16 a[14:15], v9 offset:38208
    buffer_load_dwordx4 v5, s[44:47], s56 offen offset:2048 lds
    v_mfma_f32_16x16x32_bf16 v[204:207], a[20:23], a[116:119], v[204:207]
    ds_read_b64_tr_b16 a[16:17], v8 offset:38656
    v_mfma_f32_16x16x32_bf16 v[200:203], a[20:23], a[112:115], v[200:203]
    ds_read_b64_tr_b16 a[18:19], v8 offset:39168
    buffer_load_dwordx4 a[92:95], v4, s[32:35], s55 offen offset:1024 sc1
    s_waitcnt lgkmcnt(15)
    v_mfma_f32_16x16x32_bf16 v[208:211], a[24:27], a[112:115], v[208:211]
    ds_read_b64_tr_b16 a[20:21], v9 offset:38656
    v_mfma_f32_16x16x32_bf16 v[212:215], a[24:27], a[116:119], v[212:215]
    ds_read_b64_tr_b16 a[22:23], v9 offset:39168
    v_mfma_f32_16x16x32_bf16 v[220:223], a[28:31], a[116:119], v[220:223]
    ds_read_b64_tr_b16 a[24:25], v8 offset:38720
    v_mfma_f32_16x16x32_bf16 v[216:219], a[28:31], a[112:115], v[216:219]
    ds_read_b64_tr_b16 a[26:27], v8 offset:39232
    v_mfma_f32_16x16x32_bf16 v[224:227], a[32:35], a[112:115], v[224:227]
    ds_read_b64_tr_b16 a[28:29], v9 offset:38720
    v_mfma_f32_16x16x32_bf16 v[228:231], a[32:35], a[116:119], v[228:231]
    ds_read_b64_tr_b16 a[30:31], v9 offset:39232
    s_waitcnt lgkmcnt(15)
    v_mfma_f32_16x16x32_bf16 v[236:239], a[36:39], a[116:119], v[236:239]
    ds_read_b64_tr_b16 a[32:33], v8 offset:39680
    v_mfma_f32_16x16x32_bf16 v[232:235], a[36:39], a[112:115], v[232:235]
    ds_read_b64_tr_b16 a[34:35], v8 offset:40192
    v_mfma_f32_16x16x32_bf16 v[240:243], a[40:43], a[112:115], v[240:243]
    ds_read_b64_tr_b16 a[36:37], v9 offset:39680
    v_mfma_f32_16x16x32_bf16 v[244:247], a[40:43], a[116:119], v[244:247]
    ds_read_b64_tr_b16 a[38:39], v9 offset:40192
    v_mfma_f32_16x16x32_bf16 v[252:255], a[44:47], a[116:119], v[252:255]
    ds_read_b64_tr_b16 a[40:41], v8 offset:39744
    v_mfma_f32_16x16x32_bf16 v[248:251], a[44:47], a[112:115], v[248:251]
    ds_read_b64_tr_b16 a[42:43], v8 offset:40256
    s_waitcnt lgkmcnt(15)
    v_mfma_f32_16x16x32_bf16 v[160:163], a[0:3], a[120:123], v[160:163]
    ds_read_b64_tr_b16 a[44:45], v9 offset:39744
    v_mfma_f32_16x16x32_bf16 v[164:167], a[0:3], a[124:127], v[164:167]
    ds_read_b64_tr_b16 a[46:47], v9 offset:40256
    s_waitcnt vmcnt(10)
    s_barrier
    v_mfma_f32_16x16x32_bf16 v[172:175], a[4:7], a[124:127], v[172:175]
    ds_read_b64_tr_b16 a[0:1], v6 offset:0
    v_mfma_f32_16x16x32_bf16 v[168:171], a[4:7], a[120:123], v[168:171]
    ds_read_b64_tr_b16 a[2:3], v6 offset:512
    s_add_u32 s61, s58, s59
    s_lshl_b32 s53, s61, 18
    s_mul_i32 s54, s61, 393216
    v_mfma_f32_16x16x32_bf16 v[176:179], a[8:11], a[120:123], v[176:179]
    ds_read_b64_tr_b16 a[4:5], v7 offset:0
    v_mfma_f32_16x16x32_bf16 v[180:183], a[8:11], a[124:127], v[180:183]
    ds_read_b64_tr_b16 a[6:7], v7 offset:512
    s_add_u32 s55, s53, 0x20000
    s_add_u32 s56, s54, 196608
    s_waitcnt lgkmcnt(15)
    v_mfma_f32_16x16x32_bf16 v[188:191], a[12:15], a[124:127], v[188:191]
    ds_read_b64_tr_b16 a[8:9], v6 offset:64
    v_mfma_f32_16x16x32_bf16 v[184:187], a[12:15], a[120:123], v[184:187]
    ds_read_b64_tr_b16 a[10:11], v6 offset:576
    s_add_u32 m0, s52, 50176
    v_mfma_f32_16x16x32_bf16 v[192:195], a[16:19], a[120:123], v[192:195]
    ds_read_b64_tr_b16 a[12:13], v7 offset:64
    v_mfma_f32_16x16x32_bf16 v[196:199], a[16:19], a[124:127], v[196:199]
    ds_read_b64_tr_b16 a[14:15], v7 offset:576
    buffer_load_dwordx4 a[96:99], v4, s[32:35], s53 offen sc1
    v_mfma_f32_16x16x32_bf16 v[204:207], a[20:23], a[124:127], v[204:207]
    ds_read_b64_tr_b16 a[16:17], v6 offset:1024
    v_mfma_f32_16x16x32_bf16 v[200:203], a[20:23], a[120:123], v[200:203]
    ds_read_b64_tr_b16 a[18:19], v6 offset:1536
    buffer_load_dwordx4 v5, s[36:39], s54 offen offset:0 lds
    s_waitcnt lgkmcnt(15)
    v_mfma_f32_16x16x32_bf16 v[208:211], a[24:27], a[120:123], v[208:211]
    ds_read_b64_tr_b16 a[20:21], v7 offset:1024
    v_mfma_f32_16x16x32_bf16 v[212:215], a[24:27], a[124:127], v[212:215]
    ds_read_b64_tr_b16 a[22:23], v7 offset:1536
    buffer_load_dwordx4 v5, s[40:43], s54 offen offset:1024 lds
    v_mfma_f32_16x16x32_bf16 v[220:223], a[28:31], a[124:127], v[220:223]
    ds_read_b64_tr_b16 a[24:25], v6 offset:1088
    v_mfma_f32_16x16x32_bf16 v[216:219], a[28:31], a[120:123], v[216:219]
    ds_read_b64_tr_b16 a[26:27], v6 offset:1600
    buffer_load_dwordx4 v5, s[44:47], s54 offen offset:2048 lds
    v_mfma_f32_16x16x32_bf16 v[224:227], a[32:35], a[120:123], v[224:227]
    ds_read_b64_tr_b16 a[28:29], v7 offset:1088
    v_mfma_f32_16x16x32_bf16 v[228:231], a[32:35], a[124:127], v[228:231]
    ds_read_b64_tr_b16 a[30:31], v7 offset:1600
    buffer_load_dwordx4 a[100:103], v4, s[32:35], s53 offen offset:1024 sc1
    s_waitcnt lgkmcnt(15)
    v_mfma_f32_16x16x32_bf16 v[236:239], a[36:39], a[124:127], v[236:239]
    ds_read_b64_tr_b16 a[32:33], v6 offset:2048
    v_mfma_f32_16x16x32_bf16 v[232:235], a[36:39], a[120:123], v[232:235]
    ds_read_b64_tr_b16 a[34:35], v6 offset:2560
    s_add_u32 s59, s59, 1
    s_and_b32 s59, s59, 3
    v_mfma_f32_16x16x32_bf16 v[240:243], a[40:43], a[120:123], v[240:243]
    ds_read_b64_tr_b16 a[36:37], v7 offset:2048
    s_cmp_eq_u32 s59, s60
    s_cselect_b32 s61, 4, 0
    s_add_u32 s58, s58, s61
    v_mfma_f32_16x16x32_bf16 v[244:247], a[40:43], a[124:127], v[244:247]
    ds_read_b64_tr_b16 a[38:39], v7 offset:2560
    v_mfma_f32_16x16x32_bf16 v[252:255], a[44:47], a[124:127], v[252:255]
    ds_read_b64_tr_b16 a[40:41], v6 offset:2112
    v_mfma_f32_16x16x32_bf16 v[248:251], a[44:47], a[120:123], v[248:251]
    ds_read_b64_tr_b16 a[42:43], v6 offset:2624
    s_waitcnt lgkmcnt(15)
    v_mfma_f32_16x16x32_bf16 v[160:163], a[0:3], a[64:67], v[160:163]
    ds_read_b64_tr_b16 a[44:45], v7 offset:2112
    v_mfma_f32_16x16x32_bf16 v[164:167], a[0:3], a[68:71], v[164:167]
    ds_read_b64_tr_b16 a[46:47], v7 offset:2624
    s_add_u32 m0, s52, 62720
    v_mfma_f32_16x16x32_bf16 v[172:175], a[4:7], a[68:71], v[172:175]
    ds_read_b64_tr_b16 a[0:1], v6 offset:12544
    v_mfma_f32_16x16x32_bf16 v[168:171], a[4:7], a[64:67], v[168:171]
    ds_read_b64_tr_b16 a[2:3], v6 offset:13056
    buffer_load_dwordx4 a[104:107], v4, s[32:35], s55 offen sc1
    v_mfma_f32_16x16x32_bf16 v[176:179], a[8:11], a[64:67], v[176:179]
    ds_read_b64_tr_b16 a[4:5], v7 offset:12544
    v_mfma_f32_16x16x32_bf16 v[180:183], a[8:11], a[68:71], v[180:183]
    ds_read_b64_tr_b16 a[6:7], v7 offset:13056
    buffer_load_dwordx4 v5, s[36:39], s56 offen offset:0 lds
    s_waitcnt lgkmcnt(15)
    v_mfma_f32_16x16x32_bf16 v[188:191], a[12:15], a[68:71], v[188:191]
    ds_read_b64_tr_b16 a[8:9], v6 offset:12608
    v_mfma_f32_16x16x32_bf16 v[184:187], a[12:15], a[64:67], v[184:187]
    ds_read_b64_tr_b16 a[10:11], v6 offset:13120
    buffer_load_dwordx4 v5, s[40:43], s56 offen offset:1024 lds
    v_mfma_f32_16x16x32_bf16 v[192:195], a[16:19], a[64:67], v[192:195]
    ds_read_b64_tr_b16 a[12:13], v7 offset:12608
    v_mfma_f32_16x16x32_bf16 v[196:199], a[16:19], a[68:71], v[196:199]
    ds_read_b64_tr_b16 a[14:15], v7 offset:13120
    buffer_load_dwordx4 v5, s[44:47], s56 offen offset:2048 lds
    v_mfma_f32_16x16x32_bf16 v[204:207], a[20:23], a[68:71], v[204:207]
    ds_read_b64_tr_b16 a[16:17], v6 offset:13568
    v_mfma_f32_16x16x32_bf16 v[200:203], a[20:23], a[64:67], v[200:203]
    ds_read_b64_tr_b16 a[18:19], v6 offset:14080
    buffer_load_dwordx4 a[108:111], v4, s[32:35], s55 offen offset:1024 sc1
    s_waitcnt lgkmcnt(15)
    v_mfma_f32_16x16x32_bf16 v[208:211], a[24:27], a[64:67], v[208:211]
    ds_read_b64_tr_b16 a[20:21], v7 offset:13568
    v_mfma_f32_16x16x32_bf16 v[212:215], a[24:27], a[68:71], v[212:215]
    ds_read_b64_tr_b16 a[22:23], v7 offset:14080
    s_sub_u32 s57, s57, 1
    s_cmp_lg_u32 s57, 0
    v_mfma_f32_16x16x32_bf16 v[220:223], a[28:31], a[68:71], v[220:223]
    ds_read_b64_tr_b16 a[24:25], v6 offset:13632
    v_mfma_f32_16x16x32_bf16 v[216:219], a[28:31], a[64:67], v[216:219]
    ds_read_b64_tr_b16 a[26:27], v6 offset:14144
    v_mfma_f32_16x16x32_bf16 v[224:227], a[32:35], a[64:67], v[224:227]
    ds_read_b64_tr_b16 a[28:29], v7 offset:13632
    v_mfma_f32_16x16x32_bf16 v[228:231], a[32:35], a[68:71], v[228:231]
    ds_read_b64_tr_b16 a[30:31], v7 offset:14144
    s_waitcnt lgkmcnt(15)
    v_mfma_f32_16x16x32_bf16 v[236:239], a[36:39], a[68:71], v[236:239]
    ds_read_b64_tr_b16 a[32:33], v6 offset:14592
    v_mfma_f32_16x16x32_bf16 v[232:235], a[36:39], a[64:67], v[232:235]
    ds_read_b64_tr_b16 a[34:35], v6 offset:15104
    v_mfma_f32_16x16x32_bf16 v[240:243], a[40:43], a[64:67], v[240:243]
    ds_read_b64_tr_b16 a[36:37], v7 offset:14592
    v_mfma_f32_16x16x32_bf16 v[244:247], a[40:43], a[68:71], v[244:247]
    ds_read_b64_tr_b16 a[38:39], v7 offset:15104
    v_mfma_f32_16x16x32_bf16 v[252:255], a[44:47], a[68:71], v[252:255]
    ds_read_b64_tr_b16 a[40:41], v6 offset:14656
    v_mfma_f32_16x16x32_bf16 v[248:251], a[44:47], a[64:67], v[248:251]
    ds_read_b64_tr_b16 a[42:43], v6 offset:15168
    s_cbranch_scc1 qloop_adaLN_cond__linear_kernel_hedgehog__glu_gated_swiglu__prompt_kernel_19
    s_waitcnt lgkmcnt(15)
    v_mfma_f32_16x16x32_bf16 v[160:163], a[0:3], a[72:75], v[160:163]
    ds_read_b64_tr_b16 a[44:45], v7 offset:14656
    v_mfma_f32_16x16x32_bf16 v[164:167], a[0:3], a[76:79], v[164:167]
    ds_read_b64_tr_b16 a[46:47], v7 offset:15168
    s_waitcnt vmcnt(10)
    s_barrier
    v_mfma_f32_16x16x32_bf16 v[172:175], a[4:7], a[76:79], v[172:175]
    ds_read_b64_tr_b16 a[0:1], v6 offset:25088
    v_mfma_f32_16x16x32_bf16 v[168:171], a[4:7], a[72:75], v[168:171]
    ds_read_b64_tr_b16 a[2:3], v6 offset:25600
    s_add_u32 s61, s58, s59
    s_lshl_b32 s53, s61, 18
    s_mul_i32 s54, s61, 393216
    v_mfma_f32_16x16x32_bf16 v[176:179], a[8:11], a[72:75], v[176:179]
    ds_read_b64_tr_b16 a[4:5], v7 offset:25088
    v_mfma_f32_16x16x32_bf16 v[180:183], a[8:11], a[76:79], v[180:183]
    ds_read_b64_tr_b16 a[6:7], v7 offset:25600
    s_add_u32 s55, s53, 0x20000
    s_add_u32 s56, s54, 196608
    s_waitcnt lgkmcnt(15)
    v_mfma_f32_16x16x32_bf16 v[188:191], a[12:15], a[76:79], v[188:191]
    ds_read_b64_tr_b16 a[8:9], v6 offset:25152
    v_mfma_f32_16x16x32_bf16 v[184:187], a[12:15], a[72:75], v[184:187]
    ds_read_b64_tr_b16 a[10:11], v6 offset:25664
    s_add_u32 m0, s52, 75264
    v_mfma_f32_16x16x32_bf16 v[192:195], a[16:19], a[72:75], v[192:195]
    ds_read_b64_tr_b16 a[12:13], v7 offset:25152
    v_mfma_f32_16x16x32_bf16 v[196:199], a[16:19], a[76:79], v[196:199]
    ds_read_b64_tr_b16 a[14:15], v7 offset:25664
    buffer_load_dwordx4 a[112:115], v4, s[32:35], s53 offen sc1
    v_mfma_f32_16x16x32_bf16 v[204:207], a[20:23], a[76:79], v[204:207]
    ds_read_b64_tr_b16 a[16:17], v6 offset:26112
    v_mfma_f32_16x16x32_bf16 v[200:203], a[20:23], a[72:75], v[200:203]
    ds_read_b64_tr_b16 a[18:19], v6 offset:26624
    buffer_load_dwordx4 v5, s[36:39], s54 offen offset:0 lds
    s_waitcnt lgkmcnt(15)
    v_mfma_f32_16x16x32_bf16 v[208:211], a[24:27], a[72:75], v[208:211]
    ds_read_b64_tr_b16 a[20:21], v7 offset:26112
    v_mfma_f32_16x16x32_bf16 v[212:215], a[24:27], a[76:79], v[212:215]
    ds_read_b64_tr_b16 a[22:23], v7 offset:26624
    buffer_load_dwordx4 v5, s[40:43], s54 offen offset:1024 lds
    v_mfma_f32_16x16x32_bf16 v[220:223], a[28:31], a[76:79], v[220:223]
    ds_read_b64_tr_b16 a[24:25], v6 offset:26176
    v_mfma_f32_16x16x32_bf16 v[216:219], a[28:31], a[72:75], v[216:219]
    ds_read_b64_tr_b16 a[26:27], v6 offset:26688
    buffer_load_dwordx4 v5, s[44:47], s54 offen offset:2048 lds
    v_mfma_f32_16x16x32_bf16 v[224:227], a[32:35], a[72:75], v[224:227]
    ds_read_b64_tr_b16 a[28:29], v7 offset:26176
    v_mfma_f32_16x16x32_bf16 v[228:231], a[32:35], a[76:79], v[228:231]
    ds_read_b64_tr_b16 a[30:31], v7 offset:26688
    buffer_load_dwordx4 a[116:119], v4, s[32:35], s53 offen offset:1024 sc1
    s_waitcnt lgkmcnt(15)
    v_mfma_f32_16x16x32_bf16 v[236:239], a[36:39], a[76:79], v[236:239]
    ds_read_b64_tr_b16 a[32:33], v6 offset:27136
    v_mfma_f32_16x16x32_bf16 v[232:235], a[36:39], a[72:75], v[232:235]
    ds_read_b64_tr_b16 a[34:35], v6 offset:27648
    s_add_u32 s59, s59, 1
    s_and_b32 s59, s59, 3
    v_mfma_f32_16x16x32_bf16 v[240:243], a[40:43], a[72:75], v[240:243]
    ds_read_b64_tr_b16 a[36:37], v7 offset:27136
    s_cmp_eq_u32 s59, s60
    s_cselect_b32 s61, 4, 0
    s_add_u32 s58, s58, s61
    v_mfma_f32_16x16x32_bf16 v[244:247], a[40:43], a[76:79], v[244:247]
    ds_read_b64_tr_b16 a[38:39], v7 offset:27648
    v_mfma_f32_16x16x32_bf16 v[252:255], a[44:47], a[76:79], v[252:255]
    ds_read_b64_tr_b16 a[40:41], v6 offset:27200
    v_mfma_f32_16x16x32_bf16 v[248:251], a[44:47], a[72:75], v[248:251]
    ds_read_b64_tr_b16 a[42:43], v6 offset:27712
    s_waitcnt lgkmcnt(15)
    v_mfma_f32_16x16x32_bf16 v[160:163], a[0:3], a[80:83], v[160:163]
    ds_read_b64_tr_b16 a[44:45], v7 offset:27200
    v_mfma_f32_16x16x32_bf16 v[164:167], a[0:3], a[84:87], v[164:167]
    ds_read_b64_tr_b16 a[46:47], v7 offset:27712
    s_add_u32 m0, s52, 87808
    v_mfma_f32_16x16x32_bf16 v[172:175], a[4:7], a[84:87], v[172:175]
    ds_read_b64_tr_b16 a[0:1], v6 offset:37632
    v_mfma_f32_16x16x32_bf16 v[168:171], a[4:7], a[80:83], v[168:171]
    ds_read_b64_tr_b16 a[2:3], v6 offset:38144
    buffer_load_dwordx4 a[120:123], v4, s[32:35], s55 offen sc1
    v_mfma_f32_16x16x32_bf16 v[176:179], a[8:11], a[80:83], v[176:179]
    ds_read_b64_tr_b16 a[4:5], v7 offset:37632
    v_mfma_f32_16x16x32_bf16 v[180:183], a[8:11], a[84:87], v[180:183]
    ds_read_b64_tr_b16 a[6:7], v7 offset:38144
    buffer_load_dwordx4 v5, s[36:39], s56 offen offset:0 lds
    s_waitcnt lgkmcnt(15)
    v_mfma_f32_16x16x32_bf16 v[188:191], a[12:15], a[84:87], v[188:191]
    ds_read_b64_tr_b16 a[8:9], v6 offset:37696
    v_mfma_f32_16x16x32_bf16 v[184:187], a[12:15], a[80:83], v[184:187]
    ds_read_b64_tr_b16 a[10:11], v6 offset:38208
    buffer_load_dwordx4 v5, s[40:43], s56 offen offset:1024 lds
    v_mfma_f32_16x16x32_bf16 v[192:195], a[16:19], a[80:83], v[192:195]
    ds_read_b64_tr_b16 a[12:13], v7 offset:37696
    v_mfma_f32_16x16x32_bf16 v[196:199], a[16:19], a[84:87], v[196:199]
    ds_read_b64_tr_b16 a[14:15], v7 offset:38208
    buffer_load_dwordx4 v5, s[44:47], s56 offen offset:2048 lds
    v_mfma_f32_16x16x32_bf16 v[204:207], a[20:23], a[84:87], v[204:207]
    ds_read_b64_tr_b16 a[16:17], v6 offset:38656
    v_mfma_f32_16x16x32_bf16 v[200:203], a[20:23], a[80:83], v[200:203]
    ds_read_b64_tr_b16 a[18:19], v6 offset:39168
    buffer_load_dwordx4 a[124:127], v4, s[32:35], s55 offen offset:1024 sc1
    s_waitcnt lgkmcnt(15)
    v_mfma_f32_16x16x32_bf16 v[208:211], a[24:27], a[80:83], v[208:211]
    ds_read_b64_tr_b16 a[20:21], v7 offset:38656
    v_mfma_f32_16x16x32_bf16 v[212:215], a[24:27], a[84:87], v[212:215]
    ds_read_b64_tr_b16 a[22:23], v7 offset:39168
    s_getpc_b64 s[12:13]
pc_adaLN_cond__linear_kernel_hedgehog__glu_gated_swiglu__prompt_kernel_20:
    s_add_u32 s12, s12, adaLN_cond__linear_kernel_hedgehog__glu_gated_swiglu__prompt_kernel_c1-pc_adaLN_cond__linear_kernel_hedgehog__glu_gated_swiglu__prompt_kernel_20
    s_addc_u32 s13, s13, 0
    s_and_b32 s13, s13, 0xffff
    s_mov_b32 s14, adaLN_cond__linear_kernel_hedgehog__glu_gated_swiglu__prompt_kernel_c2-adaLN_cond__linear_kernel_hedgehog__glu_gated_swiglu__prompt_kernel_c1
    s_mov_b32 s15, 0x20000
    s_lshl_b32 s20, s7, 2
    s_add_u32 s20, s20, s3
    s_lshl_b32 s20, s20, 13
    v_mfma_f32_16x16x32_bf16 v[220:223], a[28:31], a[84:87], v[220:223]
    ds_read_b64_tr_b16 a[24:25], v6 offset:38720
    v_mfma_f32_16x16x32_bf16 v[216:219], a[28:31], a[80:83], v[216:219]
    ds_read_b64_tr_b16 a[26:27], v6 offset:39232
    buffer_load_dword a254, v55, s[12:15], s20 offen
    v_mfma_f32_16x16x32_bf16 v[224:227], a[32:35], a[80:83], v[224:227]
    ds_read_b64_tr_b16 a[28:29], v7 offset:38720
    v_mfma_f32_16x16x32_bf16 v[228:231], a[32:35], a[84:87], v[228:231]
    ds_read_b64_tr_b16 a[30:31], v7 offset:39232
    s_and_b32 s20, s6, 2
    s_lshl_b32 s20, s20, 9
    s_add_u32 s12, s70, s20
    s_addc_u32 s13, s71, 0
    s_and_b32 s13, s13, 0xffff
    s_sub_u32 s14, 2097152, s20
    s_mov_b32 s15, 0x20000
    s_waitcnt lgkmcnt(15)
    v_mfma_f32_16x16x32_bf16 v[236:239], a[36:39], a[84:87], v[236:239]
    ds_read_b64_tr_b16 a[32:33], v6 offset:39680
    v_mfma_f32_16x16x32_bf16 v[232:235], a[36:39], a[80:83], v[232:235]
    ds_read_b64_tr_b16 a[34:35], v6 offset:40192
    buffer_load_dword a255, v56, s[12:15], 0 offen
    v_mfma_f32_16x16x32_bf16 v[240:243], a[40:43], a[80:83], v[240:243]
    ds_read_b64_tr_b16 a[36:37], v7 offset:39680
    v_mfma_f32_16x16x32_bf16 v[244:247], a[40:43], a[84:87], v[244:247]
    ds_read_b64_tr_b16 a[38:39], v7 offset:40192
    v_mfma_f32_16x16x32_bf16 v[252:255], a[44:47], a[84:87], v[252:255]
    ds_read_b64_tr_b16 a[40:41], v6 offset:39744
    v_mfma_f32_16x16x32_bf16 v[248:251], a[44:47], a[80:83], v[248:251]
    ds_read_b64_tr_b16 a[42:43], v6 offset:40256
adaLN_cond__linear_kernel_hedgehog__glu_gated_swiglu__prompt_kernel_c1:
    s_waitcnt lgkmcnt(15)
    v_mfma_f32_16x16x32_bf16 v[160:163], a[0:3], a[88:91], v[160:163]
    ds_read_b64_tr_b16 a[44:45], v7 offset:39744
    v_mfma_f32_16x16x32_bf16 v[164:167], a[0:3], a[92:95], v[164:167]
    ds_read_b64_tr_b16 a[46:47], v7 offset:40256
    s_waitcnt vmcnt(12)
    s_barrier
    v_mfma_f32_16x16x32_bf16 v[172:175], a[4:7], a[92:95], v[172:175]
    ds_read_b64_tr_b16 a[0:1], v8 offset:0
    v_mfma_f32_16x16x32_bf16 v[168:171], a[4:7], a[88:91], v[168:171]
    ds_read_b64_tr_b16 a[2:3], v8 offset:512
    s_mov_b32 s22, 1310720
    buffer_load_dwordx4 a[128:131], v60, s[24:27], s22 offen offset:0
    v_mfma_f32_16x16x32_bf16 v[176:179], a[8:11], a[88:91], v[176:179]
    ds_read_b64_tr_b16 a[4:5], v9 offset:0
    v_mfma_f32_16x16x32_bf16 v[180:183], a[8:11], a[92:95], v[180:183]
    ds_read_b64_tr_b16 a[6:7], v9 offset:512
    s_waitcnt lgkmcnt(15)
    v_mfma_f32_16x16x32_bf16 v[188:191], a[12:15], a[92:95], v[188:191]
    ds_read_b64_tr_b16 a[8:9], v8 offset:64
    v_mfma_f32_16x16x32_bf16 v[184:187], a[12:15], a[88:91], v[184:187]
    ds_read_b64_tr_b16 a[10:11], v8 offset:576
    buffer_load_dwordx4 a[132:135], v61, s[24:27], s22 offen offset:1024
    v_mfma_f32_16x16x32_bf16 v[192:195], a[16:19], a[88:91], v[192:195]
    ds_read_b64_tr_b16 a[12:13], v9 offset:64
    v_mfma_f32_16x16x32_bf16 v[196:199], a[16:19], a[92:95], v[196:199]
    ds_read_b64_tr_b16 a[14:15], v9 offset:576
    v_mfma_f32_16x16x32_bf16 v[204:207], a[20:23], a[92:95], v[204:207]
    ds_read_b64_tr_b16 a[16:17], v8 offset:1024
    v_mfma_f32_16x16x32_bf16 v[200:203], a[20:23], a[88:91], v[200:203]
    ds_read_b64_tr_b16 a[18:19], v8 offset:1536
    buffer_load_dwordx4 a[136:139], v62, s[24:27], s22 offen offset:2048
    s_waitcnt lgkmcnt(15)
    v_mfma_f32_16x16x32_bf16 v[208:211], a[24:27], a[88:91], v[208:211]
    ds_read_b64_tr_b16 a[20:21], v9 offset:1024
    v_mfma_f32_16x16x32_bf16 v[212:215], a[24:27], a[92:95], v[212:215]
    ds_read_b64_tr_b16 a[22:23], v9 offset:1536
    v_mfma_f32_16x16x32_bf16 v[220:223], a[28:31], a[92:95], v[220:223]
    ds_read_b64_tr_b16 a[24:25], v8 offset:1088
    v_mfma_f32_16x16x32_bf16 v[216:219], a[28:31], a[88:91], v[216:219]
    ds_read_b64_tr_b16 a[26:27], v8 offset:1600
    buffer_load_dwordx4 a[140:143], v63, s[24:27], s22 offen offset:3072
    v_mfma_f32_16x16x32_bf16 v[224:227], a[32:35], a[88:91], v[224:227]
    ds_read_b64_tr_b16 a[28:29], v9 offset:1088
    v_mfma_f32_16x16x32_bf16 v[228:231], a[32:35], a[92:95], v[228:231]
    ds_read_b64_tr_b16 a[30:31], v9 offset:1600
    s_waitcnt lgkmcnt(15)
    v_mfma_f32_16x16x32_bf16 v[236:239], a[36:39], a[92:95], v[236:239]
    ds_read_b64_tr_b16 a[32:33], v8 offset:2048
    v_mfma_f32_16x16x32_bf16 v[232:235], a[36:39], a[88:91], v[232:235]
    ds_read_b64_tr_b16 a[34:35], v8 offset:2560
    s_mov_b32 s22, 1343488
    buffer_load_dwordx4 a[144:147], v60, s[24:27], s22 offen offset:0
    v_mfma_f32_16x16x32_bf16 v[240:243], a[40:43], a[88:91], v[240:243]
    ds_read_b64_tr_b16 a[36:37], v9 offset:2048
    v_mfma_f32_16x16x32_bf16 v[244:247], a[40:43], a[92:95], v[244:247]
    ds_read_b64_tr_b16 a[38:39], v9 offset:2560
    buffer_load_dwordx4 a[148:151], v61, s[24:27], s22 offen offset:1024
    v_mfma_f32_16x16x32_bf16 v[252:255], a[44:47], a[92:95], v[252:255]
    ds_read_b64_tr_b16 a[40:41], v8 offset:2112
    v_mfma_f32_16x16x32_bf16 v[248:251], a[44:47], a[88:91], v[248:251]
    ds_read_b64_tr_b16 a[42:43], v8 offset:2624
    s_waitcnt lgkmcnt(15)
    v_mfma_f32_16x16x32_bf16 v[160:163], a[0:3], a[96:99], v[160:163]
    ds_read_b64_tr_b16 a[44:45], v9 offset:2112
    v_mfma_f32_16x16x32_bf16 v[164:167], a[0:3], a[100:103], v[164:167]
    ds_read_b64_tr_b16 a[46:47], v9 offset:2624
    buffer_load_dwordx4 a[152:155], v62, s[24:27], s22 offen offset:2048
    v_mfma_f32_16x16x32_bf16 v[172:175], a[4:7], a[100:103], v[172:175]
    ds_read_b64_tr_b16 a[0:1], v8 offset:12544
    v_mfma_f32_16x16x32_bf16 v[168:171], a[4:7], a[96:99], v[168:171]
    ds_read_b64_tr_b16 a[2:3], v8 offset:13056
    v_mfma_f32_16x16x32_bf16 v[176:179], a[8:11], a[96:99], v[176:179]
    ds_read_b64_tr_b16 a[4:5], v9 offset:12544
    v_mfma_f32_16x16x32_bf16 v[180:183], a[8:11], a[100:103], v[180:183]
    ds_read_b64_tr_b16 a[6:7], v9 offset:13056
    buffer_load_dwordx4 a[156:159], v63, s[24:27], s22 offen offset:3072
    s_waitcnt lgkmcnt(15)
    v_mfma_f32_16x16x32_bf16 v[188:191], a[12:15], a[100:103], v[188:191]
    ds_read_b64_tr_b16 a[8:9], v8 offset:12608
    v_mfma_f32_16x16x32_bf16 v[184:187], a[12:15], a[96:99], v[184:187]
    ds_read_b64_tr_b16 a[10:11], v8 offset:13120
    v_mfma_f32_16x16x32_bf16 v[192:195], a[16:19], a[96:99], v[192:195]
    ds_read_b64_tr_b16 a[12:13], v9 offset:12608
    v_mfma_f32_16x16x32_bf16 v[196:199], a[16:19], a[100:103], v[196:199]
    ds_read_b64_tr_b16 a[14:15], v9 offset:13120
    s_mov_b32 s22, 1572864
    buffer_load_dwordx4 a[160:163], v60, s[24:27], s22 offen offset:0
    v_mfma_f32_16x16x32_bf16 v[204:207], a[20:23], a[100:103], v[204:207]
    ds_read_b64_tr_b16 a[16:17], v8 offset:13568
    v_mfma_f32_16x16x32_bf16 v[200:203], a[20:23], a[96:99], v[200:203]
    ds_read_b64_tr_b16 a[18:19], v8 offset:14080
    s_waitcnt lgkmcnt(15)
    v_mfma_f32_16x16x32_bf16 v[208:211], a[24:27], a[96:99], v[208:211]
    ds_read_b64_tr_b16 a[20:21], v9 offset:13568
    v_mfma_f32_16x16x32_bf16 v[212:215], a[24:27], a[100:103], v[212:215]
    ds_read_b64_tr_b16 a[22:23], v9 offset:14080
    buffer_load_dwordx4 a[164:167], v61, s[24:27], s22 offen offset:1024
    v_mfma_f32_16x16x32_bf16 v[220:223], a[28:31], a[100:103], v[220:223]
    ds_read_b64_tr_b16 a[24:25], v8 offset:13632
    v_mfma_f32_16x16x32_bf16 v[216:219], a[28:31], a[96:99], v[216:219]
    ds_read_b64_tr_b16 a[26:27], v8 offset:14144
    v_mfma_f32_16x16x32_bf16 v[224:227], a[32:35], a[96:99], v[224:227]
    ds_read_b64_tr_b16 a[28:29], v9 offset:13632
    v_mfma_f32_16x16x32_bf16 v[228:231], a[32:35], a[100:103], v[228:231]
    ds_read_b64_tr_b16 a[30:31], v9 offset:14144
    buffer_load_dwordx4 a[168:171], v62, s[24:27], s22 offen offset:2048
    s_waitcnt lgkmcnt(15)
    v_mfma_f32_16x16x32_bf16 v[236:239], a[36:39], a[100:103], v[236:239]
    ds_read_b64_tr_b16 a[32:33], v8 offset:14592
    v_mfma_f32_16x16x32_bf16 v[232:235], a[36:39], a[96:99], v[232:235]
    ds_read_b64_tr_b16 a[34:35], v8 offset:15104
    v_mfma_f32_16x16x32_bf16 v[240:243], a[40:43], a[96:99], v[240:243]
    ds_read_b64_tr_b16 a[36:37], v9 offset:14592
    buffer_load_dwordx4 a[172:175], v63, s[24:27], s22 offen offset:3072
    v_mfma_f32_16x16x32_bf16 v[244:247], a[40:43], a[100:103], v[244:247]
    ds_read_b64_tr_b16 a[38:39], v9 offset:15104
    v_mfma_f32_16x16x32_bf16 v[252:255], a[44:47], a[100:103], v[252:255]
    ds_read_b64_tr_b16 a[40:41], v8 offset:14656
    v_mfma_f32_16x16x32_bf16 v[248:251], a[44:47], a[96:99], v[248:251]
    ds_read_b64_tr_b16 a[42:43], v8 offset:15168
    s_waitcnt lgkmcnt(15)
    v_mfma_f32_16x16x32_bf16 v[160:163], a[0:3], a[104:107], v[160:163]
    ds_read_b64_tr_b16 a[44:45], v9 offset:14656
    v_mfma_f32_16x16x32_bf16 v[164:167], a[0:3], a[108:111], v[164:167]
    ds_read_b64_tr_b16 a[46:47], v9 offset:15168
    s_waitcnt vmcnt(14)
    s_barrier
    v_mfma_f32_16x16x32_bf16 v[172:175], a[4:7], a[108:111], v[172:175]
    ds_read_b64_tr_b16 a[0:1], v8 offset:25088
    v_mfma_f32_16x16x32_bf16 v[168:171], a[4:7], a[104:107], v[168:171]
    ds_read_b64_tr_b16 a[2:3], v8 offset:25600
    s_mov_b32 s22, 1605632
    buffer_load_dwordx4 a[176:179], v60, s[24:27], s22 offen offset:0
    v_mfma_f32_16x16x32_bf16 v[176:179], a[8:11], a[104:107], v[176:179]
    ds_read_b64_tr_b16 a[4:5], v9 offset:25088
    v_mfma_f32_16x16x32_bf16 v[180:183], a[8:11], a[108:111], v[180:183]
    ds_read_b64_tr_b16 a[6:7], v9 offset:25600
    s_waitcnt lgkmcnt(15)
    v_mfma_f32_16x16x32_bf16 v[188:191], a[12:15], a[108:111], v[188:191]
    ds_read_b64_tr_b16 a[8:9], v8 offset:25152
    v_mfma_f32_16x16x32_bf16 v[184:187], a[12:15], a[104:107], v[184:187]
    ds_read_b64_tr_b16 a[10:11], v8 offset:25664
    buffer_load_dwordx4 a[180:183], v61, s[24:27], s22 offen offset:1024
    v_mfma_f32_16x16x32_bf16 v[192:195], a[16:19], a[104:107], v[192:195]
    ds_read_b64_tr_b16 a[12:13], v9 offset:25152
    v_mfma_f32_16x16x32_bf16 v[196:199], a[16:19], a[108:111], v[196:199]
    ds_read_b64_tr_b16 a[14:15], v9 offset:25664
    v_mfma_f32_16x16x32_bf16 v[204:207], a[20:23], a[108:111], v[204:207]
    ds_read_b64_tr_b16 a[16:17], v8 offset:26112
    v_mfma_f32_16x16x32_bf16 v[200:203], a[20:23], a[104:107], v[200:203]
    ds_read_b64_tr_b16 a[18:19], v8 offset:26624
    buffer_load_dwordx4 a[184:187], v62, s[24:27], s22 offen offset:2048
    s_waitcnt lgkmcnt(15)
    v_mfma_f32_16x16x32_bf16 v[208:211], a[24:27], a[104:107], v[208:211]
    ds_read_b64_tr_b16 a[20:21], v9 offset:26112
    v_mfma_f32_16x16x32_bf16 v[212:215], a[24:27], a[108:111], v[212:215]
    ds_read_b64_tr_b16 a[22:23], v9 offset:26624
    v_mfma_f32_16x16x32_bf16 v[220:223], a[28:31], a[108:111], v[220:223]
    ds_read_b64_tr_b16 a[24:25], v8 offset:26176
    v_mfma_f32_16x16x32_bf16 v[216:219], a[28:31], a[104:107], v[216:219]
    ds_read_b64_tr_b16 a[26:27], v8 offset:26688
    buffer_load_dwordx4 a[188:191], v63, s[24:27], s22 offen offset:3072
    v_mfma_f32_16x16x32_bf16 v[224:227], a[32:35], a[104:107], v[224:227]
    ds_read_b64_tr_b16 a[28:29], v9 offset:26176
    v_mfma_f32_16x16x32_bf16 v[228:231], a[32:35], a[108:111], v[228:231]
    ds_read_b64_tr_b16 a[30:31], v9 offset:26688
    s_waitcnt lgkmcnt(15)
    v_mfma_f32_16x16x32_bf16 v[236:239], a[36:39], a[108:111], v[236:239]
    ds_read_b64_tr_b16 a[32:33], v8 offset:27136
    v_mfma_f32_16x16x32_bf16 v[232:235], a[36:39], a[104:107], v[232:235]
    ds_read_b64_tr_b16 a[34:35], v8 offset:27648
    s_mov_b32 s22, 1835008
    buffer_load_dwordx4 a[192:195], v60, s[24:27], s22 offen offset:0
    v_mfma_f32_16x16x32_bf16 v[240:243], a[40:43], a[104:107], v[240:243]
    ds_read_b64_tr_b16 a[36:37], v9 offset:27136
    v_mfma_f32_16x16x32_bf16 v[244:247], a[40:43], a[108:111], v[244:247]
    ds_read_b64_tr_b16 a[38:39], v9 offset:27648
    buffer_load_dwordx4 a[196:199], v61, s[24:27], s22 offen offset:1024
    v_mfma_f32_16x16x32_bf16 v[252:255], a[44:47], a[108:111], v[252:255]
    ds_read_b64_tr_b16 a[40:41], v8 offset:27200
    v_mfma_f32_16x16x32_bf16 v[248:251], a[44:47], a[104:107], v[248:251]
    ds_read_b64_tr_b16 a[42:43], v8 offset:27712
    s_waitcnt lgkmcnt(15)
    v_mfma_f32_16x16x32_bf16 v[160:163], a[0:3], a[112:115], v[160:163]
    ds_read_b64_tr_b16 a[44:45], v9 offset:27200
    v_mfma_f32_16x16x32_bf16 v[164:167], a[0:3], a[116:119], v[164:167]
    ds_read_b64_tr_b16 a[46:47], v9 offset:27712
    buffer_load_dwordx4 a[200:203], v62, s[24:27], s22 offen offset:2048
    v_mfma_f32_16x16x32_bf16 v[172:175], a[4:7], a[116:119], v[172:175]
    ds_read_b64_tr_b16 a[0:1], v8 offset:37632
    v_mfma_f32_16x16x32_bf16 v[168:171], a[4:7], a[112:115], v[168:171]
    ds_read_b64_tr_b16 a[2:3], v8 offset:38144
    v_mfma_f32_16x16x32_bf16 v[176:179], a[8:11], a[112:115], v[176:179]
    ds_read_b64_tr_b16 a[4:5], v9 offset:37632
    v_mfma_f32_16x16x32_bf16 v[180:183], a[8:11], a[116:119], v[180:183]
    ds_read_b64_tr_b16 a[6:7], v9 offset:38144
    buffer_load_dwordx4 a[204:207], v63, s[24:27], s22 offen offset:3072
    s_waitcnt lgkmcnt(15)
    v_mfma_f32_16x16x32_bf16 v[188:191], a[12:15], a[116:119], v[188:191]
    ds_read_b64_tr_b16 a[8:9], v8 offset:37696
    v_mfma_f32_16x16x32_bf16 v[184:187], a[12:15], a[112:115], v[184:187]
    ds_read_b64_tr_b16 a[10:11], v8 offset:38208
    v_mfma_f32_16x16x32_bf16 v[192:195], a[16:19], a[112:115], v[192:195]
    ds_read_b64_tr_b16 a[12:13], v9 offset:37696
    v_mfma_f32_16x16x32_bf16 v[196:199], a[16:19], a[116:119], v[196:199]
    ds_read_b64_tr_b16 a[14:15], v9 offset:38208
    s_mov_b32 s22, 1867776
    buffer_load_dwordx4 a[208:211], v60, s[24:27], s22 offen offset:0
    v_mfma_f32_16x16x32_bf16 v[204:207], a[20:23], a[116:119], v[204:207]
    ds_read_b64_tr_b16 a[16:17], v8 offset:38656
    v_mfma_f32_16x16x32_bf16 v[200:203], a[20:23], a[112:115], v[200:203]
    ds_read_b64_tr_b16 a[18:19], v8 offset:39168
    s_waitcnt lgkmcnt(15)
    v_mfma_f32_16x16x32_bf16 v[208:211], a[24:27], a[112:115], v[208:211]
    ds_read_b64_tr_b16 a[20:21], v9 offset:38656
    v_mfma_f32_16x16x32_bf16 v[212:215], a[24:27], a[116:119], v[212:215]
    ds_read_b64_tr_b16 a[22:23], v9 offset:39168
    buffer_load_dwordx4 a[212:215], v61, s[24:27], s22 offen offset:1024
    v_mfma_f32_16x16x32_bf16 v[220:223], a[28:31], a[116:119], v[220:223]
    ds_read_b64_tr_b16 a[24:25], v8 offset:38720
    v_mfma_f32_16x16x32_bf16 v[216:219], a[28:31], a[112:115], v[216:219]
    ds_read_b64_tr_b16 a[26:27], v8 offset:39232
    v_mfma_f32_16x16x32_bf16 v[224:227], a[32:35], a[112:115], v[224:227]
    ds_read_b64_tr_b16 a[28:29], v9 offset:38720
    v_mfma_f32_16x16x32_bf16 v[228:231], a[32:35], a[116:119], v[228:231]
    ds_read_b64_tr_b16 a[30:31], v9 offset:39232
    buffer_load_dwordx4 a[216:219], v62, s[24:27], s22 offen offset:2048
    s_waitcnt lgkmcnt(15)
    v_mfma_f32_16x16x32_bf16 v[236:239], a[36:39], a[116:119], v[236:239]
    ds_read_b64_tr_b16 a[32:33], v8 offset:39680
    v_mfma_f32_16x16x32_bf16 v[232:235], a[36:39], a[112:115], v[232:235]
    ds_read_b64_tr_b16 a[34:35], v8 offset:40192
    v_mfma_f32_16x16x32_bf16 v[240:243], a[40:43], a[112:115], v[240:243]
    ds_read_b64_tr_b16 a[36:37], v9 offset:39680
    buffer_load_dwordx4 a[220:223], v63, s[24:27], s22 offen offset:3072
    v_mfma_f32_16x16x32_bf16 v[244:247], a[40:43], a[116:119], v[244:247]
    ds_read_b64_tr_b16 a[38:39], v9 offset:40192
    v_mfma_f32_16x16x32_bf16 v[252:255], a[44:47], a[116:119], v[252:255]
    ds_read_b64_tr_b16 a[40:41], v8 offset:39744
    v_mfma_f32_16x16x32_bf16 v[248:251], a[44:47], a[112:115], v[248:251]
    ds_read_b64_tr_b16 a[42:43], v8 offset:40256
    s_waitcnt lgkmcnt(15)
    v_mfma_f32_16x16x32_bf16 v[160:163], a[0:3], a[120:123], v[160:163]
    ds_read_b64_tr_b16 a[44:45], v9 offset:39744
    v_mfma_f32_16x16x32_bf16 v[164:167], a[0:3], a[124:127], v[164:167]
    ds_read_b64_tr_b16 a[46:47], v9 offset:40256
    s_add_u32 s12, s64, s21
    s_addc_u32 s13, s65, 0
    s_and_b32 s13, s13, 0xffff
    s_sub_u32 s14, 4194304, s21
    s_mov_b32 s15, 0x20000
    s_waitcnt lgkmcnt(15)
    v_mfma_f32_16x16x32_bf16 v[172:175], a[4:7], a[124:127], v[172:175]
    v_mfma_f32_16x16x32_bf16 v[168:171], a[4:7], a[120:123], v[168:171]
    buffer_load_dwordx4 a[224:227], v59, s[12:15], 0 offen offset:0
    s_waitcnt lgkmcnt(15)
    v_mfma_f32_16x16x32_bf16 v[176:179], a[8:11], a[120:123], v[176:179]
    v_mfma_f32_16x16x32_bf16 v[180:183], a[8:11], a[124:127], v[180:183]
    buffer_load_dwordx4 a[228:231], v59, s[12:15], 0 offen offset:64
    s_waitcnt lgkmcnt(15)
    v_mfma_f32_16x16x32_bf16 v[188:191], a[12:15], a[124:127], v[188:191]
    v_mfma_f32_16x16x32_bf16 v[184:187], a[12:15], a[120:123], v[184:187]
    buffer_load_dwordx4 a[232:235], v59, s[12:15], 0 offen offset:128
    s_waitcnt lgkmcnt(14)
    v_mfma_f32_16x16x32_bf16 v[192:195], a[16:19], a[120:123], v[192:195]
    v_mfma_f32_16x16x32_bf16 v[196:199], a[16:19], a[124:127], v[196:199]
    buffer_load_dwordx4 a[236:239], v59, s[12:15], 0 offen offset:192
    s_waitcnt lgkmcnt(12)
    v_mfma_f32_16x16x32_bf16 v[204:207], a[20:23], a[124:127], v[204:207]
    v_mfma_f32_16x16x32_bf16 v[200:203], a[20:23], a[120:123], v[200:203]
    s_mul_i32 s20, s6, 896
    s_add_u32 s12, s74, s20
    s_addc_u32 s13, s75, 0
    s_and_b32 s13, s13, 0xffff
    s_sub_u32 s14, 1835008, s20
    s_mov_b32 s15, 0x20000
    s_waitcnt lgkmcnt(10)
    v_mfma_f32_16x16x32_bf16 v[208:211], a[24:27], a[120:123], v[208:211]
    v_mfma_f32_16x16x32_bf16 v[212:215], a[24:27], a[124:127], v[212:215]
    buffer_load_dword a255, v57, s[12:15], 0 offen
    s_waitcnt lgkmcnt(8)
    v_mfma_f32_16x16x32_bf16 v[220:223], a[28:31], a[124:127], v[220:223]
    v_mfma_f32_16x16x32_bf16 v[216:219], a[28:31], a[120:123], v[216:219]
    s_mul_i32 s20, s6, 896
    s_add_u32 s12, s76, s20
    s_addc_u32 s13, s77, 0
    s_and_b32 s13, s13, 0xffff
    s_sub_u32 s14, 1835008, s20
    s_mov_b32 s15, 0x20000
    s_waitcnt lgkmcnt(6)
    v_mfma_f32_16x16x32_bf16 v[224:227], a[32:35], a[120:123], v[224:227]
    v_mfma_f32_16x16x32_bf16 v[228:231], a[32:35], a[124:127], v[228:231]
    buffer_load_dword a255, v57, s[12:15], 0 offen
    s_waitcnt lgkmcnt(4)
    v_mfma_f32_16x16x32_bf16 v[236:239], a[36:39], a[124:127], v[236:239]
    v_mfma_f32_16x16x32_bf16 v[232:235], a[36:39], a[120:123], v[232:235]
    s_waitcnt lgkmcnt(2)
    v_mfma_f32_16x16x32_bf16 v[240:243], a[40:43], a[120:123], v[240:243]
    v_mfma_f32_16x16x32_bf16 v[244:247], a[40:43], a[124:127], v[244:247]
    s_waitcnt lgkmcnt(0)
    v_mfma_f32_16x16x32_bf16 v[252:255], a[44:47], a[124:127], v[252:255]
    v_mfma_f32_16x16x32_bf16 v[248:251], a[44:47], a[120:123], v[248:251]
    v_cvt_pk_bf16_f32 v48, v192, v193
    v_cvt_pk_bf16_f32 v49, v194, v195
    v_cvt_pk_bf16_f32 v50, v200, v201
    v_cvt_pk_bf16_f32 v51, v202, v203
    v_cvt_pk_bf16_f32 v52, v196, v197
    v_cvt_pk_bf16_f32 v53, v198, v199
    v_cvt_pk_bf16_f32 v54, v204, v205
    v_cvt_pk_bf16_f32 v55, v206, v207
    v_cvt_pk_bf16_f32 v56, v208, v209
    v_cvt_pk_bf16_f32 v57, v210, v211
    v_cvt_pk_bf16_f32 v58, v216, v217
    v_cvt_pk_bf16_f32 v59, v218, v219
    v_cvt_pk_bf16_f32 v60, v212, v213
    v_cvt_pk_bf16_f32 v61, v214, v215
    v_cvt_pk_bf16_f32 v62, v220, v221
    v_cvt_pk_bf16_f32 v63, v222, v223
    v_cvt_pk_bf16_f32 v32, v160, v161
    v_cvt_pk_bf16_f32 v33, v162, v163
    v_cvt_pk_bf16_f32 v34, v168, v169
    v_cvt_pk_bf16_f32 v35, v170, v171
    v_cvt_pk_bf16_f32 v36, v164, v165
    v_cvt_pk_bf16_f32 v37, v166, v167
    v_cvt_pk_bf16_f32 v38, v172, v173
    v_cvt_pk_bf16_f32 v39, v174, v175
    v_cvt_pk_bf16_f32 v40, v176, v177
    v_cvt_pk_bf16_f32 v41, v178, v179
    v_cvt_pk_bf16_f32 v42, v184, v185
    v_cvt_pk_bf16_f32 v43, v186, v187
    v_cvt_pk_bf16_f32 v44, v180, v181
    v_cvt_pk_bf16_f32 v45, v182, v183
    v_cvt_pk_bf16_f32 v46, v188, v189
    v_cvt_pk_bf16_f32 v47, v190, v191
    v_mfma_f32_16x16x32_bf16 v[64:67], a[48:51], v[48:51], 0
    v_mfma_f32_16x16x32_bf16 v[68:71], a[52:55], v[48:51], 0
    v_mfma_f32_16x16x32_bf16 v[72:75], a[48:51], v[52:55], 0
    v_mfma_f32_16x16x32_bf16 v[76:79], a[52:55], v[52:55], 0
    v_mfma_f32_16x16x32_bf16 v[80:83], a[56:59], v[56:59], 0
    v_mfma_f32_16x16x32_bf16 v[84:87], a[60:63], v[56:59], 0
    v_mfma_f32_16x16x32_bf16 v[88:91], a[56:59], v[60:63], 0
    v_mfma_f32_16x16x32_bf16 v[92:95], a[60:63], v[60:63], 0
    v_mfma_f32_16x16x32_bf16 v[96:99], a[48:51], v[32:35], 0
    v_mfma_f32_16x16x32_bf16 v[100:103], a[52:55], v[32:35], 0
    v_mfma_f32_16x16x32_bf16 v[104:107], a[48:51], v[36:39], 0
    v_mfma_f32_16x16x32_bf16 v[108:111], a[52:55], v[36:39], 0
    v_mfma_f32_16x16x32_bf16 v[112:115], a[56:59], v[40:43], 0
    v_mfma_f32_16x16x32_bf16 v[116:119], a[60:63], v[40:43], 0
    v_mfma_f32_16x16x32_bf16 v[120:123], a[56:59], v[44:47], 0
    v_mfma_f32_16x16x32_bf16 v[124:127], a[60:63], v[44:47], 0
    v_cvt_pk_bf16_f32 v128, v224, v225
    v_cvt_pk_bf16_f32 v129, v226, v227
    ds_write_b64 v19, v[128:129] offset:0
    v_cvt_pk_bf16_f32 v130, v232, v233
    v_cvt_pk_bf16_f32 v131, v234, v235
    ds_write_b64 v19, v[130:131] offset:32
    v_cvt_pk_bf16_f32 v132, v228, v229
    v_cvt_pk_bf16_f32 v133, v230, v231
    ds_write_b64 v19, v[132:133] offset:1280
    v_cvt_pk_bf16_f32 v134, v236, v237
    v_cvt_pk_bf16_f32 v135, v238, v239
    ds_write_b64 v19, v[134:135] offset:1312
    v_cvt_pk_bf16_f32 v136, v240, v241
    v_cvt_pk_bf16_f32 v137, v242, v243
    ds_write_b64 v19, v[136:137] offset:10240
    v_cvt_pk_bf16_f32 v138, v248, v249
    v_cvt_pk_bf16_f32 v139, v250, v251
    ds_write_b64 v19, v[138:139] offset:10272
    v_cvt_pk_bf16_f32 v140, v244, v245
    v_cvt_pk_bf16_f32 v141, v246, v247
    ds_write_b64 v19, v[140:141] offset:11520
    v_cvt_pk_bf16_f32 v142, v252, v253
    v_cvt_pk_bf16_f32 v143, v254, v255
    ds_write_b64 v19, v[142:143] offset:11552
    v_max3_f32 v224, v64, v65, v66
    v_max3_f32 v225, v67, v68, v69
    v_max3_f32 v226, -v64, -v65, -v66
    v_max3_f32 v227, -v67, -v68, -v69
    v_max3_f32 v224, v224, v70, v71
    v_max3_f32 v226, v226, -v70, -v71
    v_max_f32 v224, v224, v225
    v_max_f32 v226, v226, v227
    v_max3_f32 v228, v72, v73, v74
    v_max3_f32 v229, v75, v76, v77
    v_max3_f32 v230, -v72, -v73, -v74
    v_max3_f32 v231, -v75, -v76, -v77
    v_max3_f32 v228, v228, v78, v79
    v_max3_f32 v230, v230, -v78, -v79
    v_max_f32 v228, v228, v229
    v_max_f32 v230, v230, v231
    v_max3_f32 v232, v80, v81, v82
    v_max3_f32 v233, v83, v84, v85
    v_max3_f32 v234, -v80, -v81, -v82
    v_max3_f32 v235, -v83, -v84, -v85
    v_max3_f32 v232, v232, v86, v87
    v_max3_f32 v234, v234, -v86, -v87
    v_max_f32 v232, v232, v233
    v_max_f32 v234, v234, v235
    v_max3_f32 v236, v88, v89, v90
    v_max3_f32 v237, v91, v92, v93
    v_max3_f32 v238, -v88, -v89, -v90
    v_max3_f32 v239, -v91, -v92, -v93
    v_max3_f32 v236, v236, v94, v95
    v_max3_f32 v238, v238, -v94, -v95
    v_max_f32 v236, v236, v237
    v_max_f32 v238, v238, v239
    s_nop 1
    v_permlane16_swap_b32 v224, v226
    v_permlane16_swap_b32 v228, v230
    v_permlane16_swap_b32 v232, v234
    v_permlane16_swap_b32 v236, v238
    v_max_f32 v224, v224, v226
    v_max_f32 v228, v228, v230
    v_max_f32 v232, v232, v234
    v_max_f32 v236, v236, v238
    v_mov_b32 v226, v224
    v_mov_b32 v230, v228
    v_mov_b32 v234, v232
    v_mov_b32 v238, v236
    s_nop 1
    v_permlane32_swap_b32 v224, v226
    v_permlane32_swap_b32 v228, v230
    v_permlane32_swap_b32 v232, v234
    v_permlane32_swap_b32 v236, v238
    v_max_f32 v224, v224, v226
    v_max_f32 v228, v228, v230
    v_max_f32 v232, v232, v234
    v_max_f32 v236, v236, v238
    v_mul_f32 v224, s10, v224
    v_mul_f32 v228, s10, v228
    v_mul_f32 v232, s10, v232
    v_mul_f32 v236, s10, v236
    s_nop 0
    v_mov_b32 v226, v224
    v_mov_b32 v230, v228
    v_mov_b32 v234, v232
    v_mov_b32 v238, v236
    s_nop 1
    v_permlane16_swap_b32 v224, v226
    v_permlane16_swap_b32 v228, v230
    v_permlane16_swap_b32 v232, v234
    v_permlane16_swap_b32 v236, v238
    v_pk_fma_f32 v[160:161], v[64:65], s[8:9], v[224:225] op_sel_hi:[1,1,0]
    v_pk_fma_f32 v[192:193], v[64:65], s[10:11], v[226:227] op_sel_hi:[1,1,0]
    v_pk_fma_f32 v[162:163], v[66:67], s[8:9], v[224:225] op_sel_hi:[1,1,0]
    v_pk_fma_f32 v[194:195], v[66:67], s[10:11], v[226:227] op_sel_hi:[1,1,0]
    v_pk_fma_f32 v[164:165], v[68:69], s[8:9], v[224:225] op_sel_hi:[1,1,0]
    v_pk_fma_f32 v[196:197], v[68:69], s[10:11], v[226:227] op_sel_hi:[1,1,0]
    v_pk_fma_f32 v[166:167], v[70:71], s[8:9], v[224:225] op_sel_hi:[1,1,0]
    v_pk_fma_f32 v[198:199], v[70:71], s[10:11], v[226:227] op_sel_hi:[1,1,0]
    v_exp_f32 v160, v160
    v_exp_f32 v192, v192
    v_exp_f32 v161, v161
    v_exp_f32 v193, v193
    v_exp_f32 v162, v162
    v_exp_f32 v194, v194
    v_exp_f32 v163, v163
    v_exp_f32 v195, v195
    v_exp_f32 v164, v164
    v_exp_f32 v196, v196
    v_exp_f32 v165, v165
    v_exp_f32 v197, v197
    v_exp_f32 v166, v166
    v_exp_f32 v198, v198
    v_exp_f32 v167, v167
    v_exp_f32 v199, v199
    v_pk_fma_f32 v[168:169], v[72:73], s[8:9], v[228:229] op_sel_hi:[1,1,0]
    v_pk_fma_f32 v[200:201], v[72:73], s[10:11], v[230:231] op_sel_hi:[1,1,0]
    v_pk_fma_f32 v[170:171], v[74:75], s[8:9], v[228:229] op_sel_hi:[1,1,0]
    v_pk_fma_f32 v[202:203], v[74:75], s[10:11], v[230:231] op_sel_hi:[1,1,0]
    v_pk_fma_f32 v[172:173], v[76:77], s[8:9], v[228:229] op_sel_hi:[1,1,0]
    v_pk_fma_f32 v[204:205], v[76:77], s[10:11], v[230:231] op_sel_hi:[1,1,0]
    v_pk_fma_f32 v[174:175], v[78:79], s[8:9], v[228:229] op_sel_hi:[1,1,0]
    v_pk_fma_f32 v[206:207], v[78:79], s[10:11], v[230:231] op_sel_hi:[1,1,0]
    v_exp_f32 v168, v168
    v_exp_f32 v200, v200
    v_exp_f32 v169, v169
    v_exp_f32 v201, v201
    v_exp_f32 v170, v170
    v_exp_f32 v202, v202
    v_exp_f32 v171, v171
    v_exp_f32 v203, v203
    v_exp_f32 v172, v172
    v_exp_f32 v204, v204
    v_exp_f32 v173, v173
    v_exp_f32 v205, v205
    v_exp_f32 v174, v174
    v_exp_f32 v206, v206
    v_exp_f32 v175, v175
    v_exp_f32 v207, v207
    v_pk_fma_f32 v[176:177], v[80:81], s[8:9], v[232:233] op_sel_hi:[1,1,0]
    v_pk_fma_f32 v[208:209], v[80:81], s[10:11], v[234:235] op_sel_hi:[1,1,0]
    v_pk_fma_f32 v[178:179], v[82:83], s[8:9], v[232:233] op_sel_hi:[1,1,0]
    v_pk_fma_f32 v[210:211], v[82:83], s[10:11], v[234:235] op_sel_hi:[1,1,0]
    v_pk_fma_f32 v[180:181], v[84:85], s[8:9], v[232:233] op_sel_hi:[1,1,0]
    v_pk_fma_f32 v[212:213], v[84:85], s[10:11], v[234:235] op_sel_hi:[1,1,0]
    v_pk_fma_f32 v[182:183], v[86:87], s[8:9], v[232:233] op_sel_hi:[1,1,0]
    v_pk_fma_f32 v[214:215], v[86:87], s[10:11], v[234:235] op_sel_hi:[1,1,0]
    v_exp_f32 v176, v176
    v_exp_f32 v208, v208
    v_exp_f32 v177, v177
    v_exp_f32 v209, v209
    v_exp_f32 v178, v178
    v_exp_f32 v210, v210
    v_exp_f32 v179, v179
    v_exp_f32 v211, v211
    v_exp_f32 v180, v180
    v_exp_f32 v212, v212
    v_exp_f32 v181, v181
    v_exp_f32 v213, v213
    v_exp_f32 v182, v182
    v_exp_f32 v214, v214
    v_exp_f32 v183, v183
    v_exp_f32 v215, v215
    v_pk_fma_f32 v[184:185], v[88:89], s[8:9], v[236:237] op_sel_hi:[1,1,0]
    v_pk_fma_f32 v[216:217], v[88:89], s[10:11], v[238:239] op_sel_hi:[1,1,0]
    v_pk_fma_f32 v[186:187], v[90:91], s[8:9], v[236:237] op_sel_hi:[1,1,0]
    v_pk_fma_f32 v[218:219], v[90:91], s[10:11], v[238:239] op_sel_hi:[1,1,0]
    v_pk_fma_f32 v[188:189], v[92:93], s[8:9], v[236:237] op_sel_hi:[1,1,0]
    v_pk_fma_f32 v[220:221], v[92:93], s[10:11], v[238:239] op_sel_hi:[1,1,0]
    v_pk_fma_f32 v[190:191], v[94:95], s[8:9], v[236:237] op_sel_hi:[1,1,0]
    v_pk_fma_f32 v[222:223], v[94:95], s[10:11], v[238:239] op_sel_hi:[1,1,0]
    v_exp_f32 v184, v184
    v_exp_f32 v216, v216
    v_exp_f32 v185, v185
    v_exp_f32 v217, v217
    v_exp_f32 v186, v186
    v_exp_f32 v218, v218
    v_exp_f32 v187, v187
    v_exp_f32 v219, v219
    v_exp_f32 v188, v188
    v_exp_f32 v220, v220
    v_exp_f32 v189, v189
    v_exp_f32 v221, v221
    v_exp_f32 v190, v190
    v_exp_f32 v222, v222
    v_exp_f32 v191, v191
    v_exp_f32 v223, v223
    s_nop 0
    v_pk_add_f32 v[240:241], v[160:161], v[162:163]
    v_pk_add_f32 v[242:243], v[164:165], v[166:167]
    v_pk_add_f32 v[244:245], v[192:193], v[194:195]
    v_pk_add_f32 v[246:247], v[196:197], v[198:199]
    v_pk_add_f32 v[240:241], v[240:241], v[242:243]
    v_pk_add_f32 v[244:245], v[244:245], v[246:247]
    v_add_f32 v224, v240, v241
    v_add_f32 v226, v244, v245
    v_pk_add_f32 v[240:241], v[168:169], v[170:171]
    v_pk_add_f32 v[242:243], v[172:173], v[174:175]
    v_pk_add_f32 v[244:245], v[200:201], v[202:203]
    v_pk_add_f32 v[246:247], v[204:205], v[206:207]
    v_pk_add_f32 v[240:241], v[240:241], v[242:243]
    v_pk_add_f32 v[244:245], v[244:245], v[246:247]
    v_add_f32 v228, v240, v241
    v_add_f32 v230, v244, v245
    v_pk_add_f32 v[240:241], v[176:177], v[178:179]
    v_pk_add_f32 v[242:243], v[180:181], v[182:183]
    v_pk_add_f32 v[244:245], v[208:209], v[210:211]
    v_pk_add_f32 v[246:247], v[212:213], v[214:215]
    v_pk_add_f32 v[240:241], v[240:241], v[242:243]
    v_pk_add_f32 v[244:245], v[244:245], v[246:247]
    v_add_f32 v232, v240, v241
    v_add_f32 v234, v244, v245
    v_pk_add_f32 v[240:241], v[184:185], v[186:187]
    v_pk_add_f32 v[242:243], v[188:189], v[190:191]
    v_pk_add_f32 v[244:245], v[216:217], v[218:219]
    v_pk_add_f32 v[246:247], v[220:221], v[222:223]
    v_pk_add_f32 v[240:241], v[240:241], v[242:243]
    v_pk_add_f32 v[244:245], v[244:245], v[246:247]
    v_add_f32 v236, v240, v241
    v_add_f32 v238, v244, v245
    s_nop 1
    v_permlane16_swap_b32 v224, v226
    v_permlane16_swap_b32 v228, v230
    v_permlane16_swap_b32 v232, v234
    v_permlane16_swap_b32 v236, v238
    v_add_f32 v224, v224, v226
    v_add_f32 v228, v228, v230
    v_add_f32 v232, v232, v234
    v_add_f32 v236, v236, v238
    v_mov_b32 v226, v224
    v_mov_b32 v230, v228
    v_mov_b32 v234, v232
    v_mov_b32 v238, v236
    s_nop 1
    v_permlane32_swap_b32 v224, v226
    v_permlane32_swap_b32 v228, v230
    v_permlane32_swap_b32 v232, v234
    v_permlane32_swap_b32 v236, v238
    v_add_f32 v224, v224, v226
    v_add_f32 v228, v228, v230
    v_add_f32 v232, v232, v234
    v_add_f32 v236, v236, v238
    v_rcp_f32 v224, v224
    v_rcp_f32 v228, v228
    v_rcp_f32 v232, v232
    v_rcp_f32 v236, v236
    s_nop 0
    v_mov_b32 v226, v224
    v_mov_b32 v230, v228
    v_mov_b32 v234, v232
    v_mov_b32 v238, v236
    s_nop 1
    v_permlane16_swap_b32 v224, v226
    v_permlane16_swap_b32 v228, v230
    v_permlane16_swap_b32 v232, v234
    v_permlane16_swap_b32 v236, v238
    v_pk_mul_f32 v[160:161], v[160:161], v[224:225] op_sel_hi:[1,0]
    v_pk_mul_f32 v[162:163], v[162:163], v[224:225] op_sel_hi:[1,0]
    v_pk_mul_f32 v[164:165], v[164:165], v[224:225] op_sel_hi:[1,0]
    v_pk_mul_f32 v[166:167], v[166:167], v[224:225] op_sel_hi:[1,0]
    v_cvt_pk_bf16_f32 v32, v160, v161
    v_cvt_pk_bf16_f32 v33, v162, v163
    v_cvt_pk_bf16_f32 v34, v164, v165
    v_cvt_pk_bf16_f32 v35, v166, v167
    ds_write_b128 v18, v[32:35] offset:0
    v_pk_mul_f32 v[192:193], v[192:193], v[226:227] op_sel_hi:[1,0]
    v_pk_mul_f32 v[194:195], v[194:195], v[226:227] op_sel_hi:[1,0]
    v_pk_mul_f32 v[196:197], v[196:197], v[226:227] op_sel_hi:[1,0]
    v_pk_mul_f32 v[198:199], v[198:199], v[226:227] op_sel_hi:[1,0]
    v_cvt_pk_bf16_f32 v36, v192, v193
    v_cvt_pk_bf16_f32 v37, v194, v195
    v_cvt_pk_bf16_f32 v38, v196, v197
    v_cvt_pk_bf16_f32 v39, v198, v199
    ds_write_b128 v18, v[36:39] offset:64
    v_pk_mul_f32 v[168:169], v[168:169], v[228:229] op_sel_hi:[1,0]
    v_pk_mul_f32 v[170:171], v[170:171], v[228:229] op_sel_hi:[1,0]
    v_pk_mul_f32 v[172:173], v[172:173], v[228:229] op_sel_hi:[1,0]
    v_pk_mul_f32 v[174:175], v[174:175], v[228:229] op_sel_hi:[1,0]
    v_cvt_pk_bf16_f32 v40, v168, v169
    v_cvt_pk_bf16_f32 v41, v170, v171
    v_cvt_pk_bf16_f32 v42, v172, v173
    v_cvt_pk_bf16_f32 v43, v174, v175
    ds_write_b128 v18, v[40:43] offset:2304
    v_pk_mul_f32 v[200:201], v[200:201], v[230:231] op_sel_hi:[1,0]
    v_pk_mul_f32 v[202:203], v[202:203], v[230:231] op_sel_hi:[1,0]
    v_pk_mul_f32 v[204:205], v[204:205], v[230:231] op_sel_hi:[1,0]
    v_pk_mul_f32 v[206:207], v[206:207], v[230:231] op_sel_hi:[1,0]
    v_cvt_pk_bf16_f32 v44, v200, v201
    v_cvt_pk_bf16_f32 v45, v202, v203
    v_cvt_pk_bf16_f32 v46, v204, v205
    v_cvt_pk_bf16_f32 v47, v206, v207
    ds_write_b128 v18, v[44:47] offset:2368
    v_pk_mul_f32 v[176:177], v[176:177], v[232:233] op_sel_hi:[1,0]
    v_pk_mul_f32 v[178:179], v[178:179], v[232:233] op_sel_hi:[1,0]
    v_pk_mul_f32 v[180:181], v[180:181], v[232:233] op_sel_hi:[1,0]
    v_pk_mul_f32 v[182:183], v[182:183], v[232:233] op_sel_hi:[1,0]
    v_cvt_pk_bf16_f32 v48, v176, v177
    v_cvt_pk_bf16_f32 v49, v178, v179
    v_cvt_pk_bf16_f32 v50, v180, v181
    v_cvt_pk_bf16_f32 v51, v182, v183
    ds_write_b128 v18, v[48:51] offset:18432
    v_pk_mul_f32 v[208:209], v[208:209], v[234:235] op_sel_hi:[1,0]
    v_pk_mul_f32 v[210:211], v[210:211], v[234:235] op_sel_hi:[1,0]
    v_pk_mul_f32 v[212:213], v[212:213], v[234:235] op_sel_hi:[1,0]
    v_pk_mul_f32 v[214:215], v[214:215], v[234:235] op_sel_hi:[1,0]
    v_cvt_pk_bf16_f32 v52, v208, v209
    v_cvt_pk_bf16_f32 v53, v210, v211
    v_cvt_pk_bf16_f32 v54, v212, v213
    v_cvt_pk_bf16_f32 v55, v214, v215
    ds_write_b128 v18, v[52:55] offset:18496
    v_pk_mul_f32 v[184:185], v[184:185], v[236:237] op_sel_hi:[1,0]
    v_pk_mul_f32 v[186:187], v[186:187], v[236:237] op_sel_hi:[1,0]
    v_pk_mul_f32 v[188:189], v[188:189], v[236:237] op_sel_hi:[1,0]
    v_pk_mul_f32 v[190:191], v[190:191], v[236:237] op_sel_hi:[1,0]
    v_cvt_pk_bf16_f32 v56, v184, v185
    v_cvt_pk_bf16_f32 v57, v186, v187
    v_cvt_pk_bf16_f32 v58, v188, v189
    v_cvt_pk_bf16_f32 v59, v190, v191
    ds_write_b128 v18, v[56:59] offset:20736
    v_pk_mul_f32 v[216:217], v[216:217], v[238:239] op_sel_hi:[1,0]
    v_pk_mul_f32 v[218:219], v[218:219], v[238:239] op_sel_hi:[1,0]
    v_pk_mul_f32 v[220:221], v[220:221], v[238:239] op_sel_hi:[1,0]
    v_pk_mul_f32 v[222:223], v[222:223], v[238:239] op_sel_hi:[1,0]
    v_cvt_pk_bf16_f32 v60, v216, v217
    v_cvt_pk_bf16_f32 v61, v218, v219
    v_cvt_pk_bf16_f32 v62, v220, v221
    v_cvt_pk_bf16_f32 v63, v222, v223
    ds_write_b128 v18, v[60:63] offset:20800
    s_waitcnt lgkmcnt(0)
    s_barrier
    ds_read_b64_tr_b16 a[64:65], v20 offset:0
    ds_read_b64_tr_b16 a[66:67], v20 offset:576
    ds_read_b64_tr_b16 a[68:69], v20 offset:8
    ds_read_b64_tr_b16 a[70:71], v20 offset:584
    ds_read_b64_tr_b16 a[72:73], v21 offset:0
    ds_read_b64_tr_b16 a[74:75], v21 offset:320
    ds_read_b64_tr_b16 a[76:77], v21 offset:32
    ds_read_b64_tr_b16 a[78:79], v21 offset:352
    ds_read_b64_tr_b16 a[80:81], v20 offset:4608
    ds_read_b64_tr_b16 a[82:83], v20 offset:5184
    ds_read_b64_tr_b16 a[84:85], v20 offset:4616
    ds_read_b64_tr_b16 a[86:87], v20 offset:5192
    ds_read_b64_tr_b16 a[88:89], v21 offset:2560
    ds_read_b64_tr_b16 a[90:91], v21 offset:2880
    ds_read_b64_tr_b16 a[92:93], v21 offset:2592
    ds_read_b64_tr_b16 a[94:95], v21 offset:2912
    ds_read_b64_tr_b16 a[96:97], v20 offset:9216
    ds_read_b64_tr_b16 a[98:99], v20 offset:9792
    ds_read_b64_tr_b16 a[100:101], v20 offset:9224
    ds_read_b64_tr_b16 a[102:103], v20 offset:9800
    ds_read_b64_tr_b16 a[104:105], v21 offset:5120
    ds_read_b64_tr_b16 a[106:107], v21 offset:5440
    ds_read_b64_tr_b16 a[108:109], v21 offset:5152
    ds_read_b64_tr_b16 a[110:111], v21 offset:5472
    ds_read_b64_tr_b16 a[112:113], v20 offset:13824
    ds_read_b64_tr_b16 a[114:115], v20 offset:14400
    ds_read_b64_tr_b16 a[116:117], v20 offset:13832
    ds_read_b64_tr_b16 a[118:119], v20 offset:14408
    ds_read_b64_tr_b16 a[120:121], v21 offset:7680
    ds_read_b64_tr_b16 a[122:123], v21 offset:8000
    ds_read_b64_tr_b16 a[124:125], v21 offset:7712
    ds_read_b64_tr_b16 a[126:127], v21 offset:8032
    s_lshl_b32 s14, s63, 1
    s_mul_i32 s14, s14, 4352
    s_add_u32 s14, s14, 17825792
    s_add_u32 s44, s4, s14
    s_addc_u32 s45, s5, 0
    s_and_b32 s45, s45, 0xffff
    s_mov_b32 s46, 2097664
    s_mov_b32 s47, 0x20000
    s_lshr_b32 s12, s3, 1
    s_mul_i32 s12, s12, 4352
    s_and_b32 s13, s3, 1
    s_lshl_b32 s13, s13, 11
    s_add_u32 s12, s12, s13
    v_add_u32 v16, s12, v2
    v_and_b32 v17, 15, v1
    v_mul_u32_u24 v17, 139264, v17
    v_lshrrev_b32 v18, 4, v1
    v_lshl_add_u32 v17, v18, 4, v17
    v_add_u32 v17, 4096, v17
    s_mov_b32 s15, 4352
    s_add_u32 s24, s4, 5242880
    s_addc_u32 s25, s5, 0
    s_and_b32 s25, s25, 0xffff
    s_mov_b32 s26, 4194304
    s_mov_b32 s27, 0x20000
    s_and_b32 s58, s7, 7
    s_lshr_b32 s59, s7, 3
    s_lshr_b32 s61, s6, 2
    s_lshl_b32 s61, s61, 4
    s_lshl_b32 s40, s58, 1
    s_waitcnt lgkmcnt(15)
    v_mfma_f32_16x16x32_bf16 v[128:131], a[64:67], a[72:75], 0
    s_add_u32 s40, s40, s61
    s_and_b32 s61, s6, 1
    v_mfma_f32_16x16x32_bf16 v[132:135], a[68:71], a[72:75], 0
    s_add_u32 s40, s40, s61
    s_and_b32 s61, s6, 2
    v_mfma_f32_16x16x32_bf16 v[136:139], a[64:67], a[76:79], 0
    s_lshl_b32 s61, s61, 1
    s_add_u32 s41, s61, s59
    v_mfma_f32_16x16x32_bf16 v[140:143], a[68:71], a[76:79], 0
    s_and_b32 s58, s7, 7
    s_lshr_b32 s59, s7, 3
    v_mfma_f32_16x16x32_bf16 v[144:147], a[64:67], v[24:27], 0
    s_lshl_b32 s60, s59, 1
    s_add_u32 s60, s60, s58
    v_mfma_f32_16x16x32_bf16 v[148:151], a[68:71], v[24:27], 0
    s_and_b32 s60, s60, 0
    s_mul_i32 s61, s3, 131072
    s_waitcnt lgkmcnt(15)
    v_mfma_f32_16x16x32_bf16 v[128:131], a[80:83], a[88:91], v[128:131]
    v_add_u32 v3, s61, v2
    s_xor_b32 s61, s3, 0
    v_mfma_f32_16x16x32_bf16 v[132:135], a[84:87], a[88:91], v[132:135]
    s_lshl_b32 s61, s61, 10
    v_add_u32 v4, s61, v3
    v_mfma_f32_16x16x32_bf16 v[136:139], a[80:83], a[92:95], v[136:139]
    s_xor_b32 s61, s3, 1
    s_lshl_b32 s61, s61, 10
    v_mfma_f32_16x16x32_bf16 v[140:143], a[84:87], a[92:95], v[140:143]
    v_add_u32 v5, s61, v3
    s_xor_b32 s61, s3, 2
    v_mfma_f32_16x16x32_bf16 v[144:147], a[80:83], v[24:27], v[144:147]
    s_lshl_b32 s61, s61, 10
    v_add_u32 v6, s61, v3
    v_mfma_f32_16x16x32_bf16 v[148:151], a[84:87], v[24:27], v[148:151]
    s_xor_b32 s61, s3, 3
    s_lshl_b32 s61, s61, 10
    s_waitcnt lgkmcnt(8)
    v_mfma_f32_16x16x32_bf16 v[128:131], a[96:99], a[104:107], v[128:131]
    v_add_u32 v7, s61, v3
    v_lshrrev_b32 v12, 4, v1
    v_mfma_f32_16x16x32_bf16 v[132:135], a[100:103], a[104:107], v[132:135]
    v_and_b32 v13, 15, v1
    v_lshlrev_b32 v14, 2, v12
    v_mfma_f32_16x16x32_bf16 v[136:139], a[96:99], a[108:111], v[136:139]
    v_xor_b32 v13, v13, v14
    v_lshlrev_b32 v13, 4, v13
    v_mfma_f32_16x16x32_bf16 v[140:143], a[100:103], a[108:111], v[140:143]
    v_lshl_add_u32 v13, v12, 11, v13
    s_mul_i32 s61, s3, 65536
    v_mfma_f32_16x16x32_bf16 v[144:147], a[96:99], v[24:27], v[144:147]
    v_add_u32 v8, s61, v13
    v_add_u32 v9, 7168, v8
    v_mfma_f32_16x16x32_bf16 v[148:151], a[100:103], v[24:27], v[148:151]
    v_add_u32 v10, 14336, v8
    v_add_u32 v11, 21504, v8
    s_waitcnt lgkmcnt(0)
    v_mfma_f32_16x16x32_bf16 v[128:131], a[112:115], a[120:123], v[128:131]
    s_lshl_b32 s52, s3, 13
    v_bfe_u32 v13, v1, 2, 2
    v_mfma_f32_16x16x32_bf16 v[132:135], a[116:119], a[120:123], v[132:135]
    v_and_b32 v14, 3, v1
    v_lshlrev_b32 v3, 10, v12
    v_mfma_f32_16x16x32_bf16 v[136:139], a[112:115], a[124:127], v[136:139]
    v_lshl_add_u32 v3, v13, 8, v3
    v_lshl_add_u32 v3, v14, 4, v3
    v_mfma_f32_16x16x32_bf16 v[140:143], a[116:119], a[124:127], v[140:143]
    v_add_u32 v3, s52, v3
    v_xor_b32 v15, 3, v13
    v_mfma_f32_16x16x32_bf16 v[144:147], a[112:115], v[24:27], v[144:147]
    v_lshl_add_u32 v15, v15, 6, v3
    v_xor_b32 v14, 2, v13
    v_mfma_f32_16x16x32_bf16 v[148:151], a[116:119], v[24:27], v[148:151]
    v_lshl_add_u32 v14, v14, 6, v3
    v_xor_b32 v12, 0, v13
    v_lshl_add_u32 v12, v12, 6, v3
    v_xor_b32 v13, 1, v13
    v_lshl_add_u32 v13, v13, 6, v3
    s_lshl_b32 s61, s40, 12
    s_sub_u32 s53, 4194304, s61
    s_add_u32 s61, s61, 5242880
    s_add_u32 s32, s4, s61
    s_addc_u32 s33, s5, 0
    v_cvt_pk_bf16_f32 v64, v128, v129
    v_cvt_pk_bf16_f32 v65, v130, v131
    v_cvt_pk_bf16_f32 v66, v132, v133
    v_cvt_pk_bf16_f32 v67, v134, v135
    buffer_store_dwordx4 v[64:67], v22, s[16:19], 0 offen offset:0 sc1
    v_cvt_pk_bf16_f32 v68, v136, v137
    v_cvt_pk_bf16_f32 v69, v138, v139
    v_cvt_pk_bf16_f32 v70, v140, v141
    v_cvt_pk_bf16_f32 v71, v142, v143
    buffer_store_dwordx4 v[68:71], v22, s[16:19], 0 offen offset:1024 sc1
    v_cvt_pk_bf16_f32 v72, v144, v145
    v_cvt_pk_bf16_f32 v73, v146, v147
    v_cvt_pk_bf16_f32 v74, v148, v149
    v_cvt_pk_bf16_f32 v75, v150, v151
    buffer_store_dwordx4 v[72:75], v23, s[16:19], 0 offen sc1
    s_and_b32 s33, s33, 0xffff
    s_mov_b32 s34, s53
    s_mov_b32 s35, 0x20000
    s_lshl_b32 s61, s41, 8
    s_sub_u32 s53, 2097152, s61
    s_add_u32 s36, s70, s61
    s_addc_u32 s37, s71, 0
    s_and_b32 s37, s37, 0xffff
    s_mov_b32 s38, s53
    s_mov_b32 s39, 0x20000
    s_mov_b32 s58, 0
    s_mov_b32 s59, s60
    v_max3_f32 v224, v96, v97, v98
    v_max3_f32 v225, v99, v100, v101
    v_max3_f32 v226, -v96, -v97, -v98
    v_max3_f32 v227, -v99, -v100, -v101
    v_max3_f32 v224, v224, v102, v103
    v_max3_f32 v226, v226, -v102, -v103
    v_max_f32 v224, v224, v225
    v_max_f32 v226, v226, v227
    v_max3_f32 v228, v104, v105, v106
    v_max3_f32 v229, v107, v108, v109
    v_max3_f32 v230, -v104, -v105, -v106
    v_max3_f32 v231, -v107, -v108, -v109
    v_max3_f32 v228, v228, v110, v111
    v_max3_f32 v230, v230, -v110, -v111
    v_max_f32 v228, v228, v229
    v_max_f32 v230, v230, v231
    v_max3_f32 v232, v112, v113, v114
    v_max3_f32 v233, v115, v116, v117
    v_max3_f32 v234, -v112, -v113, -v114
    v_max3_f32 v235, -v115, -v116, -v117
    v_max3_f32 v232, v232, v118, v119
    v_max3_f32 v234, v234, -v118, -v119
    v_max_f32 v232, v232, v233
    v_max_f32 v234, v234, v235
    v_max3_f32 v236, v120, v121, v122
    v_max3_f32 v237, v123, v124, v125
    v_max3_f32 v238, -v120, -v121, -v122
    v_max3_f32 v239, -v123, -v124, -v125
    v_max3_f32 v236, v236, v126, v127
    v_max3_f32 v238, v238, -v126, -v127
    v_max_f32 v236, v236, v237
    v_max_f32 v238, v238, v239
    s_nop 1
    v_permlane16_swap_b32 v224, v226
    v_permlane16_swap_b32 v228, v230
    v_permlane16_swap_b32 v232, v234
    v_permlane16_swap_b32 v236, v238
    v_max_f32 v224, v224, v226
    v_max_f32 v228, v228, v230
    v_max_f32 v232, v232, v234
    v_max_f32 v236, v236, v238
    v_mov_b32 v226, v224
    v_mov_b32 v230, v228
    v_mov_b32 v234, v232
    v_mov_b32 v238, v236
    s_nop 1
    v_permlane32_swap_b32 v224, v226
    v_permlane32_swap_b32 v228, v230
    v_permlane32_swap_b32 v232, v234
    v_permlane32_swap_b32 v236, v238
    v_max_f32 v224, v224, v226
    v_max_f32 v228, v228, v230
    v_max_f32 v232, v232, v234
    v_max_f32 v236, v236, v238
    v_mul_f32 v224, s10, v224
    v_mul_f32 v228, s10, v228
    v_mul_f32 v232, s10, v232
    v_mul_f32 v236, s10, v236
    s_nop 0
    v_mov_b32 v226, v224
    v_mov_b32 v230, v228
    v_mov_b32 v234, v232
    v_mov_b32 v238, v236
    s_nop 1
    v_permlane16_swap_b32 v224, v226
    v_permlane16_swap_b32 v228, v230
    v_permlane16_swap_b32 v232, v234
    v_permlane16_swap_b32 v236, v238
    v_pk_fma_f32 v[160:161], v[96:97], s[8:9], v[224:225] op_sel_hi:[1,1,0]
    v_pk_fma_f32 v[192:193], v[96:97], s[10:11], v[226:227] op_sel_hi:[1,1,0]
    v_pk_fma_f32 v[162:163], v[98:99], s[8:9], v[224:225] op_sel_hi:[1,1,0]
    v_pk_fma_f32 v[194:195], v[98:99], s[10:11], v[226:227] op_sel_hi:[1,1,0]
    v_pk_fma_f32 v[164:165], v[100:101], s[8:9], v[224:225] op_sel_hi:[1,1,0]
    v_pk_fma_f32 v[196:197], v[100:101], s[10:11], v[226:227] op_sel_hi:[1,1,0]
    v_pk_fma_f32 v[166:167], v[102:103], s[8:9], v[224:225] op_sel_hi:[1,1,0]
    v_pk_fma_f32 v[198:199], v[102:103], s[10:11], v[226:227] op_sel_hi:[1,1,0]
    v_exp_f32 v160, v160
    v_exp_f32 v192, v192
    v_exp_f32 v161, v161
    v_exp_f32 v193, v193
    v_exp_f32 v162, v162
    v_exp_f32 v194, v194
    v_exp_f32 v163, v163
    v_exp_f32 v195, v195
    v_exp_f32 v164, v164
    v_exp_f32 v196, v196
    v_exp_f32 v165, v165
    v_exp_f32 v197, v197
    v_exp_f32 v166, v166
    v_exp_f32 v198, v198
    v_exp_f32 v167, v167
    v_exp_f32 v199, v199
    v_pk_fma_f32 v[168:169], v[104:105], s[8:9], v[228:229] op_sel_hi:[1,1,0]
    v_pk_fma_f32 v[200:201], v[104:105], s[10:11], v[230:231] op_sel_hi:[1,1,0]
    v_pk_fma_f32 v[170:171], v[106:107], s[8:9], v[228:229] op_sel_hi:[1,1,0]
    v_pk_fma_f32 v[202:203], v[106:107], s[10:11], v[230:231] op_sel_hi:[1,1,0]
    v_pk_fma_f32 v[172:173], v[108:109], s[8:9], v[228:229] op_sel_hi:[1,1,0]
    v_pk_fma_f32 v[204:205], v[108:109], s[10:11], v[230:231] op_sel_hi:[1,1,0]
    v_pk_fma_f32 v[174:175], v[110:111], s[8:9], v[228:229] op_sel_hi:[1,1,0]
    v_pk_fma_f32 v[206:207], v[110:111], s[10:11], v[230:231] op_sel_hi:[1,1,0]
    v_exp_f32 v168, v168
    v_exp_f32 v200, v200
    v_exp_f32 v169, v169
    v_exp_f32 v201, v201
    v_exp_f32 v170, v170
    v_exp_f32 v202, v202
    v_exp_f32 v171, v171
    v_exp_f32 v203, v203
    v_exp_f32 v172, v172
    v_exp_f32 v204, v204
    v_exp_f32 v173, v173
    v_exp_f32 v205, v205
    v_exp_f32 v174, v174
    v_exp_f32 v206, v206
    v_exp_f32 v175, v175
    v_exp_f32 v207, v207
    v_pk_fma_f32 v[176:177], v[112:113], s[8:9], v[232:233] op_sel_hi:[1,1,0]
    v_pk_fma_f32 v[208:209], v[112:113], s[10:11], v[234:235] op_sel_hi:[1,1,0]
    v_pk_fma_f32 v[178:179], v[114:115], s[8:9], v[232:233] op_sel_hi:[1,1,0]
    v_pk_fma_f32 v[210:211], v[114:115], s[10:11], v[234:235] op_sel_hi:[1,1,0]
    v_pk_fma_f32 v[180:181], v[116:117], s[8:9], v[232:233] op_sel_hi:[1,1,0]
    v_pk_fma_f32 v[212:213], v[116:117], s[10:11], v[234:235] op_sel_hi:[1,1,0]
    v_pk_fma_f32 v[182:183], v[118:119], s[8:9], v[232:233] op_sel_hi:[1,1,0]
    v_pk_fma_f32 v[214:215], v[118:119], s[10:11], v[234:235] op_sel_hi:[1,1,0]
    v_exp_f32 v176, v176
    v_exp_f32 v208, v208
    v_exp_f32 v177, v177
    v_exp_f32 v209, v209
    v_exp_f32 v178, v178
    v_exp_f32 v210, v210
    v_exp_f32 v179, v179
    v_exp_f32 v211, v211
    v_exp_f32 v180, v180
    v_exp_f32 v212, v212
    v_exp_f32 v181, v181
    v_exp_f32 v213, v213
    v_exp_f32 v182, v182
    v_exp_f32 v214, v214
    v_exp_f32 v183, v183
    v_exp_f32 v215, v215
    v_pk_fma_f32 v[184:185], v[120:121], s[8:9], v[236:237] op_sel_hi:[1,1,0]
    v_pk_fma_f32 v[216:217], v[120:121], s[10:11], v[238:239] op_sel_hi:[1,1,0]
    v_pk_fma_f32 v[186:187], v[122:123], s[8:9], v[236:237] op_sel_hi:[1,1,0]
    v_pk_fma_f32 v[218:219], v[122:123], s[10:11], v[238:239] op_sel_hi:[1,1,0]
    v_pk_fma_f32 v[188:189], v[124:125], s[8:9], v[236:237] op_sel_hi:[1,1,0]
    v_pk_fma_f32 v[220:221], v[124:125], s[10:11], v[238:239] op_sel_hi:[1,1,0]
    v_pk_fma_f32 v[190:191], v[126:127], s[8:9], v[236:237] op_sel_hi:[1,1,0]
    v_pk_fma_f32 v[222:223], v[126:127], s[10:11], v[238:239] op_sel_hi:[1,1,0]
    v_exp_f32 v184, v184
    v_exp_f32 v216, v216
    v_exp_f32 v185, v185
    v_exp_f32 v217, v217
    v_exp_f32 v186, v186
    v_exp_f32 v218, v218
    v_exp_f32 v187, v187
    v_exp_f32 v219, v219
    v_exp_f32 v188, v188
    v_exp_f32 v220, v220
    v_exp_f32 v189, v189
    v_exp_f32 v221, v221
    v_exp_f32 v190, v190
    v_exp_f32 v222, v222
    v_exp_f32 v191, v191
    v_exp_f32 v223, v223
    s_nop 0
    v_pk_add_f32 v[240:241], v[160:161], v[162:163]
    v_pk_add_f32 v[242:243], v[164:165], v[166:167]
    v_pk_add_f32 v[244:245], v[192:193], v[194:195]
    v_pk_add_f32 v[246:247], v[196:197], v[198:199]
    v_pk_add_f32 v[240:241], v[240:241], v[242:243]
    v_pk_add_f32 v[244:245], v[244:245], v[246:247]
    v_add_f32 v224, v240, v241
    v_add_f32 v226, v244, v245
    v_pk_add_f32 v[240:241], v[168:169], v[170:171]
    v_pk_add_f32 v[242:243], v[172:173], v[174:175]
    v_pk_add_f32 v[244:245], v[200:201], v[202:203]
    v_pk_add_f32 v[246:247], v[204:205], v[206:207]
    v_pk_add_f32 v[240:241], v[240:241], v[242:243]
    v_pk_add_f32 v[244:245], v[244:245], v[246:247]
    v_add_f32 v228, v240, v241
    v_add_f32 v230, v244, v245
    v_pk_add_f32 v[240:241], v[176:177], v[178:179]
    v_pk_add_f32 v[242:243], v[180:181], v[182:183]
    v_pk_add_f32 v[244:245], v[208:209], v[210:211]
    v_pk_add_f32 v[246:247], v[212:213], v[214:215]
    v_pk_add_f32 v[240:241], v[240:241], v[242:243]
    v_pk_add_f32 v[244:245], v[244:245], v[246:247]
    v_add_f32 v232, v240, v241
    v_add_f32 v234, v244, v245
    v_pk_add_f32 v[240:241], v[184:185], v[186:187]
    v_pk_add_f32 v[242:243], v[188:189], v[190:191]
    v_pk_add_f32 v[244:245], v[216:217], v[218:219]
    v_pk_add_f32 v[246:247], v[220:221], v[222:223]
    v_pk_add_f32 v[240:241], v[240:241], v[242:243]
    v_pk_add_f32 v[244:245], v[244:245], v[246:247]
    v_add_f32 v236, v240, v241
    v_add_f32 v238, v244, v245
    s_nop 1
    v_permlane16_swap_b32 v224, v226
    v_permlane16_swap_b32 v228, v230
    v_permlane16_swap_b32 v232, v234
    v_permlane16_swap_b32 v236, v238
    v_add_f32 v224, v224, v226
    v_add_f32 v228, v228, v230
    s_add_u32 s12, s62, 0
    s_and_b32 s12, s12, 15
    s_mul_i32 s12, s12, 139264
    buffer_load_dwordx4 v[128:131], v16, s[44:47], s12 offen sc1
    v_add_f32 v232, v232, v234
    v_add_f32 v236, v236, v238
    v_mov_b32 v226, v224
    v_mov_b32 v230, v228
    buffer_load_dwordx4 v[132:135], v16, s[44:47], s12 offen offset:1024 sc1
    v_mov_b32 v234, v232
    v_mov_b32 v238, v236
    s_nop 1
    v_permlane32_swap_b32 v224, v226
    s_add_u32 s12, s62, 1
    s_and_b32 s12, s12, 15
    s_mul_i32 s12, s12, 139264
    buffer_load_dwordx4 v[136:139], v16, s[44:47], s12 offen sc1
    v_permlane32_swap_b32 v228, v230
    v_permlane32_swap_b32 v232, v234
    v_permlane32_swap_b32 v236, v238
    v_add_f32 v224, v224, v226
    buffer_load_dwordx4 v[140:143], v16, s[44:47], s12 offen offset:1024 sc1
    v_add_f32 v228, v228, v230
    v_add_f32 v232, v232, v234
    v_add_f32 v236, v236, v238
    v_rcp_f32 v224, v224
    s_add_u32 s12, s62, 2
    s_and_b32 s12, s12, 15
    s_mul_i32 s12, s12, 139264
    buffer_load_dwordx4 v[144:147], v16, s[44:47], s12 offen sc1
    v_rcp_f32 v228, v228
    v_rcp_f32 v232, v232
    v_rcp_f32 v236, v236
    s_nop 0
    v_mov_b32 v226, v224
    v_mov_b32 v230, v228
    v_mov_b32 v234, v232
    v_mov_b32 v238, v236
    buffer_load_dwordx4 v[148:151], v16, s[44:47], s12 offen offset:1024 sc1
    s_nop 1
    v_permlane16_swap_b32 v224, v226
    v_permlane16_swap_b32 v228, v230
    v_permlane16_swap_b32 v232, v234
    s_add_u32 s12, s62, 3
    s_and_b32 s12, s12, 15
    s_mul_i32 s12, s12, 139264
    buffer_load_dwordx4 v[152:155], v16, s[44:47], s12 offen sc1
    v_permlane16_swap_b32 v236, v238
    v_pk_mul_f32 v[160:161], v[160:161], v[224:225] op_sel_hi:[1,0]
    v_pk_mul_f32 v[162:163], v[162:163], v[224:225] op_sel_hi:[1,0]
    v_pk_mul_f32 v[164:165], v[164:165], v[224:225] op_sel_hi:[1,0]
    buffer_load_dwordx4 v[156:159], v16, s[44:47], s12 offen offset:1024 sc1
    v_pk_mul_f32 v[166:167], v[166:167], v[224:225] op_sel_hi:[1,0]
    v_cvt_pk_bf16_f32 v32, v160, v161
    v_cvt_pk_bf16_f32 v33, v162, v163
    v_cvt_pk_bf16_f32 v34, v164, v165
    v_cvt_pk_bf16_f32 v35, v166, v167
    v_pk_mul_f32 v[192:193], v[192:193], v[226:227] op_sel_hi:[1,0]
    v_pk_mul_f32 v[194:195], v[194:195], v[226:227] op_sel_hi:[1,0]
    v_pk_mul_f32 v[196:197], v[196:197], v[226:227] op_sel_hi:[1,0]
    v_pk_mul_f32 v[198:199], v[198:199], v[226:227] op_sel_hi:[1,0]
    v_cvt_pk_bf16_f32 v36, v192, v193
    v_cvt_pk_bf16_f32 v37, v194, v195
    v_cvt_pk_bf16_f32 v38, v196, v197
    v_cvt_pk_bf16_f32 v39, v198, v199
    v_pk_mul_f32 v[168:169], v[168:169], v[228:229] op_sel_hi:[1,0]
    v_pk_mul_f32 v[170:171], v[170:171], v[228:229] op_sel_hi:[1,0]
    v_pk_mul_f32 v[172:173], v[172:173], v[228:229] op_sel_hi:[1,0]
    v_pk_mul_f32 v[174:175], v[174:175], v[228:229] op_sel_hi:[1,0]
    v_cvt_pk_bf16_f32 v40, v168, v169
    v_cvt_pk_bf16_f32 v41, v170, v171
    v_cvt_pk_bf16_f32 v42, v172, v173
    v_cvt_pk_bf16_f32 v43, v174, v175
    v_pk_mul_f32 v[200:201], v[200:201], v[230:231] op_sel_hi:[1,0]
    v_pk_mul_f32 v[202:203], v[202:203], v[230:231] op_sel_hi:[1,0]
    v_pk_mul_f32 v[204:205], v[204:205], v[230:231] op_sel_hi:[1,0]
    v_pk_mul_f32 v[206:207], v[206:207], v[230:231] op_sel_hi:[1,0]
    v_cvt_pk_bf16_f32 v44, v200, v201
    v_cvt_pk_bf16_f32 v45, v202, v203
    v_cvt_pk_bf16_f32 v46, v204, v205
    v_cvt_pk_bf16_f32 v47, v206, v207
    v_pk_mul_f32 v[176:177], v[176:177], v[232:233] op_sel_hi:[1,0]
    v_pk_mul_f32 v[178:179], v[178:179], v[232:233] op_sel_hi:[1,0]
    v_pk_mul_f32 v[180:181], v[180:181], v[232:233] op_sel_hi:[1,0]
    v_pk_mul_f32 v[182:183], v[182:183], v[232:233] op_sel_hi:[1,0]
    v_cvt_pk_bf16_f32 v48, v176, v177
    v_cvt_pk_bf16_f32 v49, v178, v179
    v_cvt_pk_bf16_f32 v50, v180, v181
    v_cvt_pk_bf16_f32 v51, v182, v183
    v_pk_mul_f32 v[208:209], v[208:209], v[234:235] op_sel_hi:[1,0]
    v_pk_mul_f32 v[210:211], v[210:211], v[234:235] op_sel_hi:[1,0]
    v_pk_mul_f32 v[212:213], v[212:213], v[234:235] op_sel_hi:[1,0]
    v_pk_mul_f32 v[214:215], v[214:215], v[234:235] op_sel_hi:[1,0]
    v_cvt_pk_bf16_f32 v52, v208, v209
    v_cvt_pk_bf16_f32 v53, v210, v211
    v_cvt_pk_bf16_f32 v54, v212, v213
    v_cvt_pk_bf16_f32 v55, v214, v215
    v_pk_mul_f32 v[184:185], v[184:185], v[236:237] op_sel_hi:[1,0]
    v_pk_mul_f32 v[186:187], v[186:187], v[236:237] op_sel_hi:[1,0]
    v_pk_mul_f32 v[188:189], v[188:189], v[236:237] op_sel_hi:[1,0]
    v_pk_mul_f32 v[190:191], v[190:191], v[236:237] op_sel_hi:[1,0]
    v_cvt_pk_bf16_f32 v56, v184, v185
    v_cvt_pk_bf16_f32 v57, v186, v187
    v_cvt_pk_bf16_f32 v58, v188, v189
    v_cvt_pk_bf16_f32 v59, v190, v191
    v_pk_mul_f32 v[216:217], v[216:217], v[238:239] op_sel_hi:[1,0]
    v_pk_mul_f32 v[218:219], v[218:219], v[238:239] op_sel_hi:[1,0]
    v_pk_mul_f32 v[220:221], v[220:221], v[238:239] op_sel_hi:[1,0]
    v_pk_mul_f32 v[222:223], v[222:223], v[238:239] op_sel_hi:[1,0]
    v_cvt_pk_bf16_f32 v60, v216, v217
    v_cvt_pk_bf16_f32 v61, v218, v219
    v_cvt_pk_bf16_f32 v62, v220, v221
    v_cvt_pk_bf16_f32 v63, v222, v223
    s_add_u32 s12, s62, 4
    s_and_b32 s12, s12, 15
    s_mul_i32 s12, s12, 139264
    buffer_load_dwordx4 v[160:163], v16, s[44:47], s12 offen sc1
    buffer_load_dwordx4 v[164:167], v16, s[44:47], s12 offen offset:1024 sc1
    s_add_u32 s12, s62, 5
    s_and_b32 s12, s12, 15
    s_mul_i32 s12, s12, 139264
    buffer_load_dwordx4 v[168:171], v16, s[44:47], s12 offen sc1
    buffer_load_dwordx4 v[172:175], v16, s[44:47], s12 offen offset:1024 sc1
    s_add_u32 s12, s62, 6
    s_and_b32 s12, s12, 15
    s_mul_i32 s12, s12, 139264
    buffer_load_dwordx4 v[176:179], v16, s[44:47], s12 offen sc1
    buffer_load_dwordx4 v[180:183], v16, s[44:47], s12 offen offset:1024 sc1
    s_add_u32 s12, s62, 7
    s_and_b32 s12, s12, 15
    s_mul_i32 s12, s12, 139264
    buffer_load_dwordx4 v[184:187], v16, s[44:47], s12 offen sc1
    buffer_load_dwordx4 v[188:191], v16, s[44:47], s12 offen offset:1024 sc1
    s_barrier
    s_mov_b32 s97, 0
    s_waitcnt vmcnt(8)
kchk_adaLN_cond__linear_kernel_hedgehog__glu_gated_swiglu__prompt_kernel_21:
    v_max3_u32 v28, v128, v129, v130
    v_max_u32 v29, v131, v131
    v_max3_u32 v28, v28, v132, v133
    v_max3_u32 v29, v29, v134, v135
    v_max3_u32 v28, v28, v136, v137
    v_max3_u32 v29, v29, v138, v139
    v_max3_u32 v28, v28, v140, v141
    v_max3_u32 v29, v29, v142, v143
    v_max3_u32 v28, v28, v144, v145
    v_max3_u32 v29, v29, v146, v147
    v_max3_u32 v28, v28, v148, v149
    v_max3_u32 v29, v29, v150, v151
    v_max3_u32 v28, v28, v152, v153
    v_max3_u32 v29, v29, v154, v155
    v_max3_u32 v28, v28, v156, v157
    v_max3_u32 v29, v29, v158, v159
    v_max_u32 v28, v28, v29
    v_cmp_eq_u32 vcc, -1, v28
    s_cbranch_vccz kok_adaLN_cond__linear_kernel_hedgehog__glu_gated_swiglu__prompt_kernel_22
    s_add_u32 s97, s97, 1
    s_cmp_ge_u32 s97, 20000
    s_cbranch_scc1 kok_adaLN_cond__linear_kernel_hedgehog__glu_gated_swiglu__prompt_kernel_22
    s_add_u32 s12, s62, 0
    s_and_b32 s12, s12, 15
    s_mul_i32 s12, s12, 139264
    buffer_load_dwordx4 v[128:131], v16, s[44:47], s12 offen sc1
    buffer_load_dwordx4 v[132:135], v16, s[44:47], s12 offen offset:1024 sc1
    s_add_u32 s12, s62, 1
    s_and_b32 s12, s12, 15
    s_mul_i32 s12, s12, 139264
    buffer_load_dwordx4 v[136:139], v16, s[44:47], s12 offen sc1
    buffer_load_dwordx4 v[140:143], v16, s[44:47], s12 offen offset:1024 sc1
    s_add_u32 s12, s62, 2
    s_and_b32 s12, s12, 15
    s_mul_i32 s12, s12, 139264
    buffer_load_dwordx4 v[144:147], v16, s[44:47], s12 offen sc1
    buffer_load_dwordx4 v[148:151], v16, s[44:47], s12 offen offset:1024 sc1
    s_add_u32 s12, s62, 3
    s_and_b32 s12, s12, 15
    s_mul_i32 s12, s12, 139264
    buffer_load_dwordx4 v[152:155], v16, s[44:47], s12 offen sc1
    buffer_load_dwordx4 v[156:159], v16, s[44:47], s12 offen offset:1024 sc1
    s_waitcnt vmcnt(0)
    s_branch kchk_adaLN_cond__linear_kernel_hedgehog__glu_gated_swiglu__prompt_kernel_21
kok_adaLN_cond__linear_kernel_hedgehog__glu_gated_swiglu__prompt_kernel_22:
    s_add_u32 s12, s62, 8
    s_and_b32 s12, s12, 15
    s_mul_i32 s12, s12, 139264
    buffer_load_dwordx4 v[192:195], v16, s[44:47], s12 offen sc1
    buffer_load_dwordx4 v[196:199], v16, s[44:47], s12 offen offset:1024 sc1
    v_lshlrev_b32 v80, 16, v128
    v_and_b32 v81, 0xffff0000, v128
    v_lshlrev_b32 v82, 16, v129
    v_and_b32 v83, 0xffff0000, v129
    v_lshlrev_b32 v84, 16, v130
    v_and_b32 v85, 0xffff0000, v130
    v_lshlrev_b32 v86, 16, v131
    v_and_b32 v87, 0xffff0000, v131
    v_lshlrev_b32 v88, 16, v132
    v_and_b32 v89, 0xffff0000, v132
    v_lshlrev_b32 v90, 16, v133
    v_and_b32 v91, 0xffff0000, v133
    v_lshlrev_b32 v92, 16, v134
    v_and_b32 v93, 0xffff0000, v134
    v_lshlrev_b32 v94, 16, v135
    v_and_b32 v95, 0xffff0000, v135
    s_add_u32 s12, s62, 9
    s_and_b32 s12, s12, 15
    s_mul_i32 s12, s12, 139264
    buffer_load_dwordx4 v[200:203], v16, s[44:47], s12 offen sc1
    buffer_load_dwordx4 v[204:207], v16, s[44:47], s12 offen offset:1024 sc1
    v_lshlrev_b32 v96, 16, v136
    v_and_b32 v97, 0xffff0000, v136
    v_lshlrev_b32 v98, 16, v137
    v_and_b32 v99, 0xffff0000, v137
    v_lshlrev_b32 v100, 16, v138
    v_and_b32 v101, 0xffff0000, v138
    v_lshlrev_b32 v102, 16, v139
    v_and_b32 v103, 0xffff0000, v139
    v_lshlrev_b32 v104, 16, v140
    v_and_b32 v105, 0xffff0000, v140
    v_lshlrev_b32 v106, 16, v141
    v_and_b32 v107, 0xffff0000, v141
    v_lshlrev_b32 v108, 16, v142
    v_and_b32 v109, 0xffff0000, v142
    v_lshlrev_b32 v110, 16, v143
    v_and_b32 v111, 0xffff0000, v143
    v_pk_add_f32 v[80:81], v[80:81], v[96:97]
    v_pk_add_f32 v[82:83], v[82:83], v[98:99]
    v_pk_add_f32 v[84:85], v[84:85], v[100:101]
    v_pk_add_f32 v[86:87], v[86:87], v[102:103]
    v_pk_add_f32 v[88:89], v[88:89], v[104:105]
    v_pk_add_f32 v[90:91], v[90:91], v[106:107]
    v_pk_add_f32 v[92:93], v[92:93], v[108:109]
    v_pk_add_f32 v[94:95], v[94:95], v[110:111]
    s_add_u32 s12, s62, 10
    s_and_b32 s12, s12, 15
    s_mul_i32 s12, s12, 139264
    buffer_load_dwordx4 v[208:211], v16, s[44:47], s12 offen sc1
    buffer_load_dwordx4 v[212:215], v16, s[44:47], s12 offen offset:1024 sc1
    v_lshlrev_b32 v96, 16, v144
    v_and_b32 v97, 0xffff0000, v144
    v_lshlrev_b32 v98, 16, v145
    v_and_b32 v99, 0xffff0000, v145
    v_lshlrev_b32 v100, 16, v146
    v_and_b32 v101, 0xffff0000, v146
    v_lshlrev_b32 v102, 16, v147
    v_and_b32 v103, 0xffff0000, v147
    v_lshlrev_b32 v104, 16, v148
    v_and_b32 v105, 0xffff0000, v148
    v_lshlrev_b32 v106, 16, v149
    v_and_b32 v107, 0xffff0000, v149
    v_lshlrev_b32 v108, 16, v150
    v_and_b32 v109, 0xffff0000, v150
    v_lshlrev_b32 v110, 16, v151
    v_and_b32 v111, 0xffff0000, v151
    v_pk_add_f32 v[80:81], v[80:81], v[96:97]
    v_pk_add_f32 v[82:83], v[82:83], v[98:99]
    v_pk_add_f32 v[84:85], v[84:85], v[100:101]
    v_pk_add_f32 v[86:87], v[86:87], v[102:103]
    v_pk_add_f32 v[88:89], v[88:89], v[104:105]
    v_pk_add_f32 v[90:91], v[90:91], v[106:107]
    v_pk_add_f32 v[92:93], v[92:93], v[108:109]
    v_pk_add_f32 v[94:95], v[94:95], v[110:111]
    s_add_u32 s12, s62, 11
    s_and_b32 s12, s12, 15
    s_mul_i32 s12, s12, 139264
    buffer_load_dwordx4 v[216:219], v16, s[44:47], s12 offen sc1
    buffer_load_dwordx4 v[220:223], v16, s[44:47], s12 offen offset:1024 sc1
    v_lshlrev_b32 v96, 16, v152
    v_and_b32 v97, 0xffff0000, v152
    v_lshlrev_b32 v98, 16, v153
    v_and_b32 v99, 0xffff0000, v153
    v_lshlrev_b32 v100, 16, v154
    v_and_b32 v101, 0xffff0000, v154
    v_lshlrev_b32 v102, 16, v155
    v_and_b32 v103, 0xffff0000, v155
    v_lshlrev_b32 v104, 16, v156
    v_and_b32 v105, 0xffff0000, v156
    v_lshlrev_b32 v106, 16, v157
    v_and_b32 v107, 0xffff0000, v157
    v_lshlrev_b32 v108, 16, v158
    v_and_b32 v109, 0xffff0000, v158
    v_lshlrev_b32 v110, 16, v159
    v_and_b32 v111, 0xffff0000, v159
    v_pk_add_f32 v[80:81], v[80:81], v[96:97]
    v_pk_add_f32 v[82:83], v[82:83], v[98:99]
    v_pk_add_f32 v[84:85], v[84:85], v[100:101]
    v_pk_add_f32 v[86:87], v[86:87], v[102:103]
    v_pk_add_f32 v[88:89], v[88:89], v[104:105]
    v_pk_add_f32 v[90:91], v[90:91], v[106:107]
    v_pk_add_f32 v[92:93], v[92:93], v[108:109]
    v_pk_add_f32 v[94:95], v[94:95], v[110:111]
    s_waitcnt vmcnt(8)
kchk_adaLN_cond__linear_kernel_hedgehog__glu_gated_swiglu__prompt_kernel_23:
    v_max3_u32 v28, v160, v161, v162
    v_max_u32 v29, v163, v163
    v_max3_u32 v28, v28, v164, v165
    v_max3_u32 v29, v29, v166, v167
    v_max3_u32 v28, v28, v168, v169
    v_max3_u32 v29, v29, v170, v171
    v_max3_u32 v28, v28, v172, v173
    v_max3_u32 v29, v29, v174, v175
    v_max3_u32 v28, v28, v176, v177
    v_max3_u32 v29, v29, v178, v179
    v_max3_u32 v28, v28, v180, v181
    v_max3_u32 v29, v29, v182, v183
    v_max3_u32 v28, v28, v184, v185
    v_max3_u32 v29, v29, v186, v187
    v_max3_u32 v28, v28, v188, v189
    v_max3_u32 v29, v29, v190, v191
    v_max_u32 v28, v28, v29
    v_cmp_eq_u32 vcc, -1, v28
    s_cbranch_vccz kok_adaLN_cond__linear_kernel_hedgehog__glu_gated_swiglu__prompt_kernel_24
    s_add_u32 s97, s97, 1
    s_cmp_ge_u32 s97, 20000
    s_cbranch_scc1 kok_adaLN_cond__linear_kernel_hedgehog__glu_gated_swiglu__prompt_kernel_24
    s_add_u32 s12, s62, 4
    s_and_b32 s12, s12, 15
    s_mul_i32 s12, s12, 139264
    buffer_load_dwordx4 v[160:163], v16, s[44:47], s12 offen sc1
    buffer_load_dwordx4 v[164:167], v16, s[44:47], s12 offen offset:1024 sc1
    s_add_u32 s12, s62, 5
    s_and_b32 s12, s12, 15
    s_mul_i32 s12, s12, 139264
    buffer_load_dwordx4 v[168:171], v16, s[44:47], s12 offen sc1
    buffer_load_dwordx4 v[172:175], v16, s[44:47], s12 offen offset:1024 sc1
    s_add_u32 s12, s62, 6
    s_and_b32 s12, s12, 15
    s_mul_i32 s12, s12, 139264
    buffer_load_dwordx4 v[176:179], v16, s[44:47], s12 offen sc1
    buffer_load_dwordx4 v[180:183], v16, s[44:47], s12 offen offset:1024 sc1
    s_add_u32 s12, s62, 7
    s_and_b32 s12, s12, 15
    s_mul_i32 s12, s12, 139264
    buffer_load_dwordx4 v[184:187], v16, s[44:47], s12 offen sc1
    buffer_load_dwordx4 v[188:191], v16, s[44:47], s12 offen offset:1024 sc1
    s_waitcnt vmcnt(0)
    s_branch kchk_adaLN_cond__linear_kernel_hedgehog__glu_gated_swiglu__prompt_kernel_23
kok_adaLN_cond__linear_kernel_hedgehog__glu_gated_swiglu__prompt_kernel_24:
    s_add_u32 s12, s62, 12
    s_and_b32 s12, s12, 15
    s_mul_i32 s12, s12, 139264
    buffer_load_dwordx4 v[224:227], v16, s[44:47], s12 offen sc1
    buffer_load_dwordx4 v[228:231], v16, s[44:47], s12 offen offset:1024 sc1
    v_lshlrev_b32 v96, 16, v160
    v_and_b32 v97, 0xffff0000, v160
    v_lshlrev_b32 v98, 16, v161
    v_and_b32 v99, 0xffff0000, v161
    v_lshlrev_b32 v100, 16, v162
    v_and_b32 v101, 0xffff0000, v162
    v_lshlrev_b32 v102, 16, v163
    v_and_b32 v103, 0xffff0000, v163
    v_lshlrev_b32 v104, 16, v164
    v_and_b32 v105, 0xffff0000, v164
    v_lshlrev_b32 v106, 16, v165
    v_and_b32 v107, 0xffff0000, v165
    v_lshlrev_b32 v108, 16, v166
    v_and_b32 v109, 0xffff0000, v166
    v_lshlrev_b32 v110, 16, v167
    v_and_b32 v111, 0xffff0000, v167
    v_pk_add_f32 v[80:81], v[80:81], v[96:97]
    v_pk_add_f32 v[82:83], v[82:83], v[98:99]
    v_pk_add_f32 v[84:85], v[84:85], v[100:101]
    v_pk_add_f32 v[86:87], v[86:87], v[102:103]
    v_pk_add_f32 v[88:89], v[88:89], v[104:105]
    v_pk_add_f32 v[90:91], v[90:91], v[106:107]
    v_pk_add_f32 v[92:93], v[92:93], v[108:109]
    v_pk_add_f32 v[94:95], v[94:95], v[110:111]
    s_add_u32 s12, s62, 13
    s_and_b32 s12, s12, 15
    s_mul_i32 s12, s12, 139264
    buffer_load_dwordx4 v[232:235], v16, s[44:47], s12 offen sc1
    buffer_load_dwordx4 v[236:239], v16, s[44:47], s12 offen offset:1024 sc1
    v_lshlrev_b32 v96, 16, v168
    v_and_b32 v97, 0xffff0000, v168
    v_lshlrev_b32 v98, 16, v169
    v_and_b32 v99, 0xffff0000, v169
    v_lshlrev_b32 v100, 16, v170
    v_and_b32 v101, 0xffff0000, v170
    v_lshlrev_b32 v102, 16, v171
    v_and_b32 v103, 0xffff0000, v171
    v_lshlrev_b32 v104, 16, v172
    v_and_b32 v105, 0xffff0000, v172
    v_lshlrev_b32 v106, 16, v173
    v_and_b32 v107, 0xffff0000, v173
    v_lshlrev_b32 v108, 16, v174
    v_and_b32 v109, 0xffff0000, v174
    v_lshlrev_b32 v110, 16, v175
    v_and_b32 v111, 0xffff0000, v175
    v_pk_add_f32 v[80:81], v[80:81], v[96:97]
    v_pk_add_f32 v[82:83], v[82:83], v[98:99]
    v_pk_add_f32 v[84:85], v[84:85], v[100:101]
    v_pk_add_f32 v[86:87], v[86:87], v[102:103]
    v_pk_add_f32 v[88:89], v[88:89], v[104:105]
    v_pk_add_f32 v[90:91], v[90:91], v[106:107]
    v_pk_add_f32 v[92:93], v[92:93], v[108:109]
    v_pk_add_f32 v[94:95], v[94:95], v[110:111]
    s_add_u32 s12, s62, 14
    s_and_b32 s12, s12, 15
    s_mul_i32 s12, s12, 139264
    buffer_load_dwordx4 v[240:243], v16, s[44:47], s12 offen sc1
    buffer_load_dwordx4 v[244:247], v16, s[44:47], s12 offen offset:1024 sc1
    v_lshlrev_b32 v96, 16, v176
    v_and_b32 v97, 0xffff0000, v176
    v_lshlrev_b32 v98, 16, v177
    v_and_b32 v99, 0xffff0000, v177
    v_lshlrev_b32 v100, 16, v178
    v_and_b32 v101, 0xffff0000, v178
    v_lshlrev_b32 v102, 16, v179
    v_and_b32 v103, 0xffff0000, v179
    v_lshlrev_b32 v104, 16, v180
    v_and_b32 v105, 0xffff0000, v180
    v_lshlrev_b32 v106, 16, v181
    v_and_b32 v107, 0xffff0000, v181
    v_lshlrev_b32 v108, 16, v182
    v_and_b32 v109, 0xffff0000, v182
    v_lshlrev_b32 v110, 16, v183
    v_and_b32 v111, 0xffff0000, v183
    v_pk_add_f32 v[80:81], v[80:81], v[96:97]
    v_pk_add_f32 v[82:83], v[82:83], v[98:99]
    v_pk_add_f32 v[84:85], v[84:85], v[100:101]
    v_pk_add_f32 v[86:87], v[86:87], v[102:103]
    v_pk_add_f32 v[88:89], v[88:89], v[104:105]
    v_pk_add_f32 v[90:91], v[90:91], v[106:107]
    v_pk_add_f32 v[92:93], v[92:93], v[108:109]
    v_pk_add_f32 v[94:95], v[94:95], v[110:111]
    s_add_u32 s12, s62, 15
    s_and_b32 s12, s12, 15
    s_mul_i32 s12, s12, 139264
    buffer_load_dwordx4 v[248:251], v16, s[44:47], s12 offen sc1
    buffer_load_dwordx4 v[252:255], v16, s[44:47], s12 offen offset:1024 sc1
    v_lshlrev_b32 v96, 16, v184
    v_and_b32 v97, 0xffff0000, v184
    v_lshlrev_b32 v98, 16, v185
    v_and_b32 v99, 0xffff0000, v185
    v_lshlrev_b32 v100, 16, v186
    v_and_b32 v101, 0xffff0000, v186
    v_lshlrev_b32 v102, 16, v187
    v_and_b32 v103, 0xffff0000, v187
    v_lshlrev_b32 v104, 16, v188
    v_and_b32 v105, 0xffff0000, v188
    v_lshlrev_b32 v106, 16, v189
    v_and_b32 v107, 0xffff0000, v189
    v_lshlrev_b32 v108, 16, v190
    v_and_b32 v109, 0xffff0000, v190
    v_lshlrev_b32 v110, 16, v191
    v_and_b32 v111, 0xffff0000, v191
    v_pk_add_f32 v[80:81], v[80:81], v[96:97]
    v_pk_add_f32 v[82:83], v[82:83], v[98:99]
    v_pk_add_f32 v[84:85], v[84:85], v[100:101]
    v_pk_add_f32 v[86:87], v[86:87], v[102:103]
    v_pk_add_f32 v[88:89], v[88:89], v[104:105]
    v_pk_add_f32 v[90:91], v[90:91], v[106:107]
    v_pk_add_f32 v[92:93], v[92:93], v[108:109]
    v_pk_add_f32 v[94:95], v[94:95], v[110:111]
    s_waitcnt vmcnt(8)
kchk_adaLN_cond__linear_kernel_hedgehog__glu_gated_swiglu__prompt_kernel_25:
    v_max3_u32 v28, v192, v193, v194
    v_max_u32 v29, v195, v195
    v_max3_u32 v28, v28, v196, v197
    v_max3_u32 v29, v29, v198, v199
    v_max3_u32 v28, v28, v200, v201
    v_max3_u32 v29, v29, v202, v203
    v_max3_u32 v28, v28, v204, v205
    v_max3_u32 v29, v29, v206, v207
    v_max3_u32 v28, v28, v208, v209
    v_max3_u32 v29, v29, v210, v211
    v_max3_u32 v28, v28, v212, v213
    v_max3_u32 v29, v29, v214, v215
    v_max3_u32 v28, v28, v216, v217
    v_max3_u32 v29, v29, v218, v219
    v_max3_u32 v28, v28, v220, v221
    v_max3_u32 v29, v29, v222, v223
    v_max_u32 v28, v28, v29
    v_cmp_eq_u32 vcc, -1, v28
    s_cbranch_vccz kok_adaLN_cond__linear_kernel_hedgehog__glu_gated_swiglu__prompt_kernel_26
    s_add_u32 s97, s97, 1
    s_cmp_ge_u32 s97, 20000
    s_cbranch_scc1 kok_adaLN_cond__linear_kernel_hedgehog__glu_gated_swiglu__prompt_kernel_26
    s_add_u32 s12, s62, 8
    s_and_b32 s12, s12, 15
    s_mul_i32 s12, s12, 139264
    buffer_load_dwordx4 v[192:195], v16, s[44:47], s12 offen sc1
    buffer_load_dwordx4 v[196:199], v16, s[44:47], s12 offen offset:1024 sc1
    s_add_u32 s12, s62, 9
    s_and_b32 s12, s12, 15
    s_mul_i32 s12, s12, 139264
    buffer_load_dwordx4 v[200:203], v16, s[44:47], s12 offen sc1
    buffer_load_dwordx4 v[204:207], v16, s[44:47], s12 offen offset:1024 sc1
    s_add_u32 s12, s62, 10
    s_and_b32 s12, s12, 15
    s_mul_i32 s12, s12, 139264
    buffer_load_dwordx4 v[208:211], v16, s[44:47], s12 offen sc1
    buffer_load_dwordx4 v[212:215], v16, s[44:47], s12 offen offset:1024 sc1
    s_add_u32 s12, s62, 11
    s_and_b32 s12, s12, 15
    s_mul_i32 s12, s12, 139264
    buffer_load_dwordx4 v[216:219], v16, s[44:47], s12 offen sc1
    buffer_load_dwordx4 v[220:223], v16, s[44:47], s12 offen offset:1024 sc1
    s_waitcnt vmcnt(0)
    s_branch kchk_adaLN_cond__linear_kernel_hedgehog__glu_gated_swiglu__prompt_kernel_25
kok_adaLN_cond__linear_kernel_hedgehog__glu_gated_swiglu__prompt_kernel_26:
    buffer_load_dwordx4 v[64:67], v17, s[44:47], 0 offen offset:0 sc1
    buffer_load_dwordx4 v[68:71], v17, s[44:47], 0 offen offset:64 sc1
    v_lshlrev_b32 v96, 16, v192
    v_and_b32 v97, 0xffff0000, v192
    v_lshlrev_b32 v98, 16, v193
    v_and_b32 v99, 0xffff0000, v193
    v_lshlrev_b32 v100, 16, v194
    v_and_b32 v101, 0xffff0000, v194
    v_lshlrev_b32 v102, 16, v195
    v_and_b32 v103, 0xffff0000, v195
    v_lshlrev_b32 v104, 16, v196
    v_and_b32 v105, 0xffff0000, v196
    v_lshlrev_b32 v106, 16, v197
    v_and_b32 v107, 0xffff0000, v197
    v_lshlrev_b32 v108, 16, v198
    v_and_b32 v109, 0xffff0000, v198
    v_lshlrev_b32 v110, 16, v199
    v_and_b32 v111, 0xffff0000, v199
    v_pk_add_f32 v[80:81], v[80:81], v[96:97]
    v_pk_add_f32 v[82:83], v[82:83], v[98:99]
    v_pk_add_f32 v[84:85], v[84:85], v[100:101]
    v_pk_add_f32 v[86:87], v[86:87], v[102:103]
    v_pk_add_f32 v[88:89], v[88:89], v[104:105]
    v_pk_add_f32 v[90:91], v[90:91], v[106:107]
    v_pk_add_f32 v[92:93], v[92:93], v[108:109]
    v_pk_add_f32 v[94:95], v[94:95], v[110:111]
    buffer_load_dwordx4 v[72:75], v17, s[44:47], s15 offen offset:0 sc1
    buffer_load_dwordx4 v[76:79], v17, s[44:47], s15 offen offset:64 sc1
    v_lshlrev_b32 v96, 16, v200
    v_and_b32 v97, 0xffff0000, v200
    v_lshlrev_b32 v98, 16, v201
    v_and_b32 v99, 0xffff0000, v201
    v_lshlrev_b32 v100, 16, v202
    v_and_b32 v101, 0xffff0000, v202
    v_lshlrev_b32 v102, 16, v203
    v_and_b32 v103, 0xffff0000, v203
    v_lshlrev_b32 v104, 16, v204
    v_and_b32 v105, 0xffff0000, v204
    v_lshlrev_b32 v106, 16, v205
    v_and_b32 v107, 0xffff0000, v205
    v_lshlrev_b32 v108, 16, v206
    v_and_b32 v109, 0xffff0000, v206
    v_lshlrev_b32 v110, 16, v207
    v_and_b32 v111, 0xffff0000, v207
    v_pk_add_f32 v[80:81], v[80:81], v[96:97]
    v_pk_add_f32 v[82:83], v[82:83], v[98:99]
    v_pk_add_f32 v[84:85], v[84:85], v[100:101]
    v_pk_add_f32 v[86:87], v[86:87], v[102:103]
    v_pk_add_f32 v[88:89], v[88:89], v[104:105]
    v_pk_add_f32 v[90:91], v[90:91], v[106:107]
    v_pk_add_f32 v[92:93], v[92:93], v[108:109]
    v_pk_add_f32 v[94:95], v[94:95], v[110:111]
    v_lshlrev_b32 v96, 16, v208
    v_and_b32 v97, 0xffff0000, v208
    v_lshlrev_b32 v98, 16, v209
    v_and_b32 v99, 0xffff0000, v209
    v_lshlrev_b32 v100, 16, v210
    v_and_b32 v101, 0xffff0000, v210
    v_lshlrev_b32 v102, 16, v211
    v_and_b32 v103, 0xffff0000, v211
    v_lshlrev_b32 v104, 16, v212
    v_and_b32 v105, 0xffff0000, v212
    v_lshlrev_b32 v106, 16, v213
    v_and_b32 v107, 0xffff0000, v213
    v_lshlrev_b32 v108, 16, v214
    v_and_b32 v109, 0xffff0000, v214
    v_lshlrev_b32 v110, 16, v215
    v_and_b32 v111, 0xffff0000, v215
    v_pk_add_f32 v[80:81], v[80:81], v[96:97]
    v_pk_add_f32 v[82:83], v[82:83], v[98:99]
    v_pk_add_f32 v[84:85], v[84:85], v[100:101]
    v_pk_add_f32 v[86:87], v[86:87], v[102:103]
    v_pk_add_f32 v[88:89], v[88:89], v[104:105]
    v_pk_add_f32 v[90:91], v[90:91], v[106:107]
    v_pk_add_f32 v[92:93], v[92:93], v[108:109]
    v_pk_add_f32 v[94:95], v[94:95], v[110:111]
    v_lshlrev_b32 v96, 16, v216
    v_and_b32 v97, 0xffff0000, v216
    v_lshlrev_b32 v98, 16, v217
    v_and_b32 v99, 0xffff0000, v217
    v_lshlrev_b32 v100, 16, v218
    v_and_b32 v101, 0xffff0000, v218
    v_lshlrev_b32 v102, 16, v219
    v_and_b32 v103, 0xffff0000, v219
    v_lshlrev_b32 v104, 16, v220
    v_and_b32 v105, 0xffff0000, v220
    v_lshlrev_b32 v106, 16, v221
    v_and_b32 v107, 0xffff0000, v221
    v_lshlrev_b32 v108, 16, v222
    v_and_b32 v109, 0xffff0000, v222
    v_lshlrev_b32 v110, 16, v223
    v_and_b32 v111, 0xffff0000, v223
    v_pk_add_f32 v[80:81], v[80:81], v[96:97]
    v_pk_add_f32 v[82:83], v[82:83], v[98:99]
    v_pk_add_f32 v[84:85], v[84:85], v[100:101]
    v_pk_add_f32 v[86:87], v[86:87], v[102:103]
    v_pk_add_f32 v[88:89], v[88:89], v[104:105]
    v_pk_add_f32 v[90:91], v[90:91], v[106:107]
    v_pk_add_f32 v[92:93], v[92:93], v[108:109]
    v_pk_add_f32 v[94:95], v[94:95], v[110:111]
    s_waitcnt vmcnt(4)
kchk_adaLN_cond__linear_kernel_hedgehog__glu_gated_swiglu__prompt_kernel_27:
    v_max3_u32 v28, v224, v225, v226
    v_max_u32 v29, v227, v227
    v_max3_u32 v28, v28, v228, v229
    v_max3_u32 v29, v29, v230, v231
    v_max3_u32 v28, v28, v232, v233
    v_max3_u32 v29, v29, v234, v235
    v_max3_u32 v28, v28, v236, v237
    v_max3_u32 v29, v29, v238, v239
    v_max3_u32 v28, v28, v240, v241
    v_max3_u32 v29, v29, v242, v243
    v_max3_u32 v28, v28, v244, v245
    v_max3_u32 v29, v29, v246, v247
    v_max3_u32 v28, v28, v248, v249
    v_max3_u32 v29, v29, v250, v251
    v_max3_u32 v28, v28, v252, v253
    v_max3_u32 v29, v29, v254, v255
    v_max_u32 v28, v28, v29
    v_cmp_eq_u32 vcc, -1, v28
    s_cbranch_vccz kok_adaLN_cond__linear_kernel_hedgehog__glu_gated_swiglu__prompt_kernel_28
    s_add_u32 s97, s97, 1
    s_cmp_ge_u32 s97, 20000
    s_cbranch_scc1 kok_adaLN_cond__linear_kernel_hedgehog__glu_gated_swiglu__prompt_kernel_28
    s_add_u32 s12, s62, 12
    s_and_b32 s12, s12, 15
    s_mul_i32 s12, s12, 139264
    buffer_load_dwordx4 v[224:227], v16, s[44:47], s12 offen sc1
    buffer_load_dwordx4 v[228:231], v16, s[44:47], s12 offen offset:1024 sc1
    s_add_u32 s12, s62, 13
    s_and_b32 s12, s12, 15
    s_mul_i32 s12, s12, 139264
    buffer_load_dwordx4 v[232:235], v16, s[44:47], s12 offen sc1
    buffer_load_dwordx4 v[236:239], v16, s[44:47], s12 offen offset:1024 sc1
    s_add_u32 s12, s62, 14
    s_and_b32 s12, s12, 15
    s_mul_i32 s12, s12, 139264
    buffer_load_dwordx4 v[240:243], v16, s[44:47], s12 offen sc1
    buffer_load_dwordx4 v[244:247], v16, s[44:47], s12 offen offset:1024 sc1
    s_add_u32 s12, s62, 15
    s_and_b32 s12, s12, 15
    s_mul_i32 s12, s12, 139264
    buffer_load_dwordx4 v[248:251], v16, s[44:47], s12 offen sc1
    buffer_load_dwordx4 v[252:255], v16, s[44:47], s12 offen offset:1024 sc1
    s_waitcnt vmcnt(0)
    s_branch kchk_adaLN_cond__linear_kernel_hedgehog__glu_gated_swiglu__prompt_kernel_27
kok_adaLN_cond__linear_kernel_hedgehog__glu_gated_swiglu__prompt_kernel_28:
    v_lshlrev_b32 v96, 16, v224
    v_and_b32 v97, 0xffff0000, v224
    v_lshlrev_b32 v98, 16, v225
    v_and_b32 v99, 0xffff0000, v225
    v_lshlrev_b32 v100, 16, v226
    v_and_b32 v101, 0xffff0000, v226
    v_lshlrev_b32 v102, 16, v227
    v_and_b32 v103, 0xffff0000, v227
    v_lshlrev_b32 v104, 16, v228
    v_and_b32 v105, 0xffff0000, v228
    v_lshlrev_b32 v106, 16, v229
    v_and_b32 v107, 0xffff0000, v229
    v_lshlrev_b32 v108, 16, v230
    v_and_b32 v109, 0xffff0000, v230
    v_lshlrev_b32 v110, 16, v231
    v_and_b32 v111, 0xffff0000, v231
    v_pk_add_f32 v[80:81], v[80:81], v[96:97]
    v_pk_add_f32 v[82:83], v[82:83], v[98:99]
    v_pk_add_f32 v[84:85], v[84:85], v[100:101]
    v_pk_add_f32 v[86:87], v[86:87], v[102:103]
    v_pk_add_f32 v[88:89], v[88:89], v[104:105]
    v_pk_add_f32 v[90:91], v[90:91], v[106:107]
    v_pk_add_f32 v[92:93], v[92:93], v[108:109]
    v_pk_add_f32 v[94:95], v[94:95], v[110:111]
    v_lshlrev_b32 v96, 16, v232
    v_and_b32 v97, 0xffff0000, v232
    v_lshlrev_b32 v98, 16, v233
    v_and_b32 v99, 0xffff0000, v233
    v_lshlrev_b32 v100, 16, v234
    v_and_b32 v101, 0xffff0000, v234
    v_lshlrev_b32 v102, 16, v235
    v_and_b32 v103, 0xffff0000, v235
    v_lshlrev_b32 v104, 16, v236
    v_and_b32 v105, 0xffff0000, v236
    v_lshlrev_b32 v106, 16, v237
    v_and_b32 v107, 0xffff0000, v237
    v_lshlrev_b32 v108, 16, v238
    v_and_b32 v109, 0xffff0000, v238
    v_lshlrev_b32 v110, 16, v239
    v_and_b32 v111, 0xffff0000, v239
    v_pk_add_f32 v[80:81], v[80:81], v[96:97]
    v_pk_add_f32 v[82:83], v[82:83], v[98:99]
    v_pk_add_f32 v[84:85], v[84:85], v[100:101]
    v_pk_add_f32 v[86:87], v[86:87], v[102:103]
    v_pk_add_f32 v[88:89], v[88:89], v[104:105]
    v_pk_add_f32 v[90:91], v[90:91], v[106:107]
    v_pk_add_f32 v[92:93], v[92:93], v[108:109]
    v_pk_add_f32 v[94:95], v[94:95], v[110:111]
    v_lshlrev_b32 v96, 16, v240
    v_and_b32 v97, 0xffff0000, v240
    v_lshlrev_b32 v98, 16, v241
    v_and_b32 v99, 0xffff0000, v241
    v_lshlrev_b32 v100, 16, v242
    v_and_b32 v101, 0xffff0000, v242
    v_lshlrev_b32 v102, 16, v243
    v_and_b32 v103, 0xffff0000, v243
    v_lshlrev_b32 v104, 16, v244
    v_and_b32 v105, 0xffff0000, v244
    v_lshlrev_b32 v106, 16, v245
    v_and_b32 v107, 0xffff0000, v245
    v_lshlrev_b32 v108, 16, v246
    v_and_b32 v109, 0xffff0000, v246
    v_lshlrev_b32 v110, 16, v247
    v_and_b32 v111, 0xffff0000, v247
    v_pk_add_f32 v[80:81], v[80:81], v[96:97]
    v_pk_add_f32 v[82:83], v[82:83], v[98:99]
    v_pk_add_f32 v[84:85], v[84:85], v[100:101]
    v_pk_add_f32 v[86:87], v[86:87], v[102:103]
    v_pk_add_f32 v[88:89], v[88:89], v[104:105]
    v_pk_add_f32 v[90:91], v[90:91], v[106:107]
    v_pk_add_f32 v[92:93], v[92:93], v[108:109]
    v_pk_add_f32 v[94:95], v[94:95], v[110:111]
    v_lshlrev_b32 v96, 16, v248
    v_and_b32 v97, 0xffff0000, v248
    v_lshlrev_b32 v98, 16, v249
    v_and_b32 v99, 0xffff0000, v249
    v_lshlrev_b32 v100, 16, v250
    v_and_b32 v101, 0xffff0000, v250
    v_lshlrev_b32 v102, 16, v251
    v_and_b32 v103, 0xffff0000, v251
    v_lshlrev_b32 v104, 16, v252
    v_and_b32 v105, 0xffff0000, v252
    v_lshlrev_b32 v106, 16, v253
    v_and_b32 v107, 0xffff0000, v253
    v_lshlrev_b32 v108, 16, v254
    v_and_b32 v109, 0xffff0000, v254
    v_lshlrev_b32 v110, 16, v255
    v_and_b32 v111, 0xffff0000, v255
    v_pk_add_f32 v[80:81], v[80:81], v[96:97]
    v_pk_add_f32 v[82:83], v[82:83], v[98:99]
    v_pk_add_f32 v[84:85], v[84:85], v[100:101]
    v_pk_add_f32 v[86:87], v[86:87], v[102:103]
    v_pk_add_f32 v[88:89], v[88:89], v[104:105]
    v_pk_add_f32 v[90:91], v[90:91], v[106:107]
    v_pk_add_f32 v[92:93], v[92:93], v[108:109]
    v_pk_add_f32 v[94:95], v[94:95], v[110:111]
    s_waitcnt vmcnt(0)
kchk_adaLN_cond__linear_kernel_hedgehog__glu_gated_swiglu__prompt_kernel_29:
    v_max3_u32 v28, v64, v65, v66
    v_max_u32 v29, v67, v67
    v_max3_u32 v28, v28, v68, v69
    v_max3_u32 v29, v29, v70, v71
    v_max3_u32 v28, v28, v72, v73
    v_max3_u32 v29, v29, v74, v75
    v_max3_u32 v28, v28, v76, v77
    v_max3_u32 v29, v29, v78, v79
    v_max_u32 v28, v28, v29
    v_cmp_eq_u32 vcc, -1, v28
    s_cbranch_vccz kok_adaLN_cond__linear_kernel_hedgehog__glu_gated_swiglu__prompt_kernel_30
    s_add_u32 s97, s97, 1
    s_cmp_ge_u32 s97, 20000
    s_cbranch_scc1 kok_adaLN_cond__linear_kernel_hedgehog__glu_gated_swiglu__prompt_kernel_30
    buffer_load_dwordx4 v[64:67], v17, s[44:47], 0 offen offset:0 sc1
    buffer_load_dwordx4 v[68:71], v17, s[44:47], 0 offen offset:64 sc1
    buffer_load_dwordx4 v[72:75], v17, s[44:47], s15 offen offset:0 sc1
    buffer_load_dwordx4 v[76:79], v17, s[44:47], s15 offen offset:64 sc1
    s_waitcnt vmcnt(0)
    s_branch kchk_adaLN_cond__linear_kernel_hedgehog__glu_gated_swiglu__prompt_kernel_29
kok_adaLN_cond__linear_kernel_hedgehog__glu_gated_swiglu__prompt_kernel_30:
    v_cvt_pk_bf16_f32 v96, v80, v81
    v_cvt_pk_bf16_f32 v97, v82, v83
    v_cvt_pk_bf16_f32 v98, v84, v85
    v_cvt_pk_bf16_f32 v99, v86, v87
    v_cvt_pk_bf16_f32 v100, v88, v89
    v_cvt_pk_bf16_f32 v101, v90, v91
    v_cvt_pk_bf16_f32 v102, v92, v93
    v_cvt_pk_bf16_f32 v103, v94, v95
    s_lshl_b32 s12, s3, 11
    s_add_u32 s12, s12, 131072
    v_add_u32 v16, s12, v2
    ds_write_b128 v16, v[96:99]
    ds_write_b128 v16, v[100:103] offset:1024
    s_waitcnt vmcnt(0)
    s_add_u32 s61, s58, s59
    s_lshl_b32 s53, s61, 19
    s_lshl_b32 s54, s61, 18
    s_add_u32 s55, s54, 0x8000
    s_add_u32 s59, s59, 1
    s_and_b32 s59, s59, 0
    s_cmp_eq_u32 s59, s60
    s_cselect_b32 s61, 1, 0
    s_add_u32 s58, s58, s61
    s_mov_b32 s28, s53
    s_add_u32 m0, s52, 0
    s_nop 0
    buffer_load_dwordx4 v8, s[36:39], s54 offen offset:0 lds
    buffer_load_dwordx4 v9, s[36:39], s54 offen offset:1024 lds
    buffer_load_dwordx4 v10, s[36:39], s54 offen offset:2048 lds
    buffer_load_dwordx4 v11, s[36:39], s54 offen offset:3072 lds
    s_add_u32 m0, s52, 4096
    s_nop 0
    buffer_load_dwordx4 v8, s[36:39], s55 offen offset:0 lds
    buffer_load_dwordx4 v9, s[36:39], s55 offen offset:1024 lds
    buffer_load_dwordx4 v10, s[36:39], s55 offen offset:2048 lds
    buffer_load_dwordx4 v11, s[36:39], s55 offen offset:3072 lds
    v_add_u32 v16, 131072, v2
    s_waitcnt lgkmcnt(0)
    s_barrier
    ds_read_b128 v[128:131], v16 offset:0
    ds_read_b128 v[132:135], v16 offset:1024
    ds_read_b128 v[136:139], v16 offset:2048
    ds_read_b128 v[140:143], v16 offset:3072
    ds_read_b128 v[144:147], v16 offset:4096
    ds_read_b128 v[148:151], v16 offset:5120
    ds_read_b128 v[152:155], v16 offset:6144
    ds_read_b128 v[156:159], v16 offset:7168
    v_mfma_f32_16x16x32_bf16 v[168:171], v[64:67], v[32:35], 0
    v_mfma_f32_16x16x32_bf16 v[180:183], v[64:67], v[40:43], 0
    v_mfma_f32_16x16x32_bf16 v[192:195], v[72:75], v[48:51], 0
    v_mfma_f32_16x16x32_bf16 v[204:207], v[72:75], v[56:59], 0
    v_mfma_f32_16x16x32_bf16 v[168:171], v[68:71], v[36:39], v[168:171]
    v_mfma_f32_16x16x32_bf16 v[180:183], v[68:71], v[44:47], v[180:183]
    v_mfma_f32_16x16x32_bf16 v[192:195], v[76:79], v[52:55], v[192:195]
    v_mfma_f32_16x16x32_bf16 v[204:207], v[76:79], v[60:63], v[204:207]
    s_waitcnt lgkmcnt(0)
    v_mfma_f32_16x16x32_bf16 v[160:163], v[128:131], v[32:35], 0
    v_mfma_f32_16x16x32_bf16 v[164:167], v[132:135], v[32:35], 0
    v_mfma_f32_16x16x32_bf16 v[172:175], v[128:131], v[40:43], 0
    v_mfma_f32_16x16x32_bf16 v[176:179], v[132:135], v[40:43], 0
    v_mfma_f32_16x16x32_bf16 v[184:187], v[144:147], v[48:51], 0
    v_mfma_f32_16x16x32_bf16 v[188:191], v[148:151], v[48:51], 0
    v_mfma_f32_16x16x32_bf16 v[196:199], v[144:147], v[56:59], 0
    v_mfma_f32_16x16x32_bf16 v[200:203], v[148:151], v[56:59], 0
    v_mfma_f32_16x16x32_bf16 v[160:163], v[136:139], v[36:39], v[160:163]
    v_mfma_f32_16x16x32_bf16 v[164:167], v[140:143], v[36:39], v[164:167]
    v_mfma_f32_16x16x32_bf16 v[172:175], v[136:139], v[44:47], v[172:175]
    v_mfma_f32_16x16x32_bf16 v[176:179], v[140:143], v[44:47], v[176:179]
    v_mfma_f32_16x16x32_bf16 v[184:187], v[152:155], v[52:55], v[184:187]
    v_mfma_f32_16x16x32_bf16 v[188:191], v[156:159], v[52:55], v[188:191]
    v_mfma_f32_16x16x32_bf16 v[196:199], v[152:155], v[60:63], v[196:199]
    v_mfma_f32_16x16x32_bf16 v[200:203], v[156:159], v[60:63], v[200:203]
    v_pk_add_f32 v[168:169], v[168:169], v[170:171]
    v_pk_add_f32 v[180:181], v[180:181], v[182:183]
    v_pk_add_f32 v[192:193], v[192:193], v[194:195]
    v_pk_add_f32 v[204:205], v[204:205], v[206:207]
    v_add_f32 v168, v168, v169
    v_add_f32 v180, v180, v181
    v_add_f32 v192, v192, v193
    v_add_f32 v204, v204, v205
    v_mov_b32 v169, v168
    v_mov_b32 v181, v180
    v_mov_b32 v193, v192
    v_mov_b32 v205, v204
    s_nop 1
    v_permlane16_swap_b32 v168, v169
    v_permlane16_swap_b32 v180, v181
    v_permlane16_swap_b32 v192, v193
    v_permlane16_swap_b32 v204, v205
    v_add_f32 v168, v168, v169
    v_add_f32 v180, v180, v181
    v_add_f32 v192, v192, v193
    v_add_f32 v204, v204, v205
    v_mov_b32 v169, v168
    v_mov_b32 v181, v180
    v_mov_b32 v193, v192
    v_mov_b32 v205, v204
    s_nop 1
    v_permlane32_swap_b32 v168, v169
    v_permlane32_swap_b32 v180, v181
    v_permlane32_swap_b32 v192, v193
    v_permlane32_swap_b32 v204, v205
    v_add_f32 v168, v168, v169
    v_add_f32 v180, v180, v181
    v_add_f32 v192, v192, v193
    v_add_f32 v204, v204, v205
    v_add_f32 v168, 0x358637bd, v168
    v_add_f32 v180, 0x358637bd, v180
    v_add_f32 v192, 0x358637bd, v192
    v_add_f32 v204, 0x358637bd, v204
    v_rcp_f32 v168, v168
    v_rcp_f32 v180, v180
    v_rcp_f32 v192, v192
    v_rcp_f32 v204, v204
    s_lshl_b32 s12, s63, 18
    s_lshl_b32 s13, s62, 13
    s_add_u32 s12, s12, s13
    s_lshl_b32 s13, s3, 11
    s_add_u32 s12, s12, s13
    s_add_u32 s13, s12, 0x20000
    v_pk_mul_f32 v[160:161], v[160:161], v[168:169] op_sel_hi:[1,0]
    v_pk_mul_f32 v[162:163], v[162:163], v[168:169] op_sel_hi:[1,0]
    v_pk_mul_f32 v[164:165], v[164:165], v[168:169] op_sel_hi:[1,0]
    v_pk_mul_f32 v[166:167], v[166:167], v[168:169] op_sel_hi:[1,0]
    v_cvt_pk_bf16_f32 v64, v160, v161
    v_cvt_pk_bf16_f32 v65, v162, v163
    v_cvt_pk_bf16_f32 v66, v164, v165
    v_cvt_pk_bf16_f32 v67, v166, v167
    buffer_store_dwordx4 v[64:67], v2, s[24:27], s12 offen offset:0 sc1
    v_pk_mul_f32 v[172:173], v[172:173], v[180:181] op_sel_hi:[1,0]
    v_pk_mul_f32 v[174:175], v[174:175], v[180:181] op_sel_hi:[1,0]
    v_pk_mul_f32 v[176:177], v[176:177], v[180:181] op_sel_hi:[1,0]
    v_pk_mul_f32 v[178:179], v[178:179], v[180:181] op_sel_hi:[1,0]
    v_cvt_pk_bf16_f32 v68, v172, v173
    v_cvt_pk_bf16_f32 v69, v174, v175
    v_cvt_pk_bf16_f32 v70, v176, v177
    v_cvt_pk_bf16_f32 v71, v178, v179
    buffer_store_dwordx4 v[68:71], v2, s[24:27], s12 offen offset:1024 sc1
    v_pk_mul_f32 v[184:185], v[184:185], v[192:193] op_sel_hi:[1,0]
    v_pk_mul_f32 v[186:187], v[186:187], v[192:193] op_sel_hi:[1,0]
    v_pk_mul_f32 v[188:189], v[188:189], v[192:193] op_sel_hi:[1,0]
    v_pk_mul_f32 v[190:191], v[190:191], v[192:193] op_sel_hi:[1,0]
    v_cvt_pk_bf16_f32 v72, v184, v185
    v_cvt_pk_bf16_f32 v73, v186, v187
    v_cvt_pk_bf16_f32 v74, v188, v189
    v_cvt_pk_bf16_f32 v75, v190, v191
    buffer_store_dwordx4 v[72:75], v2, s[24:27], s13 offen offset:0 sc1
    v_pk_mul_f32 v[196:197], v[196:197], v[204:205] op_sel_hi:[1,0]
    v_pk_mul_f32 v[198:199], v[198:199], v[204:205] op_sel_hi:[1,0]
    v_pk_mul_f32 v[200:201], v[200:201], v[204:205] op_sel_hi:[1,0]
    v_pk_mul_f32 v[202:203], v[202:203], v[204:205] op_sel_hi:[1,0]
    v_cvt_pk_bf16_f32 v76, v196, v197
    v_cvt_pk_bf16_f32 v77, v198, v199
    v_cvt_pk_bf16_f32 v78, v200, v201
    v_cvt_pk_bf16_f32 v79, v202, v203
    buffer_store_dwordx4 v[76:79], v2, s[24:27], s13 offen offset:1024 sc1
    s_add_u32 s20, s62, 48
    s_waitcnt vmcnt(0) lgkmcnt(0)
    s_barrier
    s_cmp_lg_u32 s3, 0
    s_cbranch_scc1 arr_adaLN_cond__linear_kernel_hedgehog__glu_gated_swiglu__prompt_kernel_31
    s_lshl_b32 s96, s20, 8
    v_mov_b32 v28, 1
    v_mov_b32 v29, 0
    s_mov_b64 exec, 1
    buffer_atomic_add v28, v29, s[92:95], s96 offen sc1
    s_mov_b64 exec, -1
arr_adaLN_cond__linear_kernel_hedgehog__glu_gated_swiglu__prompt_kernel_31:
    s_add_u32 s61, s58, s59
    s_lshl_b32 s53, s61, 19
    s_lshl_b32 s54, s61, 18
    s_add_u32 s55, s54, 0x8000
    s_add_u32 s59, s59, 1
    s_and_b32 s59, s59, 0
    s_cmp_eq_u32 s59, s60
    s_cselect_b32 s61, 1, 0
    s_add_u32 s58, s58, s61
    s_mov_b32 s29, s53
    s_add_u32 m0, s52, 32768
    s_nop 0
    buffer_load_dwordx4 v8, s[36:39], s54 offen offset:0 lds
    buffer_load_dwordx4 v9, s[36:39], s54 offen offset:1024 lds
    buffer_load_dwordx4 v10, s[36:39], s54 offen offset:2048 lds
    buffer_load_dwordx4 v11, s[36:39], s54 offen offset:3072 lds
    s_add_u32 m0, s52, 36864
    s_nop 0
    buffer_load_dwordx4 v8, s[36:39], s55 offen offset:0 lds
    buffer_load_dwordx4 v9, s[36:39], s55 offen offset:1024 lds
    buffer_load_dwordx4 v10, s[36:39], s55 offen offset:2048 lds
    buffer_load_dwordx4 v11, s[36:39], s55 offen offset:3072 lds
    s_add_u32 s61, s58, s59
    s_lshl_b32 s53, s61, 19
    s_lshl_b32 s54, s61, 18
    s_add_u32 s55, s54, 0x8000
    s_add_u32 s59, s59, 1
    s_and_b32 s59, s59, 0
    s_cmp_eq_u32 s59, s60
    s_cselect_b32 s61, 1, 0
    s_add_u32 s58, s58, s61
    s_mov_b32 s30, s53
    s_add_u32 m0, s52, 65536
    s_nop 0
    buffer_load_dwordx4 v8, s[36:39], s54 offen offset:0 lds
    buffer_load_dwordx4 v9, s[36:39], s54 offen offset:1024 lds
    buffer_load_dwordx4 v10, s[36:39], s54 offen offset:2048 lds
    buffer_load_dwordx4 v11, s[36:39], s54 offen offset:3072 lds
    s_add_u32 m0, s52, 69632
    s_nop 0
    buffer_load_dwordx4 v8, s[36:39], s55 offen offset:0 lds
    buffer_load_dwordx4 v9, s[36:39], s55 offen offset:1024 lds
    buffer_load_dwordx4 v10, s[36:39], s55 offen offset:2048 lds
    buffer_load_dwordx4 v11, s[36:39], s55 offen offset:3072 lds
    s_lshr_b32 s20, s40, 1
    s_add_u32 s20, s20, 48
    s_add_u32 s61, s58, s59
    s_lshl_b32 s53, s61, 19
    s_lshl_b32 s54, s61, 18
    s_add_u32 s55, s54, 0x8000
    s_add_u32 s59, s59, 1
    s_and_b32 s59, s59, 0
    s_cmp_eq_u32 s59, s60
    s_cselect_b32 s61, 1, 0
    s_add_u32 s58, s58, s61
    s_add_u32 m0, s52, 98304
    s_nop 0
    buffer_load_dwordx4 v8, s[36:39], s54 offen offset:0 lds
    buffer_load_dwordx4 v9, s[36:39], s54 offen offset:1024 lds
    buffer_load_dwordx4 v10, s[36:39], s54 offen offset:2048 lds
    buffer_load_dwordx4 v11, s[36:39], s54 offen offset:3072 lds
    s_add_u32 m0, s52, 102400
    s_nop 0
    buffer_load_dwordx4 v8, s[36:39], s55 offen offset:0 lds
    buffer_load_dwordx4 v9, s[36:39], s55 offen offset:1024 lds
    buffer_load_dwordx4 v10, s[36:39], s55 offen offset:2048 lds
    buffer_load_dwordx4 v11, s[36:39], s55 offen offset:3072 lds
    s_add_u32 s61, s58, s59
    s_lshl_b32 s53, s61, 19
    s_lshl_b32 s54, s61, 18
    s_add_u32 s55, s54, 0x8000
    s_add_u32 s59, s59, 1
    s_and_b32 s59, s59, 0
    s_cmp_eq_u32 s59, s60
    s_cselect_b32 s61, 1, 0
    s_add_u32 s58, s58, s61
    buffer_load_dwordx4 a[96:99], v8, s[36:39], s54 offen offset:0
    buffer_load_dwordx4 a[100:103], v9, s[36:39], s54 offen offset:1024
    buffer_load_dwordx4 a[104:107], v10, s[36:39], s54 offen offset:2048
    buffer_load_dwordx4 a[108:111], v11, s[36:39], s54 offen offset:3072
    buffer_load_dwordx4 a[112:115], v8, s[36:39], s55 offen offset:0
    buffer_load_dwordx4 a[116:119], v9, s[36:39], s55 offen offset:1024
    buffer_load_dwordx4 a[120:123], v10, s[36:39], s55 offen offset:2048
    buffer_load_dwordx4 a[124:127], v11, s[36:39], s55 offen offset:3072
w0l_adaLN_cond__linear_kernel_hedgehog__glu_gated_swiglu__prompt_kernel_32:
    v_and_b32 v21, 15, v1
    s_lshl_b32 s12, s3, 4
    v_add_u32 v21, s12, v21
    v_lshrrev_b32 v22, 4, v1
    v_lshlrev_b32 v23, 11, v21
    v_lshl_add_u32 v23, v22, 4, v23
    v_lshlrev_b32 v20, 5, v22
    v_add_u32 v20, 155648, v20
    s_add_u32 s16, s4, 196608
    s_addc_u32 s17, s5, 0
    s_and_b32 s17, s17, 0xffff
    s_mov_b32 s18, 32768
    s_mov_b32 s19, 0x20000
    v_lshrrev_b32 v80, 5, v1
    v_and_b32 v81, 31, v1
    v_lshlrev_b32 v81, 4, v81
    v_lshl_add_u32 v81, v80, 12, v81
    s_lshl_b32 s12, s41, 9
    s_and_b32 s13, s3, 1
    s_lshl_b32 s14, s13, 13
    s_add_u32 s12, s12, s14
    v_add_u32 v81, s12, v81
    v_sub_u32 v80, s13, v80
    v_cmp_eq_u32 vcc, 1, v80
    s_nop 1
    v_cndmask_b32 v80, 0, 1.0, vcc
    s_lshl_b32 s13, s13, 10
    s_add_u32 s13, s13, 155648
    v_add_u32 v82, s13, v2
    s_waitcnt vmcnt(0)
    ds_read_b64_tr_b16 a[0:1], v12 offset:0
    ds_read_b64_tr_b16 a[2:3], v12 offset:4096
    ds_read_b64_tr_b16 a[4:5], v12 offset:8
    ds_read_b64_tr_b16 a[6:7], v12 offset:4104
    ds_read_b64_tr_b16 a[8:9], v13 offset:0
    ds_read_b64_tr_b16 a[10:11], v13 offset:4096
    ds_read_b64_tr_b16 a[12:13], v13 offset:8
    ds_read_b64_tr_b16 a[14:15], v13 offset:4104
    ds_read_b64_tr_b16 a[16:17], v14 offset:0
    ds_read_b64_tr_b16 a[18:19], v14 offset:4096
    ds_read_b64_tr_b16 a[20:21], v14 offset:8
    ds_read_b64_tr_b16 a[22:23], v14 offset:4104
    ds_read_b64_tr_b16 a[24:25], v15 offset:0
    ds_read_b64_tr_b16 a[26:27], v15 offset:4096
    ds_read_b64_tr_b16 a[28:29], v15 offset:8
    ds_read_b64_tr_b16 a[30:31], v15 offset:4104
    v_add_u32 v24, 0x10000, v12
    v_add_u32 v25, 0x10000, v13
    v_add_u32 v26, 0x10000, v14
    v_add_u32 v27, 0x10000, v15
    s_lshr_b32 s20, s40, 1
    s_add_u32 s20, s20, 48
    s_cmp_lg_u32 s3, 0
    s_cbranch_scc1 wt_adaLN_cond__linear_kernel_hedgehog__glu_gated_swiglu__prompt_kernel_33
    s_lshl_b32 s96, s20, 8
    v_and_b32 v29, 0, v1
    v_lshlrev_b32 v29, 8, v29
    s_mov_b32 s97, 0
    s_mov_b64 exec, 1
poll_adaLN_cond__linear_kernel_hedgehog__glu_gated_swiglu__prompt_kernel_34:
    buffer_load_dword v28, v29, s[92:95], s96 offen sc1
    s_waitcnt vmcnt(0)
    v_cmp_ne_u32 vcc, 16, v28
    s_cbranch_vccz pdone_adaLN_cond__linear_kernel_hedgehog__glu_gated_swiglu__prompt_kernel_35
    s_add_u32 s97, s97, 1
    s_cmp_lt_u32 s97, 100000
    s_cbranch_scc1 poll_adaLN_cond__linear_kernel_hedgehog__glu_gated_swiglu__prompt_kernel_34
pdone_adaLN_cond__linear_kernel_hedgehog__glu_gated_swiglu__prompt_kernel_35:
    s_mov_b64 exec, -1
wt_adaLN_cond__linear_kernel_hedgehog__glu_gated_swiglu__prompt_kernel_33:
    s_barrier
    s_mov_b32 s58, 0
    s_mov_b32 s59, s60
    s_add_u32 s61, s58, s59
    s_lshl_b32 s53, s61, 19
    s_lshl_b32 s54, s61, 18
    s_add_u32 s55, s54, 0x8000
    s_add_u32 s59, s59, 1
    s_and_b32 s59, s59, 0
    s_cmp_eq_u32 s59, s60
    s_cselect_b32 s61, 1, 0
    s_add_u32 s58, s58, s61
    buffer_load_dwordx4 a[32:35], v4, s[32:35], s53 offen sc1
    buffer_load_dwordx4 a[36:39], v5, s[32:35], s53 offen sc1
    buffer_load_dwordx4 a[40:43], v6, s[32:35], s53 offen sc1
    buffer_load_dwordx4 a[44:47], v7, s[32:35], s53 offen sc1
    s_add_u32 s61, s58, s59
    s_lshl_b32 s53, s61, 19
    s_lshl_b32 s54, s61, 18
    s_add_u32 s55, s54, 0x8000
    s_add_u32 s59, s59, 1
    s_and_b32 s59, s59, 0
    s_cmp_eq_u32 s59, s60
    s_cselect_b32 s61, 1, 0
    s_add_u32 s58, s58, s61
    buffer_load_dwordx4 a[48:51], v4, s[32:35], s53 offen sc1
    buffer_load_dwordx4 a[52:55], v5, s[32:35], s53 offen sc1
    buffer_load_dwordx4 a[56:59], v6, s[32:35], s53 offen sc1
    buffer_load_dwordx4 a[60:63], v7, s[32:35], s53 offen sc1
    s_add_u32 s61, s58, s59
    s_lshl_b32 s53, s61, 19
    s_lshl_b32 s54, s61, 18
    s_add_u32 s55, s54, 0x8000
    s_add_u32 s59, s59, 1
    s_and_b32 s59, s59, 0
    s_cmp_eq_u32 s59, s60
    s_cselect_b32 s61, 1, 0
    s_add_u32 s58, s58, s61
    buffer_load_dwordx4 a[64:67], v4, s[32:35], s53 offen sc1
    buffer_load_dwordx4 a[68:71], v5, s[32:35], s53 offen sc1
    buffer_load_dwordx4 a[72:75], v6, s[32:35], s53 offen sc1
    buffer_load_dwordx4 a[76:79], v7, s[32:35], s53 offen sc1
    s_add_u32 s61, s58, s59
    s_lshl_b32 s53, s61, 19
    s_lshl_b32 s54, s61, 18
    s_add_u32 s55, s54, 0x8000
    s_add_u32 s59, s59, 1
    s_and_b32 s59, s59, 0
    s_cmp_eq_u32 s59, s60
    s_cselect_b32 s61, 1, 0
    s_add_u32 s58, s58, s61
    buffer_load_dwordx4 a[80:83], v4, s[32:35], s53 offen sc1
    buffer_load_dwordx4 a[84:87], v5, s[32:35], s53 offen sc1
    buffer_load_dwordx4 a[88:91], v6, s[32:35], s53 offen sc1
    buffer_load_dwordx4 a[92:95], v7, s[32:35], s53 offen sc1
    v_add_u32 v16, s52, v2
    v_add_u32 v17, 0x10000, v16
    s_mov_b32 s12, 0
    buffer_load_dwordx4 v[64:67], v81, s[16:19], s12 offen sc1
    s_mov_b32 s12, 16384
    buffer_load_dwordx4 v[68:71], v81, s[16:19], s12 offen sc1
    v_accvgpr_read_b32 v96, a224
    v_accvgpr_read_b32 v97, a225
    v_accvgpr_read_b32 v98, a226
    v_accvgpr_read_b32 v99, a227
    v_accvgpr_read_b32 v100, a228
    v_accvgpr_read_b32 v101, a229
    v_accvgpr_read_b32 v102, a230
    v_accvgpr_read_b32 v103, a231
    v_accvgpr_read_b32 v104, a232
    v_accvgpr_read_b32 v105, a233
    v_accvgpr_read_b32 v106, a234
    v_accvgpr_read_b32 v107, a235
    v_accvgpr_read_b32 v108, a236
    v_accvgpr_read_b32 v109, a237
    v_accvgpr_read_b32 v110, a238
    v_accvgpr_read_b32 v111, a239
    s_lshl_b32 s20, s7, 2
    s_add_u32 s20, s20, s3
    s_and_b32 s21, s20, 1
    s_cmp_eq_u32 s21, 0
    s_cselect_b32 s24, s74, s76
    s_cselect_b32 s25, s75, s77
    s_and_b32 s25, s25, 0xffff
    s_mov_b32 s26, 7340032
    s_mov_b32 s27, 0x20000
    s_lshr_b32 s21, s20, 1
    s_lshl_b32 s21, s21, 3
    s_add_u32 s21, s21, 256
    s_mul_i32 s21, s21, 7168
    s_mul_i32 s22, s6, 896
    s_add_u32 s21, s21, s22
    s_add_u32 s22, s21, 3670016
    v_lshrrev_b32 v112, 3, v1
    v_mul_u32_u24 v112, 7168, v112
    v_and_b32 v113, 7, v1
    v_min_u32 v113, 6, v113
    v_lshl_add_u32 v112, v113, 7, v112
    s_waitcnt vmcnt(14)
    s_waitcnt lgkmcnt(10)
    v_mfma_f32_16x16x32_bf16 v[128:131], a[0:3], a[32:35], 0
    v_mfma_f32_16x16x32_bf16 v[132:135], a[0:3], a[36:39], 0
    v_mfma_f32_16x16x32_bf16 v[136:139], a[0:3], a[40:43], 0
    v_mfma_f32_16x16x32_bf16 v[140:143], a[0:3], a[44:47], 0
    v_mfma_f32_16x16x32_bf16 v[156:159], a[4:7], a[44:47], 0
    ds_read_b64_tr_b16 a[0:1], v12 offset:32768
    v_mfma_f32_16x16x32_bf16 v[152:155], a[4:7], a[40:43], 0
    ds_read_b64_tr_b16 a[2:3], v12 offset:36864
    v_mfma_f32_16x16x32_bf16 v[148:151], a[4:7], a[36:39], 0
    v_mfma_f32_16x16x32_bf16 v[144:147], a[4:7], a[32:35], 0
    s_waitcnt lgkmcnt(10)
    v_mfma_f32_16x16x32_bf16 v[160:163], a[8:11], a[32:35], 0
    ds_read_b64_tr_b16 a[4:5], v12 offset:32776
    v_mfma_f32_16x16x32_bf16 v[164:167], a[8:11], a[36:39], 0
    ds_read_b64_tr_b16 a[6:7], v12 offset:36872
    v_mfma_f32_16x16x32_bf16 v[168:171], a[8:11], a[40:43], 0
    v_mfma_f32_16x16x32_bf16 v[172:175], a[8:11], a[44:47], 0
    v_mfma_f32_16x16x32_bf16 v[188:191], a[12:15], a[44:47], 0
    ds_read_b64_tr_b16 a[8:9], v13 offset:32768
    v_mfma_f32_16x16x32_bf16 v[184:187], a[12:15], a[40:43], 0
    ds_read_b64_tr_b16 a[10:11], v13 offset:36864
    v_mfma_f32_16x16x32_bf16 v[180:183], a[12:15], a[36:39], 0
    v_mfma_f32_16x16x32_bf16 v[176:179], a[12:15], a[32:35], 0
    s_waitcnt lgkmcnt(10)
    v_mfma_f32_16x16x32_bf16 v[192:195], a[16:19], a[32:35], 0
    ds_read_b64_tr_b16 a[12:13], v13 offset:32776
    v_mfma_f32_16x16x32_bf16 v[196:199], a[16:19], a[36:39], 0
    ds_read_b64_tr_b16 a[14:15], v13 offset:36872
    v_mfma_f32_16x16x32_bf16 v[200:203], a[16:19], a[40:43], 0
    v_mfma_f32_16x16x32_bf16 v[204:207], a[16:19], a[44:47], 0
    v_mfma_f32_16x16x32_bf16 v[220:223], a[20:23], a[44:47], 0
    ds_read_b64_tr_b16 a[16:17], v14 offset:32768
    v_mfma_f32_16x16x32_bf16 v[216:219], a[20:23], a[40:43], 0
    ds_read_b64_tr_b16 a[18:19], v14 offset:36864
    v_mfma_f32_16x16x32_bf16 v[212:215], a[20:23], a[36:39], 0
    v_mfma_f32_16x16x32_bf16 v[208:211], a[20:23], a[32:35], 0
    s_waitcnt lgkmcnt(10)
    v_mfma_f32_16x16x32_bf16 v[224:227], a[24:27], a[32:35], 0
    ds_read_b64_tr_b16 a[20:21], v14 offset:32776
    v_mfma_f32_16x16x32_bf16 v[228:231], a[24:27], a[36:39], 0
    ds_read_b64_tr_b16 a[22:23], v14 offset:36872
    v_mfma_f32_16x16x32_bf16 v[232:235], a[24:27], a[40:43], 0
    v_mfma_f32_16x16x32_bf16 v[236:239], a[24:27], a[44:47], 0
    v_mfma_f32_16x16x32_bf16 v[252:255], a[28:31], a[44:47], 0
    ds_read_b64_tr_b16 a[24:25], v15 offset:32768
    v_mfma_f32_16x16x32_bf16 v[248:251], a[28:31], a[40:43], 0
    ds_read_b64_tr_b16 a[26:27], v15 offset:36864
    v_mfma_f32_16x16x32_bf16 v[244:247], a[28:31], a[36:39], 0
    v_mfma_f32_16x16x32_bf16 v[240:243], a[28:31], a[32:35], 0
    ds_read_b64_tr_b16 a[28:29], v15 offset:32776
    ds_read_b64_tr_b16 a[30:31], v15 offset:36872
    s_waitcnt vmcnt(10)
    s_waitcnt lgkmcnt(10)
    v_mfma_f32_16x16x32_bf16 v[128:131], a[0:3], a[48:51], v[128:131]
    s_add_u32 s61, s58, s59
    s_lshl_b32 s53, s61, 19
    s_lshl_b32 s54, s61, 18
    s_add_u32 s55, s54, 0x8000
    s_add_u32 s59, s59, 1
    s_and_b32 s59, s59, 0
    s_cmp_eq_u32 s59, s60
    s_cselect_b32 s61, 1, 0
    s_add_u32 s58, s58, s61
    v_mfma_f32_16x16x32_bf16 v[132:135], a[0:3], a[52:55], v[132:135]
    buffer_load_dwordx4 a[32:35], v4, s[32:35], s53 offen sc1
    v_mfma_f32_16x16x32_bf16 v[136:139], a[0:3], a[56:59], v[136:139]
    buffer_load_dwordx4 a[36:39], v5, s[32:35], s53 offen sc1
    v_mfma_f32_16x16x32_bf16 v[140:143], a[0:3], a[60:63], v[140:143]
    buffer_load_dwordx4 a[40:43], v6, s[32:35], s53 offen sc1
    v_mfma_f32_16x16x32_bf16 v[156:159], a[4:7], a[60:63], v[156:159]
    ds_read_b64_tr_b16 a[0:1], v24 offset:0
    v_mfma_f32_16x16x32_bf16 v[152:155], a[4:7], a[56:59], v[152:155]
    ds_read_b64_tr_b16 a[2:3], v24 offset:4096
    v_mfma_f32_16x16x32_bf16 v[148:151], a[4:7], a[52:55], v[148:151]
    buffer_load_dwordx4 a[44:47], v7, s[32:35], s53 offen sc1
    v_mfma_f32_16x16x32_bf16 v[144:147], a[4:7], a[48:51], v[144:147]
    ds_write_b128 v16, a[96:99] offset:0
    s_waitcnt lgkmcnt(10)
    v_mfma_f32_16x16x32_bf16 v[160:163], a[8:11], a[48:51], v[160:163]
    ds_read_b64_tr_b16 a[4:5], v24 offset:8
    v_mfma_f32_16x16x32_bf16 v[164:167], a[8:11], a[52:55], v[164:167]
    ds_read_b64_tr_b16 a[6:7], v24 offset:4104
    v_mfma_f32_16x16x32_bf16 v[168:171], a[8:11], a[56:59], v[168:171]
    ds_write_b128 v16, a[100:103] offset:1024
    v_mfma_f32_16x16x32_bf16 v[172:175], a[8:11], a[60:63], v[172:175]
    ds_write_b128 v16, a[104:107] offset:2048
    v_mfma_f32_16x16x32_bf16 v[188:191], a[12:15], a[60:63], v[188:191]
    ds_read_b64_tr_b16 a[8:9], v25 offset:0
    v_mfma_f32_16x16x32_bf16 v[184:187], a[12:15], a[56:59], v[184:187]
    ds_read_b64_tr_b16 a[10:11], v25 offset:4096
    v_mfma_f32_16x16x32_bf16 v[180:183], a[12:15], a[52:55], v[180:183]
    ds_write_b128 v16, a[108:111] offset:3072
    v_mfma_f32_16x16x32_bf16 v[176:179], a[12:15], a[48:51], v[176:179]
    ds_write_b128 v16, a[112:115] offset:4096
    s_waitcnt lgkmcnt(10)
    v_mfma_f32_16x16x32_bf16 v[192:195], a[16:19], a[48:51], v[192:195]
    ds_read_b64_tr_b16 a[12:13], v25 offset:8
    v_mfma_f32_16x16x32_bf16 v[196:199], a[16:19], a[52:55], v[196:199]
    ds_read_b64_tr_b16 a[14:15], v25 offset:4104
    v_mfma_f32_16x16x32_bf16 v[200:203], a[16:19], a[56:59], v[200:203]
    ds_write_b128 v16, a[116:119] offset:5120
    v_mfma_f32_16x16x32_bf16 v[204:207], a[16:19], a[60:63], v[204:207]
    ds_write_b128 v16, a[120:123] offset:6144
    v_mfma_f32_16x16x32_bf16 v[220:223], a[20:23], a[60:63], v[220:223]
    ds_read_b64_tr_b16 a[16:17], v26 offset:0
    v_mfma_f32_16x16x32_bf16 v[216:219], a[20:23], a[56:59], v[216:219]
    ds_read_b64_tr_b16 a[18:19], v26 offset:4096
    v_mfma_f32_16x16x32_bf16 v[212:215], a[20:23], a[52:55], v[212:215]
    ds_write_b128 v16, a[124:127] offset:7168
    v_mfma_f32_16x16x32_bf16 v[208:211], a[20:23], a[48:51], v[208:211]
    s_waitcnt lgkmcnt(10)
    v_mfma_f32_16x16x32_bf16 v[224:227], a[24:27], a[48:51], v[224:227]
    ds_read_b64_tr_b16 a[20:21], v26 offset:8
    v_mfma_f32_16x16x32_bf16 v[228:231], a[24:27], a[52:55], v[228:231]
    ds_read_b64_tr_b16 a[22:23], v26 offset:4104
    v_mfma_f32_16x16x32_bf16 v[232:235], a[24:27], a[56:59], v[232:235]
    v_mfma_f32_16x16x32_bf16 v[236:239], a[24:27], a[60:63], v[236:239]
    v_mfma_f32_16x16x32_bf16 v[252:255], a[28:31], a[60:63], v[252:255]
    ds_read_b64_tr_b16 a[24:25], v27 offset:0
    v_mfma_f32_16x16x32_bf16 v[248:251], a[28:31], a[56:59], v[248:251]
    ds_read_b64_tr_b16 a[26:27], v27 offset:4096
    v_mfma_f32_16x16x32_bf16 v[244:247], a[28:31], a[52:55], v[244:247]
    v_mfma_f32_16x16x32_bf16 v[240:243], a[28:31], a[48:51], v[240:243]
    ds_read_b64_tr_b16 a[28:29], v27 offset:8
    ds_read_b64_tr_b16 a[30:31], v27 offset:4104
    s_waitcnt vmcnt(10)
    s_waitcnt lgkmcnt(10)
    v_mfma_f32_16x16x32_bf16 v[128:131], a[0:3], a[64:67], v[128:131]
    s_add_u32 s61, s58, s59
    s_lshl_b32 s53, s61, 19
    s_lshl_b32 s54, s61, 18
    s_add_u32 s55, s54, 0x8000
    s_add_u32 s59, s59, 1
    s_and_b32 s59, s59, 0
    s_cmp_eq_u32 s59, s60
    s_cselect_b32 s61, 1, 0
    s_add_u32 s58, s58, s61
    v_mfma_f32_16x16x32_bf16 v[132:135], a[0:3], a[68:71], v[132:135]
    buffer_load_dwordx4 a[48:51], v4, s[32:35], s53 offen sc1
    v_mfma_f32_16x16x32_bf16 v[136:139], a[0:3], a[72:75], v[136:139]
    buffer_load_dwordx4 a[52:55], v5, s[32:35], s53 offen sc1
    v_mfma_f32_16x16x32_bf16 v[140:143], a[0:3], a[76:79], v[140:143]
    buffer_load_dwordx4 a[56:59], v6, s[32:35], s53 offen sc1
    v_mfma_f32_16x16x32_bf16 v[156:159], a[4:7], a[76:79], v[156:159]
    ds_read_b64_tr_b16 a[0:1], v24 offset:32768
    v_mfma_f32_16x16x32_bf16 v[152:155], a[4:7], a[72:75], v[152:155]
    ds_read_b64_tr_b16 a[2:3], v24 offset:36864
    v_mfma_f32_16x16x32_bf16 v[148:151], a[4:7], a[68:71], v[148:151]
    buffer_load_dwordx4 a[60:63], v7, s[32:35], s53 offen sc1
    v_mfma_f32_16x16x32_bf16 v[144:147], a[4:7], a[64:67], v[144:147]
    ds_write_b128 v16, a[128:131] offset:32768
    s_waitcnt lgkmcnt(10)
    v_mfma_f32_16x16x32_bf16 v[160:163], a[8:11], a[64:67], v[160:163]
    ds_read_b64_tr_b16 a[4:5], v24 offset:32776
    v_mfma_f32_16x16x32_bf16 v[164:167], a[8:11], a[68:71], v[164:167]
    ds_read_b64_tr_b16 a[6:7], v24 offset:36872
    v_mfma_f32_16x16x32_bf16 v[168:171], a[8:11], a[72:75], v[168:171]
    ds_write_b128 v16, a[132:135] offset:33792
    v_mfma_f32_16x16x32_bf16 v[172:175], a[8:11], a[76:79], v[172:175]
    ds_write_b128 v16, a[136:139] offset:34816
    v_mfma_f32_16x16x32_bf16 v[188:191], a[12:15], a[76:79], v[188:191]
    ds_read_b64_tr_b16 a[8:9], v25 offset:32768
    v_mfma_f32_16x16x32_bf16 v[184:187], a[12:15], a[72:75], v[184:187]
    ds_read_b64_tr_b16 a[10:11], v25 offset:36864
    v_mfma_f32_16x16x32_bf16 v[180:183], a[12:15], a[68:71], v[180:183]
    ds_write_b128 v16, a[140:143] offset:35840
    v_mfma_f32_16x16x32_bf16 v[176:179], a[12:15], a[64:67], v[176:179]
    ds_write_b128 v16, a[144:147] offset:36864
    s_waitcnt lgkmcnt(10)
    v_mfma_f32_16x16x32_bf16 v[192:195], a[16:19], a[64:67], v[192:195]
    ds_read_b64_tr_b16 a[12:13], v25 offset:32776
    v_mfma_f32_16x16x32_bf16 v[196:199], a[16:19], a[68:71], v[196:199]
    ds_read_b64_tr_b16 a[14:15], v25 offset:36872
    v_mfma_f32_16x16x32_bf16 v[200:203], a[16:19], a[72:75], v[200:203]
    ds_write_b128 v16, a[148:151] offset:37888
    v_mfma_f32_16x16x32_bf16 v[204:207], a[16:19], a[76:79], v[204:207]
    ds_write_b128 v16, a[152:155] offset:38912
    v_mfma_f32_16x16x32_bf16 v[220:223], a[20:23], a[76:79], v[220:223]
    ds_read_b64_tr_b16 a[16:17], v26 offset:32768
    v_mfma_f32_16x16x32_bf16 v[216:219], a[20:23], a[72:75], v[216:219]
    ds_read_b64_tr_b16 a[18:19], v26 offset:36864
    v_mfma_f32_16x16x32_bf16 v[212:215], a[20:23], a[68:71], v[212:215]
    ds_write_b128 v16, a[156:159] offset:39936
    v_mfma_f32_16x16x32_bf16 v[208:211], a[20:23], a[64:67], v[208:211]
    s_waitcnt lgkmcnt(10)
    v_mfma_f32_16x16x32_bf16 v[224:227], a[24:27], a[64:67], v[224:227]
    ds_read_b64_tr_b16 a[20:21], v26 offset:32776
    v_mfma_f32_16x16x32_bf16 v[228:231], a[24:27], a[68:71], v[228:231]
    ds_read_b64_tr_b16 a[22:23], v26 offset:36872
    v_mfma_f32_16x16x32_bf16 v[232:235], a[24:27], a[72:75], v[232:235]
    v_mfma_f32_16x16x32_bf16 v[236:239], a[24:27], a[76:79], v[236:239]
    v_mfma_f32_16x16x32_bf16 v[252:255], a[28:31], a[76:79], v[252:255]
    ds_read_b64_tr_b16 a[24:25], v27 offset:32768
    v_mfma_f32_16x16x32_bf16 v[248:251], a[28:31], a[72:75], v[248:251]
    ds_read_b64_tr_b16 a[26:27], v27 offset:36864
    v_mfma_f32_16x16x32_bf16 v[244:247], a[28:31], a[68:71], v[244:247]
    v_mfma_f32_16x16x32_bf16 v[240:243], a[28:31], a[64:67], v[240:243]
    ds_read_b64_tr_b16 a[28:29], v27 offset:32776
    ds_read_b64_tr_b16 a[30:31], v27 offset:36872
    s_waitcnt vmcnt(10)
    s_waitcnt lgkmcnt(10)
    v_mfma_f32_16x16x32_bf16 v[128:131], a[0:3], a[80:83], v[128:131]
    s_add_u32 s61, s58, s59
    s_lshl_b32 s53, s61, 19
    s_lshl_b32 s54, s61, 18
    s_add_u32 s55, s54, 0x8000
    s_add_u32 s59, s59, 1
    s_and_b32 s59, s59, 0
    s_cmp_eq_u32 s59, s60
    s_cselect_b32 s61, 1, 0
    s_add_u32 s58, s58, s61
    v_mfma_f32_16x16x32_bf16 v[132:135], a[0:3], a[84:87], v[132:135]
    buffer_load_dwordx4 a[64:67], v4, s[32:35], s53 offen sc1
    v_mfma_f32_16x16x32_bf16 v[136:139], a[0:3], a[88:91], v[136:139]
    buffer_load_dwordx4 a[68:71], v5, s[32:35], s53 offen sc1
    v_mfma_f32_16x16x32_bf16 v[140:143], a[0:3], a[92:95], v[140:143]
    buffer_load_dwordx4 a[72:75], v6, s[32:35], s53 offen sc1
    v_mfma_f32_16x16x32_bf16 v[156:159], a[4:7], a[92:95], v[156:159]
    ds_read_b64_tr_b16 a[0:1], v12 offset:0
    v_mfma_f32_16x16x32_bf16 v[152:155], a[4:7], a[88:91], v[152:155]
    ds_read_b64_tr_b16 a[2:3], v12 offset:4096
    v_mfma_f32_16x16x32_bf16 v[148:151], a[4:7], a[84:87], v[148:151]
    buffer_load_dwordx4 a[76:79], v7, s[32:35], s53 offen sc1
    v_mfma_f32_16x16x32_bf16 v[144:147], a[4:7], a[80:83], v[144:147]
    ds_write_b128 v17, a[160:163] offset:0
    s_waitcnt lgkmcnt(10)
    v_mfma_f32_16x16x32_bf16 v[160:163], a[8:11], a[80:83], v[160:163]
    ds_read_b64_tr_b16 a[4:5], v12 offset:8
    v_mfma_f32_16x16x32_bf16 v[164:167], a[8:11], a[84:87], v[164:167]
    ds_read_b64_tr_b16 a[6:7], v12 offset:4104
    v_mfma_f32_16x16x32_bf16 v[168:171], a[8:11], a[88:91], v[168:171]
    ds_write_b128 v17, a[164:167] offset:1024
    v_mfma_f32_16x16x32_bf16 v[172:175], a[8:11], a[92:95], v[172:175]
    ds_write_b128 v17, a[168:171] offset:2048
    v_mfma_f32_16x16x32_bf16 v[188:191], a[12:15], a[92:95], v[188:191]
    ds_read_b64_tr_b16 a[8:9], v13 offset:0
    v_mfma_f32_16x16x32_bf16 v[184:187], a[12:15], a[88:91], v[184:187]
    ds_read_b64_tr_b16 a[10:11], v13 offset:4096
    v_mfma_f32_16x16x32_bf16 v[180:183], a[12:15], a[84:87], v[180:183]
    ds_write_b128 v17, a[172:175] offset:3072
    v_mfma_f32_16x16x32_bf16 v[176:179], a[12:15], a[80:83], v[176:179]
    ds_write_b128 v17, a[176:179] offset:4096
    s_waitcnt lgkmcnt(10)
    v_mfma_f32_16x16x32_bf16 v[192:195], a[16:19], a[80:83], v[192:195]
    ds_read_b64_tr_b16 a[12:13], v13 offset:8
    v_mfma_f32_16x16x32_bf16 v[196:199], a[16:19], a[84:87], v[196:199]
    ds_read_b64_tr_b16 a[14:15], v13 offset:4104
    v_mfma_f32_16x16x32_bf16 v[200:203], a[16:19], a[88:91], v[200:203]
    ds_write_b128 v17, a[180:183] offset:5120
    v_mfma_f32_16x16x32_bf16 v[204:207], a[16:19], a[92:95], v[204:207]
    ds_write_b128 v17, a[184:187] offset:6144
    v_mfma_f32_16x16x32_bf16 v[220:223], a[20:23], a[92:95], v[220:223]
    ds_read_b64_tr_b16 a[16:17], v14 offset:0
    v_mfma_f32_16x16x32_bf16 v[216:219], a[20:23], a[88:91], v[216:219]
    ds_read_b64_tr_b16 a[18:19], v14 offset:4096
    v_mfma_f32_16x16x32_bf16 v[212:215], a[20:23], a[84:87], v[212:215]
    ds_write_b128 v17, a[188:191] offset:7168
    v_mfma_f32_16x16x32_bf16 v[208:211], a[20:23], a[80:83], v[208:211]
    s_waitcnt lgkmcnt(10)
    v_mfma_f32_16x16x32_bf16 v[224:227], a[24:27], a[80:83], v[224:227]
    ds_read_b64_tr_b16 a[20:21], v14 offset:8
    v_mfma_f32_16x16x32_bf16 v[228:231], a[24:27], a[84:87], v[228:231]
    ds_read_b64_tr_b16 a[22:23], v14 offset:4104
    v_mfma_f32_16x16x32_bf16 v[232:235], a[24:27], a[88:91], v[232:235]
    v_mfma_f32_16x16x32_bf16 v[236:239], a[24:27], a[92:95], v[236:239]
    v_mfma_f32_16x16x32_bf16 v[252:255], a[28:31], a[92:95], v[252:255]
    ds_read_b64_tr_b16 a[24:25], v15 offset:0
    v_mfma_f32_16x16x32_bf16 v[248:251], a[28:31], a[88:91], v[248:251]
    ds_read_b64_tr_b16 a[26:27], v15 offset:4096
    v_mfma_f32_16x16x32_bf16 v[244:247], a[28:31], a[84:87], v[244:247]
    v_mfma_f32_16x16x32_bf16 v[240:243], a[28:31], a[80:83], v[240:243]
    ds_read_b64_tr_b16 a[28:29], v15 offset:8
    ds_read_b64_tr_b16 a[30:31], v15 offset:4104
    s_waitcnt vmcnt(8)
    s_waitcnt lgkmcnt(10)
    v_mfma_f32_16x16x32_bf16 v[128:131], a[0:3], a[32:35], v[128:131]
    s_add_u32 s61, s58, s59
    s_lshl_b32 s53, s61, 19
    s_lshl_b32 s54, s61, 18
    s_add_u32 s55, s54, 0x8000
    s_add_u32 s59, s59, 1
    s_and_b32 s59, s59, 0
    s_cmp_eq_u32 s59, s60
    s_cselect_b32 s61, 1, 0
    s_add_u32 s58, s58, s61
    v_mfma_f32_16x16x32_bf16 v[132:135], a[0:3], a[36:39], v[132:135]
    buffer_load_dwordx4 a[80:83], v4, s[32:35], s53 offen sc1
    v_mfma_f32_16x16x32_bf16 v[136:139], a[0:3], a[40:43], v[136:139]
    buffer_load_dwordx4 a[84:87], v5, s[32:35], s53 offen sc1
    v_mfma_f32_16x16x32_bf16 v[140:143], a[0:3], a[44:47], v[140:143]
    buffer_load_dwordx4 a[88:91], v6, s[32:35], s53 offen sc1
    v_mfma_f32_16x16x32_bf16 v[156:159], a[4:7], a[44:47], v[156:159]
    ds_read_b64_tr_b16 a[0:1], v12 offset:32768
    v_mfma_f32_16x16x32_bf16 v[152:155], a[4:7], a[40:43], v[152:155]
    ds_read_b64_tr_b16 a[2:3], v12 offset:36864
    v_mfma_f32_16x16x32_bf16 v[148:151], a[4:7], a[36:39], v[148:151]
    buffer_load_dwordx4 a[92:95], v7, s[32:35], s53 offen sc1
    v_mfma_f32_16x16x32_bf16 v[144:147], a[4:7], a[32:35], v[144:147]
    ds_write_b128 v17, a[192:195] offset:32768
    s_waitcnt lgkmcnt(10)
    v_mfma_f32_16x16x32_bf16 v[160:163], a[8:11], a[32:35], v[160:163]
    ds_read_b64_tr_b16 a[4:5], v12 offset:32776
    v_mfma_f32_16x16x32_bf16 v[164:167], a[8:11], a[36:39], v[164:167]
    ds_read_b64_tr_b16 a[6:7], v12 offset:36872
    v_mfma_f32_16x16x32_bf16 v[168:171], a[8:11], a[40:43], v[168:171]
    ds_write_b128 v17, a[196:199] offset:33792
    v_mfma_f32_16x16x32_bf16 v[172:175], a[8:11], a[44:47], v[172:175]
    ds_write_b128 v17, a[200:203] offset:34816
    v_mfma_f32_16x16x32_bf16 v[188:191], a[12:15], a[44:47], v[188:191]
    ds_read_b64_tr_b16 a[8:9], v13 offset:32768
    v_mfma_f32_16x16x32_bf16 v[184:187], a[12:15], a[40:43], v[184:187]
    ds_read_b64_tr_b16 a[10:11], v13 offset:36864
    v_mfma_f32_16x16x32_bf16 v[180:183], a[12:15], a[36:39], v[180:183]
    ds_write_b128 v17, a[204:207] offset:35840
    v_mfma_f32_16x16x32_bf16 v[176:179], a[12:15], a[32:35], v[176:179]
    ds_write_b128 v17, a[208:211] offset:36864
    s_waitcnt lgkmcnt(10)
    v_mfma_f32_16x16x32_bf16 v[192:195], a[16:19], a[32:35], v[192:195]
    ds_read_b64_tr_b16 a[12:13], v13 offset:32776
    v_mfma_f32_16x16x32_bf16 v[196:199], a[16:19], a[36:39], v[196:199]
    ds_read_b64_tr_b16 a[14:15], v13 offset:36872
    v_mfma_f32_16x16x32_bf16 v[200:203], a[16:19], a[40:43], v[200:203]
    ds_write_b128 v17, a[212:215] offset:37888
    v_mfma_f32_16x16x32_bf16 v[204:207], a[16:19], a[44:47], v[204:207]
    ds_write_b128 v17, a[216:219] offset:38912
    v_mfma_f32_16x16x32_bf16 v[220:223], a[20:23], a[44:47], v[220:223]
    ds_read_b64_tr_b16 a[16:17], v14 offset:32768
    v_mfma_f32_16x16x32_bf16 v[216:219], a[20:23], a[40:43], v[216:219]
    ds_read_b64_tr_b16 a[18:19], v14 offset:36864
    v_mfma_f32_16x16x32_bf16 v[212:215], a[20:23], a[36:39], v[212:215]
    ds_write_b128 v17, a[220:223] offset:39936
    v_mfma_f32_16x16x32_bf16 v[208:211], a[20:23], a[32:35], v[208:211]
    buffer_load_dword v114, v112, s[24:27], s21 offen
    s_waitcnt lgkmcnt(10)
    v_mfma_f32_16x16x32_bf16 v[224:227], a[24:27], a[32:35], v[224:227]
    ds_read_b64_tr_b16 a[20:21], v14 offset:32776
    v_mfma_f32_16x16x32_bf16 v[228:231], a[24:27], a[36:39], v[228:231]
    ds_read_b64_tr_b16 a[22:23], v14 offset:36872
    v_mfma_f32_16x16x32_bf16 v[232:235], a[24:27], a[40:43], v[232:235]
    v_mfma_f32_16x16x32_bf16 v[236:239], a[24:27], a[44:47], v[236:239]
    v_mfma_f32_16x16x32_bf16 v[252:255], a[28:31], a[44:47], v[252:255]
    ds_read_b64_tr_b16 a[24:25], v15 offset:32768
    v_mfma_f32_16x16x32_bf16 v[248:251], a[28:31], a[40:43], v[248:251]
    ds_read_b64_tr_b16 a[26:27], v15 offset:36864
    v_mfma_f32_16x16x32_bf16 v[244:247], a[28:31], a[36:39], v[244:247]
    v_mfma_f32_16x16x32_bf16 v[240:243], a[28:31], a[32:35], v[240:243]
    ds_read_b64_tr_b16 a[28:29], v15 offset:32776
    ds_read_b64_tr_b16 a[30:31], v15 offset:36872
    s_waitcnt vmcnt(9)
    s_waitcnt lgkmcnt(10)
    v_mfma_f32_16x16x32_bf16 v[128:131], a[0:3], a[48:51], v[128:131]
    v_mfma_f32_16x16x32_bf16 v[132:135], a[0:3], a[52:55], v[132:135]
    v_mfma_f32_16x16x32_bf16 v[136:139], a[0:3], a[56:59], v[136:139]
    v_mfma_f32_16x16x32_bf16 v[140:143], a[0:3], a[60:63], v[140:143]
    v_mfma_f32_16x16x32_bf16 v[156:159], a[4:7], a[60:63], v[156:159]
    ds_read_b64_tr_b16 a[0:1], v24 offset:0
    v_mfma_f32_16x16x32_bf16 v[152:155], a[4:7], a[56:59], v[152:155]
    ds_read_b64_tr_b16 a[2:3], v24 offset:4096
    v_mfma_f32_16x16x32_bf16 v[148:151], a[4:7], a[52:55], v[148:151]
    v_mfma_f32_16x16x32_bf16 v[144:147], a[4:7], a[48:51], v[144:147]
    s_waitcnt lgkmcnt(10)
    v_mfma_f32_16x16x32_bf16 v[160:163], a[8:11], a[48:51], v[160:163]
    ds_read_b64_tr_b16 a[4:5], v24 offset:8
    v_mfma_f32_16x16x32_bf16 v[164:167], a[8:11], a[52:55], v[164:167]
    ds_read_b64_tr_b16 a[6:7], v24 offset:4104
    v_mfma_f32_16x16x32_bf16 v[168:171], a[8:11], a[56:59], v[168:171]
    v_mfma_f32_16x16x32_bf16 v[172:175], a[8:11], a[60:63], v[172:175]
    v_mfma_f32_16x16x32_bf16 v[188:191], a[12:15], a[60:63], v[188:191]
    ds_read_b64_tr_b16 a[8:9], v25 offset:0
    v_mfma_f32_16x16x32_bf16 v[184:187], a[12:15], a[56:59], v[184:187]
    ds_read_b64_tr_b16 a[10:11], v25 offset:4096
    v_mfma_f32_16x16x32_bf16 v[180:183], a[12:15], a[52:55], v[180:183]
    v_mfma_f32_16x16x32_bf16 v[176:179], a[12:15], a[48:51], v[176:179]
    s_waitcnt lgkmcnt(10)
    v_mfma_f32_16x16x32_bf16 v[192:195], a[16:19], a[48:51], v[192:195]
    ds_read_b64_tr_b16 a[12:13], v25 offset:8
    v_mfma_f32_16x16x32_bf16 v[196:199], a[16:19], a[52:55], v[196:199]
    ds_read_b64_tr_b16 a[14:15], v25 offset:4104
    v_mfma_f32_16x16x32_bf16 v[200:203], a[16:19], a[56:59], v[200:203]
    v_mfma_f32_16x16x32_bf16 v[204:207], a[16:19], a[60:63], v[204:207]
    v_mfma_f32_16x16x32_bf16 v[220:223], a[20:23], a[60:63], v[220:223]
    ds_read_b64_tr_b16 a[16:17], v26 offset:0
    v_mfma_f32_16x16x32_bf16 v[216:219], a[20:23], a[56:59], v[216:219]
    ds_read_b64_tr_b16 a[18:19], v26 offset:4096
    v_mfma_f32_16x16x32_bf16 v[212:215], a[20:23], a[52:55], v[212:215]
    v_mfma_f32_16x16x32_bf16 v[208:211], a[20:23], a[48:51], v[208:211]
    s_waitcnt lgkmcnt(10)
    v_mfma_f32_16x16x32_bf16 v[224:227], a[24:27], a[48:51], v[224:227]
    ds_read_b64_tr_b16 a[20:21], v26 offset:8
    v_mfma_f32_16x16x32_bf16 v[228:231], a[24:27], a[52:55], v[228:231]
    ds_read_b64_tr_b16 a[22:23], v26 offset:4104
    v_mfma_f32_16x16x32_bf16 v[232:235], a[24:27], a[56:59], v[232:235]
    v_mfma_f32_16x16x32_bf16 v[236:239], a[24:27], a[60:63], v[236:239]
    v_mfma_f32_16x16x32_bf16 v[252:255], a[28:31], a[60:63], v[252:255]
    ds_read_b64_tr_b16 a[24:25], v27 offset:0
    v_mfma_f32_16x16x32_bf16 v[248:251], a[28:31], a[56:59], v[248:251]
    ds_read_b64_tr_b16 a[26:27], v27 offset:4096
    v_mfma_f32_16x16x32_bf16 v[244:247], a[28:31], a[52:55], v[244:247]
    v_mfma_f32_16x16x32_bf16 v[240:243], a[28:31], a[48:51], v[240:243]
    ds_read_b64_tr_b16 a[28:29], v27 offset:8
    ds_read_b64_tr_b16 a[30:31], v27 offset:4104
    s_waitcnt vmcnt(5)
    s_waitcnt lgkmcnt(10)
    v_mfma_f32_16x16x32_bf16 v[128:131], a[0:3], a[64:67], v[128:131]
    v_add_f32 v64, v64, v68
    v_add_f32 v65, v65, v69
    v_mfma_f32_16x16x32_bf16 v[132:135], a[0:3], a[68:71], v[132:135]
    v_add_f32 v66, v66, v70
    v_add_f32 v67, v67, v71
    v_mfma_f32_16x16x32_bf16 v[136:139], a[0:3], a[72:75], v[136:139]
    v_cvt_pk_bf16_f32 v65, v64, v65
    v_lshlrev_b32 v64, 16, v65
    v_mfma_f32_16x16x32_bf16 v[140:143], a[0:3], a[76:79], v[140:143]
    v_and_b32 v65, 0xffff0000, v65
    v_cvt_pk_bf16_f32 v67, v66, v67
    v_mfma_f32_16x16x32_bf16 v[156:159], a[4:7], a[76:79], v[156:159]
    ds_read_b64_tr_b16 a[0:1], v24 offset:32768
    v_mfma_f32_16x16x32_bf16 v[152:155], a[4:7], a[72:75], v[152:155]
    ds_read_b64_tr_b16 a[2:3], v24 offset:36864
    v_mfma_f32_16x16x32_bf16 v[148:151], a[4:7], a[68:71], v[148:151]
    v_lshlrev_b32 v66, 16, v67
    v_and_b32 v67, 0xffff0000, v67
    v_mfma_f32_16x16x32_bf16 v[144:147], a[4:7], a[64:67], v[144:147]
    v_add_f32 v64, v80, v64
    v_add_f32 v65, v80, v65
    s_waitcnt lgkmcnt(10)
    v_mfma_f32_16x16x32_bf16 v[160:163], a[8:11], a[64:67], v[160:163]
    ds_read_b64_tr_b16 a[4:5], v24 offset:32776
    v_mfma_f32_16x16x32_bf16 v[164:167], a[8:11], a[68:71], v[164:167]
    ds_read_b64_tr_b16 a[6:7], v24 offset:36872
    v_mfma_f32_16x16x32_bf16 v[168:171], a[8:11], a[72:75], v[168:171]
    v_add_f32 v66, v80, v66
    v_add_f32 v67, v80, v67
    v_mfma_f32_16x16x32_bf16 v[172:175], a[8:11], a[76:79], v[172:175]
    v_cvt_pk_bf16_f32 v65, v64, v65
    v_lshlrev_b32 v64, 16, v65
    v_mfma_f32_16x16x32_bf16 v[188:191], a[12:15], a[76:79], v[188:191]
    ds_read_b64_tr_b16 a[8:9], v25 offset:32768
    v_mfma_f32_16x16x32_bf16 v[184:187], a[12:15], a[72:75], v[184:187]
    ds_read_b64_tr_b16 a[10:11], v25 offset:36864
    v_mfma_f32_16x16x32_bf16 v[180:183], a[12:15], a[68:71], v[180:183]
    v_and_b32 v65, 0xffff0000, v65
    v_cvt_pk_bf16_f32 v67, v66, v67
    v_mfma_f32_16x16x32_bf16 v[176:179], a[12:15], a[64:67], v[176:179]
    v_lshlrev_b32 v66, 16, v67
    v_and_b32 v67, 0xffff0000, v67
    s_waitcnt lgkmcnt(10)
    v_mfma_f32_16x16x32_bf16 v[192:195], a[16:19], a[64:67], v[192:195]
    ds_read_b64_tr_b16 a[12:13], v25 offset:32776
    v_mfma_f32_16x16x32_bf16 v[196:199], a[16:19], a[68:71], v[196:199]
    ds_read_b64_tr_b16 a[14:15], v25 offset:36872
    v_mfma_f32_16x16x32_bf16 v[200:203], a[16:19], a[72:75], v[200:203]
    ds_write_b128 v82, v[64:67]
    v_mfma_f32_16x16x32_bf16 v[204:207], a[16:19], a[76:79], v[204:207]
    v_mfma_f32_16x16x32_bf16 v[220:223], a[20:23], a[76:79], v[220:223]
    ds_read_b64_tr_b16 a[16:17], v26 offset:32768
    v_mfma_f32_16x16x32_bf16 v[216:219], a[20:23], a[72:75], v[216:219]
    ds_read_b64_tr_b16 a[18:19], v26 offset:36864
    v_mfma_f32_16x16x32_bf16 v[212:215], a[20:23], a[68:71], v[212:215]
    v_mfma_f32_16x16x32_bf16 v[208:211], a[20:23], a[64:67], v[208:211]
    s_waitcnt lgkmcnt(10)
    v_mfma_f32_16x16x32_bf16 v[224:227], a[24:27], a[64:67], v[224:227]
    ds_read_b64_tr_b16 a[20:21], v26 offset:32776
    v_mfma_f32_16x16x32_bf16 v[228:231], a[24:27], a[68:71], v[228:231]
    ds_read_b64_tr_b16 a[22:23], v26 offset:36872
    v_mfma_f32_16x16x32_bf16 v[232:235], a[24:27], a[72:75], v[232:235]
    v_mfma_f32_16x16x32_bf16 v[236:239], a[24:27], a[76:79], v[236:239]
    v_mfma_f32_16x16x32_bf16 v[252:255], a[28:31], a[76:79], v[252:255]
    ds_read_b64_tr_b16 a[24:25], v27 offset:32768
    v_mfma_f32_16x16x32_bf16 v[248:251], a[28:31], a[72:75], v[248:251]
    ds_read_b64_tr_b16 a[26:27], v27 offset:36864
    v_mfma_f32_16x16x32_bf16 v[244:247], a[28:31], a[68:71], v[244:247]
    v_mfma_f32_16x16x32_bf16 v[240:243], a[28:31], a[64:67], v[240:243]
    ds_read_b64_tr_b16 a[28:29], v27 offset:32776
    ds_read_b64_tr_b16 a[30:31], v27 offset:36872
    s_waitcnt vmcnt(1)
    s_waitcnt lgkmcnt(14)
    v_mfma_f32_16x16x32_bf16 v[128:131], a[0:3], a[80:83], v[128:131]
    v_mfma_f32_16x16x32_bf16 v[132:135], a[0:3], a[84:87], v[132:135]
    v_mfma_f32_16x16x32_bf16 v[136:139], a[0:3], a[88:91], v[136:139]
    v_mfma_f32_16x16x32_bf16 v[140:143], a[0:3], a[92:95], v[140:143]
    s_waitcnt lgkmcnt(12)
    v_mfma_f32_16x16x32_bf16 v[156:159], a[4:7], a[92:95], v[156:159]
    v_mfma_f32_16x16x32_bf16 v[152:155], a[4:7], a[88:91], v[152:155]
    v_mfma_f32_16x16x32_bf16 v[148:151], a[4:7], a[84:87], v[148:151]
    v_mfma_f32_16x16x32_bf16 v[144:147], a[4:7], a[80:83], v[144:147]
    s_waitcnt lgkmcnt(10)
    v_mfma_f32_16x16x32_bf16 v[160:163], a[8:11], a[80:83], v[160:163]
    v_mfma_f32_16x16x32_bf16 v[164:167], a[8:11], a[84:87], v[164:167]
    ds_write_b128 v16, v[132:135] offset:0
    v_mfma_f32_16x16x32_bf16 v[168:171], a[8:11], a[88:91], v[168:171]
    ds_write_b128 v16, v[136:139] offset:32768
    v_mfma_f32_16x16x32_bf16 v[172:175], a[8:11], a[92:95], v[172:175]
    ds_write_b128 v17, v[140:143] offset:0
    s_waitcnt lgkmcnt(11)
    v_mfma_f32_16x16x32_bf16 v[188:191], a[12:15], a[92:95], v[188:191]
    v_mfma_f32_16x16x32_bf16 v[184:187], a[12:15], a[88:91], v[184:187]
    ds_write_b128 v16, v[148:151] offset:1024
    v_mfma_f32_16x16x32_bf16 v[180:183], a[12:15], a[84:87], v[180:183]
    ds_write_b128 v16, v[152:155] offset:33792
    v_mfma_f32_16x16x32_bf16 v[176:179], a[12:15], a[80:83], v[176:179]
    ds_write_b128 v17, v[156:159] offset:1024
    s_waitcnt lgkmcnt(12)
    v_mfma_f32_16x16x32_bf16 v[192:195], a[16:19], a[80:83], v[192:195]
    v_mfma_f32_16x16x32_bf16 v[196:199], a[16:19], a[84:87], v[196:199]
    ds_write_b128 v16, v[164:167] offset:2048
    v_mfma_f32_16x16x32_bf16 v[200:203], a[16:19], a[88:91], v[200:203]
    ds_write_b128 v16, v[168:171] offset:34816
    v_mfma_f32_16x16x32_bf16 v[204:207], a[16:19], a[92:95], v[204:207]
    ds_write_b128 v17, v[172:175] offset:2048
    s_waitcnt lgkmcnt(13)
    v_mfma_f32_16x16x32_bf16 v[220:223], a[20:23], a[92:95], v[220:223]
    v_mfma_f32_16x16x32_bf16 v[216:219], a[20:23], a[88:91], v[216:219]
    ds_write_b128 v16, v[180:183] offset:3072
    v_mfma_f32_16x16x32_bf16 v[212:215], a[20:23], a[84:87], v[212:215]
    ds_write_b128 v16, v[184:187] offset:35840
    v_mfma_f32_16x16x32_bf16 v[208:211], a[20:23], a[80:83], v[208:211]
    ds_write_b128 v17, v[188:191] offset:3072
    s_waitcnt lgkmcnt(14)
    v_mfma_f32_16x16x32_bf16 v[224:227], a[24:27], a[80:83], v[224:227]
    v_mfma_f32_16x16x32_bf16 v[228:231], a[24:27], a[84:87], v[228:231]
    ds_write_b128 v16, v[196:199] offset:4096
    v_mfma_f32_16x16x32_bf16 v[232:235], a[24:27], a[88:91], v[232:235]
    ds_write_b128 v16, v[200:203] offset:36864
    v_mfma_f32_16x16x32_bf16 v[236:239], a[24:27], a[92:95], v[236:239]
    ds_write_b128 v17, v[204:207] offset:4096
    s_waitcnt lgkmcnt(15)
    v_mfma_f32_16x16x32_bf16 v[252:255], a[28:31], a[92:95], v[252:255]
    v_mfma_f32_16x16x32_bf16 v[248:251], a[28:31], a[88:91], v[248:251]
    ds_write_b128 v16, v[212:215] offset:5120
    v_mfma_f32_16x16x32_bf16 v[244:247], a[28:31], a[84:87], v[244:247]
    ds_write_b128 v16, v[216:219] offset:37888
    v_mfma_f32_16x16x32_bf16 v[240:243], a[28:31], a[80:83], v[240:243]
    ds_write_b128 v17, v[220:223] offset:5120
    v_add_u32 v16, s52, v2
    v_add_u32 v17, 0x10000, v16
    s_xor_b32 s61, s3, 1
    s_lshl_b32 s61, s61, 13
    s_add_u32 s61, s61, 0
    v_add_u32 v24, s61, v2
    s_xor_b32 s61, s3, 2
    s_lshl_b32 s61, s61, 13
    s_add_u32 s61, s61, 32768
    v_add_u32 v25, s61, v2
    s_xor_b32 s61, s3, 3
    s_lshl_b32 s61, s61, 13
    s_add_u32 s61, s61, 65536
    v_add_u32 v26, s61, v2
    ds_write_b128 v16, v[228:231] offset:6144
    ds_write_b128 v16, v[232:235] offset:38912
    ds_write_b128 v17, v[236:239] offset:6144
    ds_write_b128 v16, v[244:247] offset:7168
    ds_write_b128 v16, v[248:251] offset:39936
    ds_write_b128 v17, v[252:255] offset:7168
    s_waitcnt lgkmcnt(0)
    s_barrier
    ds_read_b128 v[32:35], v20 offset:0
    ds_read_b128 v[36:39], v20 offset:16
    ds_read_b128 v[40:43], v20 offset:128
    ds_read_b128 v[44:47], v20 offset:144
    ds_read_b128 v[48:51], v20 offset:256
    ds_read_b128 v[52:55], v20 offset:272
    ds_read_b128 v[56:59], v20 offset:384
    ds_read_b128 v[60:63], v20 offset:400
    ds_read_b128 v[132:135], v24 offset:0
    ds_read_b128 v[148:151], v24 offset:1024
    ds_read_b128 v[164:167], v24 offset:2048
    ds_read_b128 v[180:183], v24 offset:3072
    ds_read_b128 v[196:199], v24 offset:4096
    ds_read_b128 v[212:215], v24 offset:5120
    ds_read_b128 v[228:231], v24 offset:6144
    ds_read_b128 v[244:247], v24 offset:7168
    ds_read_b128 v[136:139], v25 offset:0
    ds_read_b128 v[152:155], v25 offset:1024
    ds_read_b128 v[168:171], v25 offset:2048
    ds_read_b128 v[184:187], v25 offset:3072
    ds_read_b128 v[200:203], v25 offset:4096
    ds_read_b128 v[216:219], v25 offset:5120
    ds_read_b128 v[232:235], v25 offset:6144
    ds_read_b128 v[248:251], v25 offset:7168
    ds_read_b128 v[140:143], v26 offset:0
    ds_read_b128 v[156:159], v26 offset:1024
    ds_read_b128 v[172:175], v26 offset:2048
    ds_read_b128 v[188:191], v26 offset:3072
    ds_read_b128 v[204:207], v26 offset:4096
    ds_read_b128 v[220:223], v26 offset:5120
    ds_read_b128 v[236:239], v26 offset:6144
    ds_read_b128 v[252:255], v26 offset:7168
    s_waitcnt lgkmcnt(15)
    v_pk_add_f32 v[128:129], v[128:129], v[132:133]
    v_pk_add_f32 v[130:131], v[130:131], v[134:135]
    v_pk_add_f32 v[144:145], v[144:145], v[148:149]
    v_pk_add_f32 v[146:147], v[146:147], v[150:151]
    v_pk_add_f32 v[160:161], v[160:161], v[164:165]
    v_pk_add_f32 v[162:163], v[162:163], v[166:167]
    v_pk_add_f32 v[176:177], v[176:177], v[180:181]
    v_pk_add_f32 v[178:179], v[178:179], v[182:183]
    v_pk_add_f32 v[192:193], v[192:193], v[196:197]
    v_pk_add_f32 v[194:195], v[194:195], v[198:199]
    v_pk_add_f32 v[208:209], v[208:209], v[212:213]
    v_pk_add_f32 v[210:211], v[210:211], v[214:215]
    v_pk_add_f32 v[224:225], v[224:225], v[228:229]
    v_pk_add_f32 v[226:227], v[226:227], v[230:231]
    v_pk_add_f32 v[240:241], v[240:241], v[244:245]
    v_pk_add_f32 v[242:243], v[242:243], v[246:247]
    s_waitcnt lgkmcnt(15)
    v_pk_add_f32 v[128:129], v[128:129], v[136:137]
    v_pk_add_f32 v[130:131], v[130:131], v[138:139]
    s_waitcnt lgkmcnt(14)
    v_pk_add_f32 v[144:145], v[144:145], v[152:153]
    v_pk_add_f32 v[146:147], v[146:147], v[154:155]
    s_waitcnt lgkmcnt(13)
    v_pk_add_f32 v[160:161], v[160:161], v[168:169]
    v_pk_add_f32 v[162:163], v[162:163], v[170:171]
    s_waitcnt lgkmcnt(12)
    v_pk_add_f32 v[176:177], v[176:177], v[184:185]
    v_pk_add_f32 v[178:179], v[178:179], v[186:187]
    s_waitcnt lgkmcnt(11)
    v_pk_add_f32 v[192:193], v[192:193], v[200:201]
    v_pk_add_f32 v[194:195], v[194:195], v[202:203]
    s_waitcnt lgkmcnt(10)
    v_pk_add_f32 v[208:209], v[208:209], v[216:217]
    v_pk_add_f32 v[210:211], v[210:211], v[218:219]
    s_waitcnt lgkmcnt(9)
    v_pk_add_f32 v[224:225], v[224:225], v[232:233]
    v_pk_add_f32 v[226:227], v[226:227], v[234:235]
    s_waitcnt lgkmcnt(8)
    v_pk_add_f32 v[240:241], v[240:241], v[248:249]
    v_pk_add_f32 v[242:243], v[242:243], v[250:251]
    s_waitcnt lgkmcnt(7)
    v_pk_add_f32 v[128:129], v[128:129], v[140:141]
    v_pk_add_f32 v[130:131], v[130:131], v[142:143]
    s_waitcnt lgkmcnt(6)
    v_pk_add_f32 v[144:145], v[144:145], v[156:157]
    v_pk_add_f32 v[146:147], v[146:147], v[158:159]
    s_waitcnt lgkmcnt(5)
    v_pk_add_f32 v[160:161], v[160:161], v[172:173]
    v_pk_add_f32 v[162:163], v[162:163], v[174:175]
    s_waitcnt lgkmcnt(4)
    v_pk_add_f32 v[176:177], v[176:177], v[188:189]
    v_pk_add_f32 v[178:179], v[178:179], v[190:191]
    s_waitcnt lgkmcnt(3)
    v_pk_add_f32 v[192:193], v[192:193], v[204:205]
    v_pk_add_f32 v[194:195], v[194:195], v[206:207]
    s_waitcnt lgkmcnt(2)
    v_pk_add_f32 v[208:209], v[208:209], v[220:221]
    v_pk_add_f32 v[210:211], v[210:211], v[222:223]
    s_waitcnt lgkmcnt(1)
    v_pk_add_f32 v[224:225], v[224:225], v[236:237]
    v_pk_add_f32 v[226:227], v[226:227], v[238:239]
    s_waitcnt lgkmcnt(0)
    v_pk_add_f32 v[240:241], v[240:241], v[252:253]
    v_pk_add_f32 v[242:243], v[242:243], v[254:255]
    s_barrier
    v_lshlrev_b32 v64, 16, v96
    v_and_b32 v65, 0xffff0000, v96
    v_pk_fma_f32 v[64:65], v[32:33], v[128:129], v[64:65]
    v_lshlrev_b32 v66, 16, v97
    v_and_b32 v67, 0xffff0000, v97
    v_pk_fma_f32 v[66:67], v[34:35], v[130:131], v[66:67]
    v_lshlrev_b32 v68, 16, v98
    v_and_b32 v69, 0xffff0000, v98
    v_pk_fma_f32 v[68:69], v[36:37], v[144:145], v[68:69]
    v_lshlrev_b32 v70, 16, v99
    v_and_b32 v71, 0xffff0000, v99
    v_pk_fma_f32 v[70:71], v[38:39], v[146:147], v[70:71]
    v_lshlrev_b32 v72, 16, v100
    v_and_b32 v73, 0xffff0000, v100
    v_pk_fma_f32 v[72:73], v[40:41], v[160:161], v[72:73]
    v_lshlrev_b32 v74, 16, v101
    v_and_b32 v75, 0xffff0000, v101
    v_pk_fma_f32 v[74:75], v[42:43], v[162:163], v[74:75]
    v_lshlrev_b32 v76, 16, v102
    v_and_b32 v77, 0xffff0000, v102
    v_pk_fma_f32 v[76:77], v[44:45], v[176:177], v[76:77]
    v_lshlrev_b32 v78, 16, v103
    v_and_b32 v79, 0xffff0000, v103
    v_pk_fma_f32 v[78:79], v[46:47], v[178:179], v[78:79]
    v_lshlrev_b32 v80, 16, v104
    v_and_b32 v81, 0xffff0000, v104
    v_pk_fma_f32 v[80:81], v[48:49], v[192:193], v[80:81]
    v_lshlrev_b32 v82, 16, v105
    v_and_b32 v83, 0xffff0000, v105
    v_pk_fma_f32 v[82:83], v[50:51], v[194:195], v[82:83]
    v_lshlrev_b32 v84, 16, v106
    v_and_b32 v85, 0xffff0000, v106
    v_pk_fma_f32 v[84:85], v[52:53], v[208:209], v[84:85]
    v_lshlrev_b32 v86, 16, v107
    v_and_b32 v87, 0xffff0000, v107
    v_pk_fma_f32 v[86:87], v[54:55], v[210:211], v[86:87]
    v_lshlrev_b32 v88, 16, v108
    v_and_b32 v89, 0xffff0000, v108
    v_pk_fma_f32 v[88:89], v[56:57], v[224:225], v[88:89]
    v_lshlrev_b32 v90, 16, v109
    v_and_b32 v91, 0xffff0000, v109
    v_pk_fma_f32 v[90:91], v[58:59], v[226:227], v[90:91]
    v_lshlrev_b32 v92, 16, v110
    v_and_b32 v93, 0xffff0000, v110
    v_pk_fma_f32 v[92:93], v[60:61], v[240:241], v[92:93]
    v_lshlrev_b32 v94, 16, v111
    v_and_b32 v95, 0xffff0000, v111
    v_pk_fma_f32 v[94:95], v[62:63], v[242:243], v[94:95]
    ds_read_b128 v[128:131], v20 offset:512
    ds_read_b128 v[132:135], v20 offset:528
    ds_read_b128 v[136:139], v20 offset:640
    ds_read_b128 v[140:143], v20 offset:656
    ds_read_b128 v[144:147], v20 offset:768
    ds_read_b128 v[148:151], v20 offset:784
    ds_read_b128 v[152:155], v20 offset:896
    ds_read_b128 v[156:159], v20 offset:912
    ds_read_b128 v[160:163], v20 offset:1024
    ds_read_b128 v[164:167], v20 offset:1040
    ds_read_b128 v[168:171], v20 offset:1152
    ds_read_b128 v[172:175], v20 offset:1168
    ds_read_b128 v[176:179], v20 offset:1280
    ds_read_b128 v[180:183], v20 offset:1296
    ds_read_b128 v[184:187], v20 offset:1408
    ds_read_b128 v[188:191], v20 offset:1424
    v_pk_add_f32 v[32:33], v[64:65], v[66:67]
    v_pk_add_f32 v[34:35], v[68:69], v[70:71]
    v_pk_add_f32 v[36:37], v[72:73], v[74:75]
    v_pk_add_f32 v[38:39], v[76:77], v[78:79]
    v_pk_add_f32 v[40:41], v[80:81], v[82:83]
    v_pk_add_f32 v[42:43], v[84:85], v[86:87]
    v_pk_add_f32 v[44:45], v[88:89], v[90:91]
    v_pk_add_f32 v[46:47], v[92:93], v[94:95]
    v_pk_add_f32 v[32:33], v[32:33], v[40:41]
    v_pk_add_f32 v[34:35], v[34:35], v[42:43]
    v_pk_add_f32 v[36:37], v[36:37], v[44:45]
    v_pk_add_f32 v[38:39], v[38:39], v[46:47]
    v_pk_add_f32 v[32:33], v[32:33], v[36:37]
    v_pk_add_f32 v[34:35], v[34:35], v[38:39]
    v_pk_add_f32 v[32:33], v[32:33], v[34:35]
    v_add_f32 v16, v32, v33
    v_mov_b32 v18, v16
    s_nop 1
    v_permlane16_swap_b32 v16, v18
    v_add_f32 v16, v16, v18
    v_mov_b32 v18, v16
    s_nop 1
    v_permlane32_swap_b32 v16, v18
    v_add_f32 v16, v16, v18
    v_mul_f32 v16, 0x3c000000, v16
    v_pk_add_f32 v[32:33], v[64:65], v[16:17] op_sel_hi:[1,0] neg_lo:[0,1] neg_hi:[0,1]
    v_pk_add_f32 v[34:35], v[66:67], v[16:17] op_sel_hi:[1,0] neg_lo:[0,1] neg_hi:[0,1]
    v_pk_add_f32 v[36:37], v[68:69], v[16:17] op_sel_hi:[1,0] neg_lo:[0,1] neg_hi:[0,1]
    v_pk_add_f32 v[38:39], v[70:71], v[16:17] op_sel_hi:[1,0] neg_lo:[0,1] neg_hi:[0,1]
    v_pk_add_f32 v[40:41], v[72:73], v[16:17] op_sel_hi:[1,0] neg_lo:[0,1] neg_hi:[0,1]
    v_pk_add_f32 v[42:43], v[74:75], v[16:17] op_sel_hi:[1,0] neg_lo:[0,1] neg_hi:[0,1]
    v_pk_add_f32 v[44:45], v[76:77], v[16:17] op_sel_hi:[1,0] neg_lo:[0,1] neg_hi:[0,1]
    v_pk_add_f32 v[46:47], v[78:79], v[16:17] op_sel_hi:[1,0] neg_lo:[0,1] neg_hi:[0,1]
    v_pk_add_f32 v[48:49], v[80:81], v[16:17] op_sel_hi:[1,0] neg_lo:[0,1] neg_hi:[0,1]
    v_pk_add_f32 v[50:51], v[82:83], v[16:17] op_sel_hi:[1,0] neg_lo:[0,1] neg_hi:[0,1]
    v_pk_add_f32 v[52:53], v[84:85], v[16:17] op_sel_hi:[1,0] neg_lo:[0,1] neg_hi:[0,1]
    v_pk_add_f32 v[54:55], v[86:87], v[16:17] op_sel_hi:[1,0] neg_lo:[0,1] neg_hi:[0,1]
    v_pk_add_f32 v[56:57], v[88:89], v[16:17] op_sel_hi:[1,0] neg_lo:[0,1] neg_hi:[0,1]
    v_pk_add_f32 v[58:59], v[90:91], v[16:17] op_sel_hi:[1,0] neg_lo:[0,1] neg_hi:[0,1]
    v_pk_add_f32 v[60:61], v[92:93], v[16:17] op_sel_hi:[1,0] neg_lo:[0,1] neg_hi:[0,1]
    v_pk_add_f32 v[62:63], v[94:95], v[16:17] op_sel_hi:[1,0] neg_lo:[0,1] neg_hi:[0,1]
    v_pk_mul_f32 v[18:19], v[32:33], v[32:33]
    v_pk_mul_f32 v[24:25], v[34:35], v[34:35]
    v_pk_fma_f32 v[18:19], v[36:37], v[36:37], v[18:19]
    v_pk_fma_f32 v[24:25], v[38:39], v[38:39], v[24:25]
    v_pk_fma_f32 v[18:19], v[40:41], v[40:41], v[18:19]
    v_pk_fma_f32 v[24:25], v[42:43], v[42:43], v[24:25]
    v_pk_fma_f32 v[18:19], v[44:45], v[44:45], v[18:19]
    v_pk_fma_f32 v[24:25], v[46:47], v[46:47], v[24:25]
    v_pk_fma_f32 v[18:19], v[48:49], v[48:49], v[18:19]
    v_pk_fma_f32 v[24:25], v[50:51], v[50:51], v[24:25]
    v_pk_fma_f32 v[18:19], v[52:53], v[52:53], v[18:19]
    v_pk_fma_f32 v[24:25], v[54:55], v[54:55], v[24:25]
    v_pk_fma_f32 v[18:19], v[56:57], v[56:57], v[18:19]
    v_pk_fma_f32 v[24:25], v[58:59], v[58:59], v[24:25]
    v_pk_fma_f32 v[18:19], v[60:61], v[60:61], v[18:19]
    v_pk_fma_f32 v[24:25], v[62:63], v[62:63], v[24:25]
    v_pk_add_f32 v[18:19], v[18:19], v[24:25]
    v_add_f32 v17, v18, v19
    v_mov_b32 v18, v17
    s_nop 1
    v_permlane16_swap_b32 v17, v18
    v_add_f32 v17, v17, v18
    v_mov_b32 v18, v17
    s_nop 1
    v_permlane32_swap_b32 v17, v18
    v_add_f32 v17, v17, v18
    s_lshl_b32 s12, s40, 12
    s_add_u32 s12, s12, 524288
    s_add_u32 s16, s4, s12
    s_addc_u32 s17, s5, 0
    s_and_b32 s17, s17, 0xffff
    s_mov_b32 s18, 4096
    s_mov_b32 s19, 0x20000
    v_and_b32 v18, 15, v1
    v_lshlrev_b32 v18, 3, v18
    s_lshl_b32 s12, s3, 10
    v_add_u32 v18, s12, v18
    v_lshl_add_u32 v19, v22, 8, v18
    s_lshl_b32 s12, s41, 7
    s_mov_b64 exec, 0xffff
    buffer_store_dwordx2 v[16:17], v18, s[16:19], s12 offen sc1
    s_mov_b64 exec, -1
    v_cvt_pk_bf16_f32 v96, v64, v65
    v_cvt_pk_bf16_f32 v97, v66, v67
    v_cvt_pk_bf16_f32 v98, v68, v69
    v_cvt_pk_bf16_f32 v99, v70, v71
    v_cvt_pk_bf16_f32 v100, v72, v73
    v_cvt_pk_bf16_f32 v101, v74, v75
    v_cvt_pk_bf16_f32 v102, v76, v77
    v_cvt_pk_bf16_f32 v103, v78, v79
    v_cvt_pk_bf16_f32 v104, v80, v81
    v_cvt_pk_bf16_f32 v105, v82, v83
    v_cvt_pk_bf16_f32 v106, v84, v85
    v_cvt_pk_bf16_f32 v107, v86, v87
    v_cvt_pk_bf16_f32 v108, v88, v89
    v_cvt_pk_bf16_f32 v109, v90, v91
    v_cvt_pk_bf16_f32 v110, v92, v93
    v_cvt_pk_bf16_f32 v111, v94, v95
    v_accvgpr_write_b32 a240, v96
    v_lshlrev_b32 v64, 16, v96
    v_and_b32 v65, 0xffff0000, v96
    v_accvgpr_write_b32 a241, v97
    v_lshlrev_b32 v66, 16, v97
    v_and_b32 v67, 0xffff0000, v97
    v_accvgpr_write_b32 a242, v98
    v_lshlrev_b32 v68, 16, v98
    v_and_b32 v69, 0xffff0000, v98
    v_accvgpr_write_b32 a243, v99
    v_lshlrev_b32 v70, 16, v99
    v_and_b32 v71, 0xffff0000, v99
    v_accvgpr_write_b32 a244, v100
    v_lshlrev_b32 v72, 16, v100
    v_and_b32 v73, 0xffff0000, v100
    v_accvgpr_write_b32 a245, v101
    v_lshlrev_b32 v74, 16, v101
    v_and_b32 v75, 0xffff0000, v101
    v_accvgpr_write_b32 a246, v102
    v_lshlrev_b32 v76, 16, v102
    v_and_b32 v77, 0xffff0000, v102
    v_accvgpr_write_b32 a247, v103
    v_lshlrev_b32 v78, 16, v103
    v_and_b32 v79, 0xffff0000, v103
    v_accvgpr_write_b32 a248, v104
    v_lshlrev_b32 v80, 16, v104
    v_and_b32 v81, 0xffff0000, v104
    v_accvgpr_write_b32 a249, v105
    v_lshlrev_b32 v82, 16, v105
    v_and_b32 v83, 0xffff0000, v105
    v_accvgpr_write_b32 a250, v106
    v_lshlrev_b32 v84, 16, v106
    v_and_b32 v85, 0xffff0000, v106
    v_accvgpr_write_b32 a251, v107
    v_lshlrev_b32 v86, 16, v107
    v_and_b32 v87, 0xffff0000, v107
    v_accvgpr_write_b32 a252, v108
    v_lshlrev_b32 v88, 16, v108
    v_and_b32 v89, 0xffff0000, v108
    v_accvgpr_write_b32 a253, v109
    v_lshlrev_b32 v90, 16, v109
    v_and_b32 v91, 0xffff0000, v109
    v_accvgpr_write_b32 a254, v110
    v_lshlrev_b32 v92, 16, v110
    v_and_b32 v93, 0xffff0000, v110
    v_accvgpr_write_b32 a255, v111
    v_lshlrev_b32 v94, 16, v111
    v_and_b32 v95, 0xffff0000, v111
    s_add_u32 s24, s4, 50331648
    s_addc_u32 s25, s5, 0
    s_and_b32 s25, s25, 0xffff
    s_mov_b32 s26, 4194304
    s_mov_b32 s27, 0x20000
    s_lshl_b32 s14, s40, 3
    s_add_u32 s14, s14, s41
    s_lshl_b32 s14, s14, 14
    s_lshl_b32 s15, s3, 12
    s_add_u32 s14, s14, s15
    v_mov_b32 v116, -1
    v_mov_b32 v117, -1
    v_mov_b32 v118, -1
    v_mov_b32 v119, -1
    buffer_store_dwordx4 v[116:119], v2, s[24:27], s14 offen offset:0 sc1
    buffer_store_dwordx4 v[116:119], v2, s[24:27], s14 offen offset:1024 sc1
    buffer_store_dwordx4 v[116:119], v2, s[24:27], s14 offen offset:2048 sc1
    buffer_store_dwordx4 v[116:119], v2, s[24:27], s14 offen offset:3072 sc1
    s_mov_b32 s97, 0
    s_mov_b32 s13, 3212836864
spoll_adaLN_cond__linear_kernel_hedgehog__glu_gated_swiglu__prompt_kernel_36:
    buffer_load_dwordx2 v[24:25], v19, s[16:19], 0 offen sc1
    buffer_load_dwordx2 v[26:27], v19, s[16:19], 0 offen offset:128 sc1
    s_waitcnt vmcnt(0)
    v_cmp_eq_u32 vcc, s13, v25
    v_cmp_eq_u32 s[98:99], s13, v27
    s_nop 1
    s_or_b64 vcc, vcc, s[98:99]
    s_cbranch_scc0 sdone_adaLN_cond__linear_kernel_hedgehog__glu_gated_swiglu__prompt_kernel_37
    s_add_u32 s97, s97, 1
    s_cmp_lt_u32 s97, 100000
    s_cbranch_scc1 spoll_adaLN_cond__linear_kernel_hedgehog__glu_gated_swiglu__prompt_kernel_36
sdone_adaLN_cond__linear_kernel_hedgehog__glu_gated_swiglu__prompt_kernel_37:
    v_add_f32 v16, v24, v26
    v_mov_b32 v18, v16
    s_nop 1
    v_permlane16_swap_b32 v16, v18
    v_add_f32 v16, v16, v18
    v_mov_b32 v18, v16
    s_nop 1
    v_permlane32_swap_b32 v16, v18
    v_add_f32 v16, v16, v18
    v_mul_f32 v16, 0x3e000000, v16
    v_sub_f32 v24, v24, v16
    v_sub_f32 v26, v26, v16
    v_mul_f32 v24, v24, v24
    v_fmac_f32 v24, v26, v26
    v_add_f32 v17, v25, v27
    v_fmac_f32 v17, 0x43000000, v24
    v_mov_b32 v18, v17
    s_nop 1
    v_permlane16_swap_b32 v17, v18
    v_add_f32 v17, v17, v18
    v_mov_b32 v18, v17
    s_nop 1
    v_permlane32_swap_b32 v17, v18
    v_add_f32 v17, v17, v18
    v_mul_f32 v17, 0x3a800000, v17
    v_cvt_pk_bf16_f32 v17, v16, v17
    v_lshlrev_b32 v16, 16, v17
    v_and_b32 v17, 0xffff0000, v17
    v_add_f32 v17, 0x3727c5ac, v17
    v_cvt_pk_bf16_f32 v17, v17, v17
    v_and_b32 v17, 0xffff0000, v17
    v_sqrt_f32 v17, v17
    s_nop 0
    v_cvt_pk_bf16_f32 v17, v17, v17
    v_and_b32 v17, 0xffff0000, v17
    v_rcp_f32 v18, v17
    s_add_u32 s16, s4, 13631488
    s_addc_u32 s17, s5, 0
    s_and_b32 s17, s17, 0xffff
    s_mov_b32 s18, 4194304
    s_mov_b32 s19, 0x20000
    s_lshl_b32 s12, s41, 19
    s_lshl_b32 s13, s40, 12
    s_add_u32 s12, s12, s13
    s_lshl_b32 s13, s3, 10
    s_add_u32 s12, s12, s13
    s_waitcnt lgkmcnt(0)
    v_pk_add_f32 v[64:65], v[64:65], v[16:17] op_sel_hi:[1,0] neg_lo:[0,1] neg_hi:[0,1]
    v_pk_add_f32 v[66:67], v[66:67], v[16:17] op_sel_hi:[1,0] neg_lo:[0,1] neg_hi:[0,1]
    v_pk_add_f32 v[68:69], v[68:69], v[16:17] op_sel_hi:[1,0] neg_lo:[0,1] neg_hi:[0,1]
    v_pk_add_f32 v[70:71], v[70:71], v[16:17] op_sel_hi:[1,0] neg_lo:[0,1] neg_hi:[0,1]
    v_pk_mul_f32 v[64:65], v[64:65], v[18:19] op_sel_hi:[1,0]
    v_pk_mul_f32 v[66:67], v[66:67], v[18:19] op_sel_hi:[1,0]
    v_pk_mul_f32 v[68:69], v[68:69], v[18:19] op_sel_hi:[1,0]
    v_pk_mul_f32 v[70:71], v[70:71], v[18:19] op_sel_hi:[1,0]
    v_pk_fma_f32 v[64:65], v[64:65], v[160:161], v[128:129]
    v_pk_fma_f32 v[66:67], v[66:67], v[162:163], v[130:131]
    v_pk_fma_f32 v[68:69], v[68:69], v[164:165], v[132:133]
    v_pk_fma_f32 v[70:71], v[70:71], v[166:167], v[134:135]
    v_cvt_pk_bf16_f32 v32, v64, v65
    v_cvt_pk_bf16_f32 v33, v66, v67
    v_cvt_pk_bf16_f32 v34, v68, v69
    v_cvt_pk_bf16_f32 v35, v70, v71
    buffer_store_dwordx4 v[32:35], v2, s[16:19], s12 offen sc1
    s_add_u32 s12, s12, 0x20000
    v_pk_add_f32 v[72:73], v[72:73], v[16:17] op_sel_hi:[1,0] neg_lo:[0,1] neg_hi:[0,1]
    v_pk_add_f32 v[74:75], v[74:75], v[16:17] op_sel_hi:[1,0] neg_lo:[0,1] neg_hi:[0,1]
    v_pk_add_f32 v[76:77], v[76:77], v[16:17] op_sel_hi:[1,0] neg_lo:[0,1] neg_hi:[0,1]
    v_pk_add_f32 v[78:79], v[78:79], v[16:17] op_sel_hi:[1,0] neg_lo:[0,1] neg_hi:[0,1]
    v_pk_mul_f32 v[72:73], v[72:73], v[18:19] op_sel_hi:[1,0]
    v_pk_mul_f32 v[74:75], v[74:75], v[18:19] op_sel_hi:[1,0]
    v_pk_mul_f32 v[76:77], v[76:77], v[18:19] op_sel_hi:[1,0]
    v_pk_mul_f32 v[78:79], v[78:79], v[18:19] op_sel_hi:[1,0]
    v_pk_fma_f32 v[72:73], v[72:73], v[168:169], v[136:137]
    v_pk_fma_f32 v[74:75], v[74:75], v[170:171], v[138:139]
    v_pk_fma_f32 v[76:77], v[76:77], v[172:173], v[140:141]
    v_pk_fma_f32 v[78:79], v[78:79], v[174:175], v[142:143]
    v_cvt_pk_bf16_f32 v36, v72, v73
    v_cvt_pk_bf16_f32 v37, v74, v75
    v_cvt_pk_bf16_f32 v38, v76, v77
    v_cvt_pk_bf16_f32 v39, v78, v79
    buffer_store_dwordx4 v[36:39], v2, s[16:19], s12 offen sc1
    s_add_u32 s12, s12, 0x20000
    v_pk_add_f32 v[80:81], v[80:81], v[16:17] op_sel_hi:[1,0] neg_lo:[0,1] neg_hi:[0,1]
    v_pk_add_f32 v[82:83], v[82:83], v[16:17] op_sel_hi:[1,0] neg_lo:[0,1] neg_hi:[0,1]
    v_pk_add_f32 v[84:85], v[84:85], v[16:17] op_sel_hi:[1,0] neg_lo:[0,1] neg_hi:[0,1]
    v_pk_add_f32 v[86:87], v[86:87], v[16:17] op_sel_hi:[1,0] neg_lo:[0,1] neg_hi:[0,1]
    v_pk_mul_f32 v[80:81], v[80:81], v[18:19] op_sel_hi:[1,0]
    v_pk_mul_f32 v[82:83], v[82:83], v[18:19] op_sel_hi:[1,0]
    v_pk_mul_f32 v[84:85], v[84:85], v[18:19] op_sel_hi:[1,0]
    v_pk_mul_f32 v[86:87], v[86:87], v[18:19] op_sel_hi:[1,0]
    v_pk_fma_f32 v[80:81], v[80:81], v[176:177], v[144:145]
    v_pk_fma_f32 v[82:83], v[82:83], v[178:179], v[146:147]
    v_pk_fma_f32 v[84:85], v[84:85], v[180:181], v[148:149]
    v_pk_fma_f32 v[86:87], v[86:87], v[182:183], v[150:151]
    v_cvt_pk_bf16_f32 v40, v80, v81
    v_cvt_pk_bf16_f32 v41, v82, v83
    v_cvt_pk_bf16_f32 v42, v84, v85
    v_cvt_pk_bf16_f32 v43, v86, v87
    buffer_store_dwordx4 v[40:43], v2, s[16:19], s12 offen sc1
    s_add_u32 s12, s12, 0x20000
    v_pk_add_f32 v[88:89], v[88:89], v[16:17] op_sel_hi:[1,0] neg_lo:[0,1] neg_hi:[0,1]
    v_pk_add_f32 v[90:91], v[90:91], v[16:17] op_sel_hi:[1,0] neg_lo:[0,1] neg_hi:[0,1]
    v_pk_add_f32 v[92:93], v[92:93], v[16:17] op_sel_hi:[1,0] neg_lo:[0,1] neg_hi:[0,1]
    v_pk_add_f32 v[94:95], v[94:95], v[16:17] op_sel_hi:[1,0] neg_lo:[0,1] neg_hi:[0,1]
    v_pk_mul_f32 v[88:89], v[88:89], v[18:19] op_sel_hi:[1,0]
    v_pk_mul_f32 v[90:91], v[90:91], v[18:19] op_sel_hi:[1,0]
    v_pk_mul_f32 v[92:93], v[92:93], v[18:19] op_sel_hi:[1,0]
    v_pk_mul_f32 v[94:95], v[94:95], v[18:19] op_sel_hi:[1,0]
    v_pk_fma_f32 v[88:89], v[88:89], v[184:185], v[152:153]
    v_pk_fma_f32 v[90:91], v[90:91], v[186:187], v[154:155]
    v_pk_fma_f32 v[92:93], v[92:93], v[188:189], v[156:157]
    v_pk_fma_f32 v[94:95], v[94:95], v[190:191], v[158:159]
    v_cvt_pk_bf16_f32 v44, v88, v89
    v_cvt_pk_bf16_f32 v45, v90, v91
    v_cvt_pk_bf16_f32 v46, v92, v93
    v_cvt_pk_bf16_f32 v47, v94, v95
    buffer_store_dwordx4 v[44:47], v2, s[16:19], s12 offen sc1
    s_and_b32 s61, s7, 3
    s_lshl_b32 s43, s6, 2
    s_add_u32 s43, s43, s61
    s_lshr_b32 s42, s7, 2
    s_and_b32 s56, s43, 1
    s_lshl_b32 s60, s61, 1
    s_add_u32 s60, s60, s42
    s_and_b32 s60, s60, 3
    s_lshl_b32 s61, s3, 12
    v_add_u32 v3, s61, v2
    v_lshrrev_b32 v6, 4, v1
    v_and_b32 v7, 15, v1
    v_lshlrev_b32 v8, 1, v6
    v_xor_b32 v7, v7, v8
    s_lshl_b32 s61, s56, 1
    v_add_u32 v9, s61, v7
    v_subrev_u32 v10, 14, v9
    v_cmp_le_u32 vcc, 14, v9
    s_nop 1
    v_cndmask_b32 v9, v9, v10, vcc
    s_lshl_b32 s61, s3, 3
    v_add_u32 v12, s61, v6
    v_mul_u32_u24 v12, 7168, v12
    v_lshl_add_u32 v4, v9, 4, v12
    v_mov_b32 v10, 0x40000000
    v_cmp_le_u32 vcc, 14, v7
    s_nop 1
    v_cndmask_b32 v4, v4, v10, vcc
    v_add_u32 v5, 26624, v4
    v_bfe_u32 v7, v1, 2, 2
    v_and_b32 v12, 3, v1
    v_mul_u32_u24 v13, 4224, v6
    v_lshl_add_u32 v13, v7, 8, v13
    v_lshl_add_u32 v13, v12, 3, v13
    v_xor_b32 v14, 0, v7
    v_lshl_add_u32 v8, v14, 5, v13
    v_xor_b32 v14, 1, v7
    v_lshl_add_u32 v9, v14, 5, v13
    v_xor_b32 v14, 2, v7
    v_lshl_add_u32 v10, v14, 5, v13
    v_xor_b32 v14, 3, v7
    v_lshl_add_u32 v11, v14, 5, v13
    s_lshl_b32 s61, s42, 14
    s_sub_u32 s53, 4194304, s61
    s_add_u32 s61, s61, 13631488
    s_add_u32 s32, s4, s61
    s_addc_u32 s33, s5, 0
    s_and_b32 s33, s33, 0xffff
    s_mov_b32 s34, s53
    s_mov_b32 s35, 0x20000
    s_mul_i32 s61, s43, 224
    s_sub_u32 s53, 7340032, s61
    s_add_u32 s36, s74, s61
    s_addc_u32 s37, s75, 0
    s_and_b32 s37, s37, 0xffff
    s_mov_b32 s38, s53
    s_mov_b32 s39, 0x20000
    s_add_u32 s44, s76, s61
    s_addc_u32 s45, s77, 0
    s_sub_u32 s44, s44, 1024
    s_subb_u32 s45, s45, 0
    s_and_b32 s45, s45, 0xffff
    s_add_u32 s46, s53, 1024
    s_mov_b32 s47, 0x20000
    s_add_u32 s48, s4, 33554432
    s_addc_u32 s49, s5, 0
    s_and_b32 s49, s49, 0xffff
    s_mov_b32 s50, 14680064
    s_mov_b32 s51, 0x20000
    s_mul_i32 s52, s3, 4224
    s_mov_b32 s58, 0
    s_mov_b32 s59, s60
    s_add_u32 s20, s40, 96
    s_waitcnt vmcnt(0) lgkmcnt(0)
    s_barrier
    s_cmp_lg_u32 s3, 0
    s_cbranch_scc1 arr_adaLN_cond__linear_kernel_hedgehog__glu_gated_swiglu__prompt_kernel_38
    s_lshl_b32 s96, s20, 8
    v_mov_b32 v28, 1
    v_mov_b32 v29, 0
    s_mov_b64 exec, 1
    buffer_atomic_add v28, v29, s[92:95], s96 offen sc1
    s_mov_b64 exec, -1
arr_adaLN_cond__linear_kernel_hedgehog__glu_gated_swiglu__prompt_kernel_38:
    s_add_u32 s61, s58, s59
    s_lshl_b32 s53, s61, 17
    s_mul_i32 s54, s61, 229376
    s_add_u32 s59, s59, 1
    s_and_b32 s59, s59, 3
    s_cmp_eq_u32 s59, s60
    s_cselect_b32 s61, 4, 0
    s_add_u32 s58, s58, s61
    s_mov_b32 s28, s53
    s_add_u32 m0, s52, 0
    s_nop 0
    buffer_load_dwordx4 v4, s[36:39], s54 offen lds
    buffer_load_dwordx4 v4, s[44:47], s54 offen offset:1024 lds
    buffer_load_dwordx4 v5, s[36:39], s54 offen offset:2048 lds
    buffer_load_dwordx4 v5, s[44:47], s54 offen offset:3072 lds
    s_add_u32 s61, s58, s59
    s_lshl_b32 s53, s61, 17
    s_mul_i32 s54, s61, 229376
    s_add_u32 s59, s59, 1
    s_and_b32 s59, s59, 3
    s_cmp_eq_u32 s59, s60
    s_cselect_b32 s61, 4, 0
    s_add_u32 s58, s58, s61
    s_mov_b32 s29, s53
    s_add_u32 m0, s52, 16896
    s_nop 0
    buffer_load_dwordx4 v4, s[36:39], s54 offen lds
    buffer_load_dwordx4 v4, s[44:47], s54 offen offset:1024 lds
    buffer_load_dwordx4 v5, s[36:39], s54 offen offset:2048 lds
    buffer_load_dwordx4 v5, s[44:47], s54 offen offset:3072 lds
    s_add_u32 s61, s58, s59
    s_lshl_b32 s53, s61, 17
    s_mul_i32 s54, s61, 229376
    s_add_u32 s59, s59, 1
    s_and_b32 s59, s59, 3
    s_cmp_eq_u32 s59, s60
    s_cselect_b32 s61, 4, 0
    s_add_u32 s58, s58, s61
    s_mov_b32 s30, s53
    s_add_u32 m0, s52, 33792
    s_nop 0
    buffer_load_dwordx4 v4, s[36:39], s54 offen lds
    buffer_load_dwordx4 v4, s[44:47], s54 offen offset:1024 lds
    buffer_load_dwordx4 v5, s[36:39], s54 offen offset:2048 lds
    buffer_load_dwordx4 v5, s[44:47], s54 offen offset:3072 lds
    s_lshl_b32 s20, s42, 2
    s_add_u32 s20, s20, 96
    s_lshl_b32 s20, s7, 2
    s_add_u32 s20, s20, s3
    s_lshl_b32 s20, s20, 3
    v_lshrrev_b32 v12, 3, v1
    v_add_u32 v12, s20, v12
    v_and_b32 v13, 7, v1
    v_lshlrev_b32 v12, 11, v12
    v_lshl_add_u32 v12, v13, 7, v12
    s_and_b32 s20, s6, 2
    s_lshl_b32 s20, s20, 9
    s_sub_u32 s21, 3670016, s20
    s_and_b32 s22, s6, 1
    s_mul_i32 s22, s22, 3670016
    s_add_u32 s20, s20, s22
    s_mov_b32 s23, 2097152
    s_lshr_b32 s22, s6, 2
    s_mul_i32 s22, s22, 1835008
    s_add_u32 s20, s20, s22
    s_sub_u32 s21, s21, 1835008
    s_add_u32 s16, s78, s20
    s_addc_u32 s17, s79, 0
    s_and_b32 s17, s17, 0xffff
    s_mov_b32 s18, s21
    s_mov_b32 s19, 0x20000
    s_getpc_b64 s[24:25]
pc_adaLN_cond__linear_kernel_hedgehog__glu_gated_swiglu__prompt_kernel_39:
    s_add_u32 s24, s24, adaLN_cond__linear_kernel_hedgehog__glu_gated_swiglu__prompt_kernel_c2-pc_adaLN_cond__linear_kernel_hedgehog__glu_gated_swiglu__prompt_kernel_39
    s_addc_u32 s25, s25, 0
    s_and_b32 s25, s25, 0xffff
    s_mov_b32 s26, end_adaLN_cond__linear_kernel_hedgehog__glu_gated_swiglu__prompt_kernel_1-adaLN_cond__linear_kernel_hedgehog__glu_gated_swiglu__prompt_kernel_c2
    s_mov_b32 s27, 0x20000
    s_lshl_b32 s22, s7, 2
    s_add_u32 s22, s22, s3
    s_lshl_b32 s22, s22, 13
    v_lshlrev_b32 v13, 7, v1
    s_lshl_b32 s20, s42, 2
    s_add_u32 s20, s20, 96
    s_waitcnt vmcnt(0)
    s_cmp_lg_u32 s3, 0
    s_cbranch_scc1 wt_adaLN_cond__linear_kernel_hedgehog__glu_gated_swiglu__prompt_kernel_40
    s_lshl_b32 s96, s20, 8
    v_and_b32 v29, 3, v1
    v_lshlrev_b32 v29, 8, v29
    s_mov_b32 s97, 0
    s_mov_b64 exec, 15
poll_adaLN_cond__linear_kernel_hedgehog__glu_gated_swiglu__prompt_kernel_41:
    buffer_load_dword v28, v29, s[92:95], s96 offen sc1
    s_waitcnt vmcnt(0)
    v_cmp_ne_u32 vcc, 8, v28
    s_cbranch_vccz pdone_adaLN_cond__linear_kernel_hedgehog__glu_gated_swiglu__prompt_kernel_42
    s_add_u32 s97, s97, 1
    s_cmp_lt_u32 s97, 100000
    s_cbranch_scc1 poll_adaLN_cond__linear_kernel_hedgehog__glu_gated_swiglu__prompt_kernel_41
pdone_adaLN_cond__linear_kernel_hedgehog__glu_gated_swiglu__prompt_kernel_42:
    s_mov_b64 exec, -1
wt_adaLN_cond__linear_kernel_hedgehog__glu_gated_swiglu__prompt_kernel_40:
    s_barrier
    buffer_load_dwordx4 a[64:67], v3, s[32:35], s28 offen offset:0 sc1
    buffer_load_dwordx4 a[68:71], v3, s[32:35], s28 offen offset:1024 sc1
    buffer_load_dwordx4 a[72:75], v3, s[32:35], s28 offen offset:2048 sc1
    buffer_load_dwordx4 a[76:79], v3, s[32:35], s28 offen offset:3072 sc1
    buffer_load_dwordx4 a[80:83], v3, s[32:35], s29 offen offset:0 sc1
    buffer_load_dwordx4 a[84:87], v3, s[32:35], s29 offen offset:1024 sc1
    buffer_load_dwordx4 a[88:91], v3, s[32:35], s29 offen offset:2048 sc1
    buffer_load_dwordx4 a[92:95], v3, s[32:35], s29 offen offset:3072 sc1
    buffer_load_dwordx4 a[96:99], v3, s[32:35], s30 offen offset:0 sc1
    buffer_load_dwordx4 a[100:103], v3, s[32:35], s30 offen offset:1024 sc1
    buffer_load_dwordx4 a[104:107], v3, s[32:35], s30 offen offset:2048 sc1
    buffer_load_dwordx4 a[108:111], v3, s[32:35], s30 offen offset:3072 sc1
    ds_read_b64_tr_b16 a[0:1], v8 offset:0
    ds_read_b64_tr_b16 a[2:3], v8 offset:2048
    ds_read_b64_tr_b16 a[4:5], v8 offset:1024
    ds_read_b64_tr_b16 a[6:7], v8 offset:3072
    ds_read_b64_tr_b16 a[8:9], v9 offset:0
    ds_read_b64_tr_b16 a[10:11], v9 offset:2048
    ds_read_b64_tr_b16 a[12:13], v9 offset:1024
    ds_read_b64_tr_b16 a[14:15], v9 offset:3072
    ds_read_b64_tr_b16 a[16:17], v10 offset:0
    ds_read_b64_tr_b16 a[18:19], v10 offset:2048
    ds_read_b64_tr_b16 a[20:21], v10 offset:1024
    ds_read_b64_tr_b16 a[22:23], v10 offset:3072
    ds_read_b64_tr_b16 a[24:25], v11 offset:0
    ds_read_b64_tr_b16 a[26:27], v11 offset:2048
    ds_read_b64_tr_b16 a[28:29], v11 offset:1024
    ds_read_b64_tr_b16 a[30:31], v11 offset:3072
    ds_read_b64_tr_b16 a[32:33], v8 offset:128
    ds_read_b64_tr_b16 a[34:35], v8 offset:2176
    ds_read_b64_tr_b16 a[36:37], v8 offset:1152
    ds_read_b64_tr_b16 a[38:39], v8 offset:3200
    ds_read_b64_tr_b16 a[40:41], v9 offset:128
    ds_read_b64_tr_b16 a[42:43], v9 offset:2176
    ds_read_b64_tr_b16 a[44:45], v9 offset:1152
    ds_read_b64_tr_b16 a[46:47], v9 offset:3200
    ds_read_b64_tr_b16 a[48:49], v10 offset:128
    ds_read_b64_tr_b16 a[50:51], v10 offset:2176
    ds_read_b64_tr_b16 a[52:53], v10 offset:1152
    ds_read_b64_tr_b16 a[54:55], v10 offset:3200
    s_mov_b32 s57, 7
    s_waitcnt vmcnt(8)
    s_waitcnt lgkmcnt(12)
    v_mfma_f32_16x16x32_bf16 v[32:35], a[0:3], a[64:67], 0
    v_mfma_f32_16x16x32_bf16 v[48:51], a[4:7], a[64:67], 0
    v_mfma_f32_16x16x32_bf16 v[52:55], a[4:7], a[68:71], 0
    v_mfma_f32_16x16x32_bf16 v[36:39], a[0:3], a[68:71], 0
    v_mfma_f32_16x16x32_bf16 v[40:43], a[0:3], a[72:75], 0
    v_mfma_f32_16x16x32_bf16 v[56:59], a[4:7], a[72:75], 0
    v_mfma_f32_16x16x32_bf16 v[60:63], a[4:7], a[76:79], 0
    s_add_u32 s61, s58, s59
    s_lshl_b32 s53, s61, 17
    s_mul_i32 s54, s61, 229376
    v_mfma_f32_16x16x32_bf16 v[44:47], a[0:3], a[76:79], 0
    s_add_u32 m0, s52, 50688
    v_mfma_f32_16x16x32_bf16 v[76:79], a[8:11], a[76:79], 0
    ds_read_b64_tr_b16 a[0:1], v8 offset:16896
    v_mfma_f32_16x16x32_bf16 v[92:95], a[12:15], a[76:79], 0
    ds_read_b64_tr_b16 a[2:3], v8 offset:18944
    v_mfma_f32_16x16x32_bf16 v[88:91], a[12:15], a[72:75], 0
    buffer_load_dwordx4 v4, s[36:39], s54 offen lds
    v_mfma_f32_16x16x32_bf16 v[72:75], a[8:11], a[72:75], 0
    v_mfma_f32_16x16x32_bf16 v[68:71], a[8:11], a[68:71], 0
    ds_read_b64_tr_b16 a[4:5], v8 offset:17920
    v_mfma_f32_16x16x32_bf16 v[84:87], a[12:15], a[68:71], 0
    ds_read_b64_tr_b16 a[6:7], v8 offset:19968
    v_mfma_f32_16x16x32_bf16 v[80:83], a[12:15], a[64:67], 0
    buffer_load_dwordx4 a[112:115], v3, s[32:35], s53 offen offset:0 sc1
    v_mfma_f32_16x16x32_bf16 v[64:67], a[8:11], a[64:67], 0
    s_waitcnt lgkmcnt(15)
    v_mfma_f32_16x16x32_bf16 v[96:99], a[16:19], a[64:67], 0
    ds_read_b64_tr_b16 a[8:9], v9 offset:16896
    v_mfma_f32_16x16x32_bf16 v[112:115], a[20:23], a[64:67], 0
    ds_read_b64_tr_b16 a[10:11], v9 offset:18944
    v_mfma_f32_16x16x32_bf16 v[116:119], a[20:23], a[68:71], 0
    buffer_load_dwordx4 v4, s[44:47], s54 offen offset:1024 lds
    v_mfma_f32_16x16x32_bf16 v[100:103], a[16:19], a[68:71], 0
    v_mfma_f32_16x16x32_bf16 v[104:107], a[16:19], a[72:75], 0
    ds_read_b64_tr_b16 a[12:13], v9 offset:17920
    v_mfma_f32_16x16x32_bf16 v[120:123], a[20:23], a[72:75], 0
    ds_read_b64_tr_b16 a[14:15], v9 offset:19968
    v_mfma_f32_16x16x32_bf16 v[124:127], a[20:23], a[76:79], 0
    buffer_load_dwordx4 a[116:119], v3, s[32:35], s53 offen offset:1024 sc1
    v_mfma_f32_16x16x32_bf16 v[108:111], a[16:19], a[76:79], 0
    v_mfma_f32_16x16x32_bf16 v[140:143], a[24:27], a[76:79], 0
    ds_read_b64_tr_b16 a[16:17], v10 offset:16896
    v_mfma_f32_16x16x32_bf16 v[156:159], a[28:31], a[76:79], 0
    ds_read_b64_tr_b16 a[18:19], v10 offset:18944
    v_mfma_f32_16x16x32_bf16 v[152:155], a[28:31], a[72:75], 0
    buffer_load_dwordx4 v5, s[36:39], s54 offen offset:2048 lds
    v_mfma_f32_16x16x32_bf16 v[136:139], a[24:27], a[72:75], 0
    v_mfma_f32_16x16x32_bf16 v[132:135], a[24:27], a[68:71], 0
    ds_read_b64_tr_b16 a[20:21], v10 offset:17920
    v_mfma_f32_16x16x32_bf16 v[148:151], a[28:31], a[68:71], 0
    ds_read_b64_tr_b16 a[22:23], v10 offset:19968
    v_mfma_f32_16x16x32_bf16 v[144:147], a[28:31], a[64:67], 0
    buffer_load_dwordx4 a[120:123], v3, s[32:35], s53 offen offset:2048 sc1
    v_mfma_f32_16x16x32_bf16 v[128:131], a[24:27], a[64:67], 0
    s_waitcnt lgkmcnt(15)
    v_mfma_f32_16x16x32_bf16 v[160:163], a[32:35], a[64:67], 0
    ds_read_b64_tr_b16 a[24:25], v11 offset:16896
    v_mfma_f32_16x16x32_bf16 v[176:179], a[36:39], a[64:67], 0
    ds_read_b64_tr_b16 a[26:27], v11 offset:18944
    v_mfma_f32_16x16x32_bf16 v[180:183], a[36:39], a[68:71], 0
    buffer_load_dwordx4 v5, s[44:47], s54 offen offset:3072 lds
    v_mfma_f32_16x16x32_bf16 v[164:167], a[32:35], a[68:71], 0
    v_mfma_f32_16x16x32_bf16 v[168:171], a[32:35], a[72:75], 0
    ds_read_b64_tr_b16 a[28:29], v11 offset:17920
    v_mfma_f32_16x16x32_bf16 v[184:187], a[36:39], a[72:75], 0
    ds_read_b64_tr_b16 a[30:31], v11 offset:19968
    v_mfma_f32_16x16x32_bf16 v[188:191], a[36:39], a[76:79], 0
    buffer_load_dwordx4 a[124:127], v3, s[32:35], s53 offen offset:3072 sc1
    v_mfma_f32_16x16x32_bf16 v[172:175], a[32:35], a[76:79], 0
    v_mfma_f32_16x16x32_bf16 v[204:207], a[40:43], a[76:79], 0
    ds_read_b64_tr_b16 a[32:33], v8 offset:17024
    v_mfma_f32_16x16x32_bf16 v[220:223], a[44:47], a[76:79], 0
    ds_read_b64_tr_b16 a[34:35], v8 offset:19072
    v_mfma_f32_16x16x32_bf16 v[216:219], a[44:47], a[72:75], 0
    s_add_u32 s59, s59, 1
    s_and_b32 s59, s59, 3
    v_mfma_f32_16x16x32_bf16 v[200:203], a[40:43], a[72:75], 0
    v_mfma_f32_16x16x32_bf16 v[196:199], a[40:43], a[68:71], 0
    ds_read_b64_tr_b16 a[36:37], v8 offset:18048
    v_mfma_f32_16x16x32_bf16 v[212:215], a[44:47], a[68:71], 0
    ds_read_b64_tr_b16 a[38:39], v8 offset:20096
    v_mfma_f32_16x16x32_bf16 v[208:211], a[44:47], a[64:67], 0
    s_cmp_eq_u32 s59, s60
    s_cselect_b32 s61, 4, 0
    s_add_u32 s58, s58, s61
    v_mfma_f32_16x16x32_bf16 v[192:195], a[40:43], a[64:67], 0
    s_waitcnt lgkmcnt(15)
    v_mfma_f32_16x16x32_bf16 v[224:227], a[48:51], a[64:67], 0
    ds_read_b64_tr_b16 a[40:41], v9 offset:17024
    v_mfma_f32_16x16x32_bf16 v[240:243], a[52:55], a[64:67], 0
    ds_read_b64_tr_b16 a[42:43], v9 offset:19072
    v_mfma_f32_16x16x32_bf16 v[244:247], a[52:55], a[68:71], 0
    v_mfma_f32_16x16x32_bf16 v[228:231], a[48:51], a[68:71], 0
    v_mfma_f32_16x16x32_bf16 v[232:235], a[48:51], a[72:75], 0
    ds_read_b64_tr_b16 a[44:45], v9 offset:18048
    v_mfma_f32_16x16x32_bf16 v[248:251], a[52:55], a[72:75], 0
    ds_read_b64_tr_b16 a[46:47], v9 offset:20096
    v_mfma_f32_16x16x32_bf16 v[252:255], a[52:55], a[76:79], 0
    v_mfma_f32_16x16x32_bf16 v[236:239], a[48:51], a[76:79], 0
    s_waitcnt vmcnt(12)
    .p2align 6
floop_adaLN_cond__linear_kernel_hedgehog__glu_gated_swiglu__prompt_kernel_43:
    s_waitcnt lgkmcnt(12)
    v_mfma_f32_16x16x32_bf16 v[32:35], a[0:3], a[80:83], v[32:35]
    ds_read_b64_tr_b16 a[48:49], v10 offset:17024
    v_mfma_f32_16x16x32_bf16 v[48:51], a[4:7], a[80:83], v[48:51]
    ds_read_b64_tr_b16 a[50:51], v10 offset:19072
    v_mfma_f32_16x16x32_bf16 v[52:55], a[4:7], a[84:87], v[52:55]
    ds_read_b64_tr_b16 a[52:53], v10 offset:18048
    v_mfma_f32_16x16x32_bf16 v[36:39], a[0:3], a[84:87], v[36:39]
    ds_read_b64_tr_b16 a[54:55], v10 offset:20096
    v_mfma_f32_16x16x32_bf16 v[40:43], a[0:3], a[88:91], v[40:43]
    v_mfma_f32_16x16x32_bf16 v[56:59], a[4:7], a[88:91], v[56:59]
    s_waitcnt vmcnt(8)
    s_barrier
    v_mfma_f32_16x16x32_bf16 v[60:63], a[4:7], a[92:95], v[60:63]
    s_add_u32 s61, s58, s59
    s_lshl_b32 s53, s61, 17
    s_mul_i32 s54, s61, 229376
    v_mfma_f32_16x16x32_bf16 v[44:47], a[0:3], a[92:95], v[44:47]
    s_add_u32 m0, s52, 0
    v_mfma_f32_16x16x32_bf16 v[76:79], a[8:11], a[92:95], v[76:79]
    ds_read_b64_tr_b16 a[0:1], v8 offset:33792
    v_mfma_f32_16x16x32_bf16 v[92:95], a[12:15], a[92:95], v[92:95]
    ds_read_b64_tr_b16 a[2:3], v8 offset:35840
    v_mfma_f32_16x16x32_bf16 v[88:91], a[12:15], a[88:91], v[88:91]
    buffer_load_dwordx4 v4, s[36:39], s54 offen lds
    v_mfma_f32_16x16x32_bf16 v[72:75], a[8:11], a[88:91], v[72:75]
    v_mfma_f32_16x16x32_bf16 v[68:71], a[8:11], a[84:87], v[68:71]
    ds_read_b64_tr_b16 a[4:5], v8 offset:34816
    v_mfma_f32_16x16x32_bf16 v[84:87], a[12:15], a[84:87], v[84:87]
    ds_read_b64_tr_b16 a[6:7], v8 offset:36864
    v_mfma_f32_16x16x32_bf16 v[80:83], a[12:15], a[80:83], v[80:83]
    buffer_load_dwordx4 a[64:67], v3, s[32:35], s53 offen offset:0 sc1
    v_mfma_f32_16x16x32_bf16 v[64:67], a[8:11], a[80:83], v[64:67]
    s_waitcnt lgkmcnt(15)
    v_mfma_f32_16x16x32_bf16 v[96:99], a[16:19], a[80:83], v[96:99]
    ds_read_b64_tr_b16 a[8:9], v9 offset:33792
    v_mfma_f32_16x16x32_bf16 v[112:115], a[20:23], a[80:83], v[112:115]
    ds_read_b64_tr_b16 a[10:11], v9 offset:35840
    v_mfma_f32_16x16x32_bf16 v[116:119], a[20:23], a[84:87], v[116:119]
    buffer_load_dwordx4 v4, s[44:47], s54 offen offset:1024 lds
    v_mfma_f32_16x16x32_bf16 v[100:103], a[16:19], a[84:87], v[100:103]
    v_mfma_f32_16x16x32_bf16 v[104:107], a[16:19], a[88:91], v[104:107]
    ds_read_b64_tr_b16 a[12:13], v9 offset:34816
    v_mfma_f32_16x16x32_bf16 v[120:123], a[20:23], a[88:91], v[120:123]
    ds_read_b64_tr_b16 a[14:15], v9 offset:36864
    v_mfma_f32_16x16x32_bf16 v[124:127], a[20:23], a[92:95], v[124:127]
    buffer_load_dwordx4 a[68:71], v3, s[32:35], s53 offen offset:1024 sc1
    v_mfma_f32_16x16x32_bf16 v[108:111], a[16:19], a[92:95], v[108:111]
    v_mfma_f32_16x16x32_bf16 v[140:143], a[24:27], a[92:95], v[140:143]
    ds_read_b64_tr_b16 a[16:17], v10 offset:33792
    v_mfma_f32_16x16x32_bf16 v[156:159], a[28:31], a[92:95], v[156:159]
    ds_read_b64_tr_b16 a[18:19], v10 offset:35840
    v_mfma_f32_16x16x32_bf16 v[152:155], a[28:31], a[88:91], v[152:155]
    buffer_load_dwordx4 v5, s[36:39], s54 offen offset:2048 lds
    v_mfma_f32_16x16x32_bf16 v[136:139], a[24:27], a[88:91], v[136:139]
    v_mfma_f32_16x16x32_bf16 v[132:135], a[24:27], a[84:87], v[132:135]
    ds_read_b64_tr_b16 a[20:21], v10 offset:34816
    v_mfma_f32_16x16x32_bf16 v[148:151], a[28:31], a[84:87], v[148:151]
    ds_read_b64_tr_b16 a[22:23], v10 offset:36864
    v_mfma_f32_16x16x32_bf16 v[144:147], a[28:31], a[80:83], v[144:147]
    buffer_load_dwordx4 a[72:75], v3, s[32:35], s53 offen offset:2048 sc1
    v_mfma_f32_16x16x32_bf16 v[128:131], a[24:27], a[80:83], v[128:131]
    s_waitcnt lgkmcnt(15)
    v_mfma_f32_16x16x32_bf16 v[160:163], a[32:35], a[80:83], v[160:163]
    ds_read_b64_tr_b16 a[24:25], v11 offset:33792
    v_mfma_f32_16x16x32_bf16 v[176:179], a[36:39], a[80:83], v[176:179]
    ds_read_b64_tr_b16 a[26:27], v11 offset:35840
    v_mfma_f32_16x16x32_bf16 v[180:183], a[36:39], a[84:87], v[180:183]
    buffer_load_dwordx4 v5, s[44:47], s54 offen offset:3072 lds
    v_mfma_f32_16x16x32_bf16 v[164:167], a[32:35], a[84:87], v[164:167]
    v_mfma_f32_16x16x32_bf16 v[168:171], a[32:35], a[88:91], v[168:171]
    ds_read_b64_tr_b16 a[28:29], v11 offset:34816
    v_mfma_f32_16x16x32_bf16 v[184:187], a[36:39], a[88:91], v[184:187]
    ds_read_b64_tr_b16 a[30:31], v11 offset:36864
    v_mfma_f32_16x16x32_bf16 v[188:191], a[36:39], a[92:95], v[188:191]
    buffer_load_dwordx4 a[76:79], v3, s[32:35], s53 offen offset:3072 sc1
    v_mfma_f32_16x16x32_bf16 v[172:175], a[32:35], a[92:95], v[172:175]
    v_mfma_f32_16x16x32_bf16 v[204:207], a[40:43], a[92:95], v[204:207]
    ds_read_b64_tr_b16 a[32:33], v8 offset:33920
    v_mfma_f32_16x16x32_bf16 v[220:223], a[44:47], a[92:95], v[220:223]
    ds_read_b64_tr_b16 a[34:35], v8 offset:35968
    v_mfma_f32_16x16x32_bf16 v[216:219], a[44:47], a[88:91], v[216:219]
    s_add_u32 s59, s59, 1
    s_and_b32 s59, s59, 3
    v_mfma_f32_16x16x32_bf16 v[200:203], a[40:43], a[88:91], v[200:203]
    v_mfma_f32_16x16x32_bf16 v[196:199], a[40:43], a[84:87], v[196:199]
    ds_read_b64_tr_b16 a[36:37], v8 offset:34944
    v_mfma_f32_16x16x32_bf16 v[212:215], a[44:47], a[84:87], v[212:215]
    ds_read_b64_tr_b16 a[38:39], v8 offset:36992
    v_mfma_f32_16x16x32_bf16 v[208:211], a[44:47], a[80:83], v[208:211]
    s_cmp_eq_u32 s59, s60
    s_cselect_b32 s61, 4, 0
    s_add_u32 s58, s58, s61
    v_mfma_f32_16x16x32_bf16 v[192:195], a[40:43], a[80:83], v[192:195]
    s_waitcnt lgkmcnt(15)
    v_mfma_f32_16x16x32_bf16 v[224:227], a[48:51], a[80:83], v[224:227]
    ds_read_b64_tr_b16 a[40:41], v9 offset:33920
    v_mfma_f32_16x16x32_bf16 v[240:243], a[52:55], a[80:83], v[240:243]
    ds_read_b64_tr_b16 a[42:43], v9 offset:35968
    v_mfma_f32_16x16x32_bf16 v[244:247], a[52:55], a[84:87], v[244:247]
    s_cmp_eq_u32 s57, 2
    s_cselect_b32 s21, s22, 0x1000000
    buffer_load_dword a237, v13, s[24:27], s21 offen
    v_mfma_f32_16x16x32_bf16 v[228:231], a[48:51], a[84:87], v[228:231]
    v_mfma_f32_16x16x32_bf16 v[232:235], a[48:51], a[88:91], v[232:235]
    ds_read_b64_tr_b16 a[44:45], v9 offset:34944
    v_mfma_f32_16x16x32_bf16 v[248:251], a[52:55], a[88:91], v[248:251]
    ds_read_b64_tr_b16 a[46:47], v9 offset:36992
    v_mfma_f32_16x16x32_bf16 v[252:255], a[52:55], a[92:95], v[252:255]
    v_mfma_f32_16x16x32_bf16 v[236:239], a[48:51], a[92:95], v[236:239]
    s_waitcnt lgkmcnt(12)
    v_mfma_f32_16x16x32_bf16 v[32:35], a[0:3], a[96:99], v[32:35]
    ds_read_b64_tr_b16 a[48:49], v10 offset:33920
    v_mfma_f32_16x16x32_bf16 v[48:51], a[4:7], a[96:99], v[48:51]
    ds_read_b64_tr_b16 a[50:51], v10 offset:35968
    v_mfma_f32_16x16x32_bf16 v[52:55], a[4:7], a[100:103], v[52:55]
    ds_read_b64_tr_b16 a[52:53], v10 offset:34944
    v_mfma_f32_16x16x32_bf16 v[36:39], a[0:3], a[100:103], v[36:39]
    ds_read_b64_tr_b16 a[54:55], v10 offset:36992
    v_mfma_f32_16x16x32_bf16 v[40:43], a[0:3], a[104:107], v[40:43]
    v_mfma_f32_16x16x32_bf16 v[56:59], a[4:7], a[104:107], v[56:59]
    s_waitcnt vmcnt(8)
    s_barrier
    v_mfma_f32_16x16x32_bf16 v[60:63], a[4:7], a[108:111], v[60:63]
    s_add_u32 s61, s58, s59
    s_lshl_b32 s53, s61, 17
    s_mul_i32 s54, s61, 229376
    v_mfma_f32_16x16x32_bf16 v[44:47], a[0:3], a[108:111], v[44:47]
    s_add_u32 m0, s52, 16896
    v_mfma_f32_16x16x32_bf16 v[76:79], a[8:11], a[108:111], v[76:79]
    ds_read_b64_tr_b16 a[0:1], v8 offset:50688
    v_mfma_f32_16x16x32_bf16 v[92:95], a[12:15], a[108:111], v[92:95]
    ds_read_b64_tr_b16 a[2:3], v8 offset:52736
    v_mfma_f32_16x16x32_bf16 v[88:91], a[12:15], a[104:107], v[88:91]
    buffer_load_dwordx4 v4, s[36:39], s54 offen lds
    v_mfma_f32_16x16x32_bf16 v[72:75], a[8:11], a[104:107], v[72:75]
    v_mfma_f32_16x16x32_bf16 v[68:71], a[8:11], a[100:103], v[68:71]
    ds_read_b64_tr_b16 a[4:5], v8 offset:51712
    v_mfma_f32_16x16x32_bf16 v[84:87], a[12:15], a[100:103], v[84:87]
    ds_read_b64_tr_b16 a[6:7], v8 offset:53760
    v_mfma_f32_16x16x32_bf16 v[80:83], a[12:15], a[96:99], v[80:83]
    buffer_load_dwordx4 a[80:83], v3, s[32:35], s53 offen offset:0 sc1
    v_mfma_f32_16x16x32_bf16 v[64:67], a[8:11], a[96:99], v[64:67]
    s_waitcnt lgkmcnt(15)
    v_mfma_f32_16x16x32_bf16 v[96:99], a[16:19], a[96:99], v[96:99]
    ds_read_b64_tr_b16 a[8:9], v9 offset:50688
    v_mfma_f32_16x16x32_bf16 v[112:115], a[20:23], a[96:99], v[112:115]
    ds_read_b64_tr_b16 a[10:11], v9 offset:52736
    v_mfma_f32_16x16x32_bf16 v[116:119], a[20:23], a[100:103], v[116:119]
    buffer_load_dwordx4 v4, s[44:47], s54 offen offset:1024 lds
    v_mfma_f32_16x16x32_bf16 v[100:103], a[16:19], a[100:103], v[100:103]
    v_mfma_f32_16x16x32_bf16 v[104:107], a[16:19], a[104:107], v[104:107]
    ds_read_b64_tr_b16 a[12:13], v9 offset:51712
    v_mfma_f32_16x16x32_bf16 v[120:123], a[20:23], a[104:107], v[120:123]
    ds_read_b64_tr_b16 a[14:15], v9 offset:53760
    v_mfma_f32_16x16x32_bf16 v[124:127], a[20:23], a[108:111], v[124:127]
    buffer_load_dwordx4 a[84:87], v3, s[32:35], s53 offen offset:1024 sc1
    v_mfma_f32_16x16x32_bf16 v[108:111], a[16:19], a[108:111], v[108:111]
    v_mfma_f32_16x16x32_bf16 v[140:143], a[24:27], a[108:111], v[140:143]
    ds_read_b64_tr_b16 a[16:17], v10 offset:50688
    v_mfma_f32_16x16x32_bf16 v[156:159], a[28:31], a[108:111], v[156:159]
    ds_read_b64_tr_b16 a[18:19], v10 offset:52736
    v_mfma_f32_16x16x32_bf16 v[152:155], a[28:31], a[104:107], v[152:155]
    buffer_load_dwordx4 v5, s[36:39], s54 offen offset:2048 lds
    v_mfma_f32_16x16x32_bf16 v[136:139], a[24:27], a[104:107], v[136:139]
    v_mfma_f32_16x16x32_bf16 v[132:135], a[24:27], a[100:103], v[132:135]
    ds_read_b64_tr_b16 a[20:21], v10 offset:51712
    v_mfma_f32_16x16x32_bf16 v[148:151], a[28:31], a[100:103], v[148:151]
    ds_read_b64_tr_b16 a[22:23], v10 offset:53760
    v_mfma_f32_16x16x32_bf16 v[144:147], a[28:31], a[96:99], v[144:147]
    buffer_load_dwordx4 a[88:91], v3, s[32:35], s53 offen offset:2048 sc1
    v_mfma_f32_16x16x32_bf16 v[128:131], a[24:27], a[96:99], v[128:131]
    s_waitcnt lgkmcnt(15)
    v_mfma_f32_16x16x32_bf16 v[160:163], a[32:35], a[96:99], v[160:163]
    ds_read_b64_tr_b16 a[24:25], v11 offset:50688
    v_mfma_f32_16x16x32_bf16 v[176:179], a[36:39], a[96:99], v[176:179]
    ds_read_b64_tr_b16 a[26:27], v11 offset:52736
    v_mfma_f32_16x16x32_bf16 v[180:183], a[36:39], a[100:103], v[180:183]
    buffer_load_dwordx4 v5, s[44:47], s54 offen offset:3072 lds
    v_mfma_f32_16x16x32_bf16 v[164:167], a[32:35], a[100:103], v[164:167]
    v_mfma_f32_16x16x32_bf16 v[168:171], a[32:35], a[104:107], v[168:171]
    ds_read_b64_tr_b16 a[28:29], v11 offset:51712
    v_mfma_f32_16x16x32_bf16 v[184:187], a[36:39], a[104:107], v[184:187]
    ds_read_b64_tr_b16 a[30:31], v11 offset:53760
    v_mfma_f32_16x16x32_bf16 v[188:191], a[36:39], a[108:111], v[188:191]
    buffer_load_dwordx4 a[92:95], v3, s[32:35], s53 offen offset:3072 sc1
    v_mfma_f32_16x16x32_bf16 v[172:175], a[32:35], a[108:111], v[172:175]
    v_mfma_f32_16x16x32_bf16 v[204:207], a[40:43], a[108:111], v[204:207]
    ds_read_b64_tr_b16 a[32:33], v8 offset:50816
    v_mfma_f32_16x16x32_bf16 v[220:223], a[44:47], a[108:111], v[220:223]
    ds_read_b64_tr_b16 a[34:35], v8 offset:52864
    v_mfma_f32_16x16x32_bf16 v[216:219], a[44:47], a[104:107], v[216:219]
    s_add_u32 s59, s59, 1
    s_and_b32 s59, s59, 3
    v_mfma_f32_16x16x32_bf16 v[200:203], a[40:43], a[104:107], v[200:203]
    v_mfma_f32_16x16x32_bf16 v[196:199], a[40:43], a[100:103], v[196:199]
    ds_read_b64_tr_b16 a[36:37], v8 offset:51840
    v_mfma_f32_16x16x32_bf16 v[212:215], a[44:47], a[100:103], v[212:215]
    ds_read_b64_tr_b16 a[38:39], v8 offset:53888
    v_mfma_f32_16x16x32_bf16 v[208:211], a[44:47], a[96:99], v[208:211]
    s_cmp_eq_u32 s59, s60
    s_cselect_b32 s61, 4, 0
    s_add_u32 s58, s58, s61
    v_mfma_f32_16x16x32_bf16 v[192:195], a[40:43], a[96:99], v[192:195]
    s_waitcnt lgkmcnt(15)
    v_mfma_f32_16x16x32_bf16 v[224:227], a[48:51], a[96:99], v[224:227]
    ds_read_b64_tr_b16 a[40:41], v9 offset:50816
    v_mfma_f32_16x16x32_bf16 v[240:243], a[52:55], a[96:99], v[240:243]
    ds_read_b64_tr_b16 a[42:43], v9 offset:52864
    v_mfma_f32_16x16x32_bf16 v[244:247], a[52:55], a[100:103], v[244:247]
    v_mfma_f32_16x16x32_bf16 v[228:231], a[48:51], a[100:103], v[228:231]
    v_mfma_f32_16x16x32_bf16 v[232:235], a[48:51], a[104:107], v[232:235]
    ds_read_b64_tr_b16 a[44:45], v9 offset:51840
    v_mfma_f32_16x16x32_bf16 v[248:251], a[52:55], a[104:107], v[248:251]
    ds_read_b64_tr_b16 a[46:47], v9 offset:53888
    v_mfma_f32_16x16x32_bf16 v[252:255], a[52:55], a[108:111], v[252:255]
    v_mfma_f32_16x16x32_bf16 v[236:239], a[48:51], a[108:111], v[236:239]
    s_waitcnt lgkmcnt(12)
    v_mfma_f32_16x16x32_bf16 v[32:35], a[0:3], a[112:115], v[32:35]
    ds_read_b64_tr_b16 a[48:49], v10 offset:50816
    v_mfma_f32_16x16x32_bf16 v[48:51], a[4:7], a[112:115], v[48:51]
    ds_read_b64_tr_b16 a[50:51], v10 offset:52864
    v_mfma_f32_16x16x32_bf16 v[52:55], a[4:7], a[116:119], v[52:55]
    ds_read_b64_tr_b16 a[52:53], v10 offset:51840
    v_mfma_f32_16x16x32_bf16 v[36:39], a[0:3], a[116:119], v[36:39]
    ds_read_b64_tr_b16 a[54:55], v10 offset:53888
    v_mfma_f32_16x16x32_bf16 v[40:43], a[0:3], a[120:123], v[40:43]
    v_mfma_f32_16x16x32_bf16 v[56:59], a[4:7], a[120:123], v[56:59]
    s_waitcnt vmcnt(8)
    s_barrier
    v_mfma_f32_16x16x32_bf16 v[60:63], a[4:7], a[124:127], v[60:63]
    s_add_u32 s61, s58, s59
    s_lshl_b32 s53, s61, 17
    s_mul_i32 s54, s61, 229376
    v_mfma_f32_16x16x32_bf16 v[44:47], a[0:3], a[124:127], v[44:47]
    s_add_u32 m0, s52, 33792
    v_mfma_f32_16x16x32_bf16 v[76:79], a[8:11], a[124:127], v[76:79]
    ds_read_b64_tr_b16 a[0:1], v8 offset:0
    v_mfma_f32_16x16x32_bf16 v[92:95], a[12:15], a[124:127], v[92:95]
    ds_read_b64_tr_b16 a[2:3], v8 offset:2048
    v_mfma_f32_16x16x32_bf16 v[88:91], a[12:15], a[120:123], v[88:91]
    buffer_load_dwordx4 v4, s[36:39], s54 offen lds
    v_mfma_f32_16x16x32_bf16 v[72:75], a[8:11], a[120:123], v[72:75]
    v_mfma_f32_16x16x32_bf16 v[68:71], a[8:11], a[116:119], v[68:71]
    ds_read_b64_tr_b16 a[4:5], v8 offset:1024
    v_mfma_f32_16x16x32_bf16 v[84:87], a[12:15], a[116:119], v[84:87]
    ds_read_b64_tr_b16 a[6:7], v8 offset:3072
    v_mfma_f32_16x16x32_bf16 v[80:83], a[12:15], a[112:115], v[80:83]
    buffer_load_dwordx4 a[96:99], v3, s[32:35], s53 offen offset:0 sc1
    v_mfma_f32_16x16x32_bf16 v[64:67], a[8:11], a[112:115], v[64:67]
    s_waitcnt lgkmcnt(15)
    v_mfma_f32_16x16x32_bf16 v[96:99], a[16:19], a[112:115], v[96:99]
    ds_read_b64_tr_b16 a[8:9], v9 offset:0
    v_mfma_f32_16x16x32_bf16 v[112:115], a[20:23], a[112:115], v[112:115]
    ds_read_b64_tr_b16 a[10:11], v9 offset:2048
    v_mfma_f32_16x16x32_bf16 v[116:119], a[20:23], a[116:119], v[116:119]
    buffer_load_dwordx4 v4, s[44:47], s54 offen offset:1024 lds
    v_mfma_f32_16x16x32_bf16 v[100:103], a[16:19], a[116:119], v[100:103]
    v_mfma_f32_16x16x32_bf16 v[104:107], a[16:19], a[120:123], v[104:107]
    ds_read_b64_tr_b16 a[12:13], v9 offset:1024
    v_mfma_f32_16x16x32_bf16 v[120:123], a[20:23], a[120:123], v[120:123]
    ds_read_b64_tr_b16 a[14:15], v9 offset:3072
    v_mfma_f32_16x16x32_bf16 v[124:127], a[20:23], a[124:127], v[124:127]
    buffer_load_dwordx4 a[100:103], v3, s[32:35], s53 offen offset:1024 sc1
    v_mfma_f32_16x16x32_bf16 v[108:111], a[16:19], a[124:127], v[108:111]
    v_mfma_f32_16x16x32_bf16 v[140:143], a[24:27], a[124:127], v[140:143]
    ds_read_b64_tr_b16 a[16:17], v10 offset:0
    v_mfma_f32_16x16x32_bf16 v[156:159], a[28:31], a[124:127], v[156:159]
    ds_read_b64_tr_b16 a[18:19], v10 offset:2048
    v_mfma_f32_16x16x32_bf16 v[152:155], a[28:31], a[120:123], v[152:155]
    buffer_load_dwordx4 v5, s[36:39], s54 offen offset:2048 lds
    v_mfma_f32_16x16x32_bf16 v[136:139], a[24:27], a[120:123], v[136:139]
    v_mfma_f32_16x16x32_bf16 v[132:135], a[24:27], a[116:119], v[132:135]
    ds_read_b64_tr_b16 a[20:21], v10 offset:1024
    v_mfma_f32_16x16x32_bf16 v[148:151], a[28:31], a[116:119], v[148:151]
    ds_read_b64_tr_b16 a[22:23], v10 offset:3072
    v_mfma_f32_16x16x32_bf16 v[144:147], a[28:31], a[112:115], v[144:147]
    buffer_load_dwordx4 a[104:107], v3, s[32:35], s53 offen offset:2048 sc1
    v_mfma_f32_16x16x32_bf16 v[128:131], a[24:27], a[112:115], v[128:131]
    s_waitcnt lgkmcnt(15)
    v_mfma_f32_16x16x32_bf16 v[160:163], a[32:35], a[112:115], v[160:163]
    ds_read_b64_tr_b16 a[24:25], v11 offset:0
    v_mfma_f32_16x16x32_bf16 v[176:179], a[36:39], a[112:115], v[176:179]
    ds_read_b64_tr_b16 a[26:27], v11 offset:2048
    v_mfma_f32_16x16x32_bf16 v[180:183], a[36:39], a[116:119], v[180:183]
    buffer_load_dwordx4 v5, s[44:47], s54 offen offset:3072 lds
    v_mfma_f32_16x16x32_bf16 v[164:167], a[32:35], a[116:119], v[164:167]
    v_mfma_f32_16x16x32_bf16 v[168:171], a[32:35], a[120:123], v[168:171]
    ds_read_b64_tr_b16 a[28:29], v11 offset:1024
    v_mfma_f32_16x16x32_bf16 v[184:187], a[36:39], a[120:123], v[184:187]
    ds_read_b64_tr_b16 a[30:31], v11 offset:3072
    v_mfma_f32_16x16x32_bf16 v[188:191], a[36:39], a[124:127], v[188:191]
    buffer_load_dwordx4 a[108:111], v3, s[32:35], s53 offen offset:3072 sc1
    v_mfma_f32_16x16x32_bf16 v[172:175], a[32:35], a[124:127], v[172:175]
    v_mfma_f32_16x16x32_bf16 v[204:207], a[40:43], a[124:127], v[204:207]
    ds_read_b64_tr_b16 a[32:33], v8 offset:128
    v_mfma_f32_16x16x32_bf16 v[220:223], a[44:47], a[124:127], v[220:223]
    ds_read_b64_tr_b16 a[34:35], v8 offset:2176
    v_mfma_f32_16x16x32_bf16 v[216:219], a[44:47], a[120:123], v[216:219]
    s_add_u32 s59, s59, 1
    s_and_b32 s59, s59, 3
    v_mfma_f32_16x16x32_bf16 v[200:203], a[40:43], a[120:123], v[200:203]
    v_mfma_f32_16x16x32_bf16 v[196:199], a[40:43], a[116:119], v[196:199]
    ds_read_b64_tr_b16 a[36:37], v8 offset:1152
    v_mfma_f32_16x16x32_bf16 v[212:215], a[44:47], a[116:119], v[212:215]
    ds_read_b64_tr_b16 a[38:39], v8 offset:3200
    v_mfma_f32_16x16x32_bf16 v[208:211], a[44:47], a[112:115], v[208:211]
    s_cmp_eq_u32 s59, s60
    s_cselect_b32 s61, 4, 0
    s_add_u32 s58, s58, s61
    v_mfma_f32_16x16x32_bf16 v[192:195], a[40:43], a[112:115], v[192:195]
    s_waitcnt lgkmcnt(15)
    v_mfma_f32_16x16x32_bf16 v[224:227], a[48:51], a[112:115], v[224:227]
    ds_read_b64_tr_b16 a[40:41], v9 offset:128
    v_mfma_f32_16x16x32_bf16 v[240:243], a[52:55], a[112:115], v[240:243]
    ds_read_b64_tr_b16 a[42:43], v9 offset:2176
    v_mfma_f32_16x16x32_bf16 v[244:247], a[52:55], a[116:119], v[244:247]
    v_mfma_f32_16x16x32_bf16 v[228:231], a[48:51], a[116:119], v[228:231]
    v_mfma_f32_16x16x32_bf16 v[232:235], a[48:51], a[120:123], v[232:235]
    ds_read_b64_tr_b16 a[44:45], v9 offset:1152
    v_mfma_f32_16x16x32_bf16 v[248:251], a[52:55], a[120:123], v[248:251]
    ds_read_b64_tr_b16 a[46:47], v9 offset:3200
    v_mfma_f32_16x16x32_bf16 v[252:255], a[52:55], a[124:127], v[252:255]
    v_mfma_f32_16x16x32_bf16 v[236:239], a[48:51], a[124:127], v[236:239]
    s_waitcnt lgkmcnt(12)
    v_mfma_f32_16x16x32_bf16 v[32:35], a[0:3], a[64:67], v[32:35]
    ds_read_b64_tr_b16 a[48:49], v10 offset:128
    v_mfma_f32_16x16x32_bf16 v[48:51], a[4:7], a[64:67], v[48:51]
    ds_read_b64_tr_b16 a[50:51], v10 offset:2176
    v_mfma_f32_16x16x32_bf16 v[52:55], a[4:7], a[68:71], v[52:55]
    ds_read_b64_tr_b16 a[52:53], v10 offset:1152
    v_mfma_f32_16x16x32_bf16 v[36:39], a[0:3], a[68:71], v[36:39]
    ds_read_b64_tr_b16 a[54:55], v10 offset:3200
    v_mfma_f32_16x16x32_bf16 v[40:43], a[0:3], a[72:75], v[40:43]
    v_mfma_f32_16x16x32_bf16 v[56:59], a[4:7], a[72:75], v[56:59]
    s_waitcnt vmcnt(8)
    s_barrier
    v_mfma_f32_16x16x32_bf16 v[60:63], a[4:7], a[76:79], v[60:63]
    s_add_u32 s61, s58, s59
    s_lshl_b32 s53, s61, 17
    s_mul_i32 s54, s61, 229376
    v_mfma_f32_16x16x32_bf16 v[44:47], a[0:3], a[76:79], v[44:47]
    s_add_u32 m0, s52, 50688
    v_mfma_f32_16x16x32_bf16 v[76:79], a[8:11], a[76:79], v[76:79]
    ds_read_b64_tr_b16 a[0:1], v8 offset:16896
    v_mfma_f32_16x16x32_bf16 v[92:95], a[12:15], a[76:79], v[92:95]
    ds_read_b64_tr_b16 a[2:3], v8 offset:18944
    v_mfma_f32_16x16x32_bf16 v[88:91], a[12:15], a[72:75], v[88:91]
    buffer_load_dwordx4 v4, s[36:39], s54 offen lds
    v_mfma_f32_16x16x32_bf16 v[72:75], a[8:11], a[72:75], v[72:75]
    v_mfma_f32_16x16x32_bf16 v[68:71], a[8:11], a[68:71], v[68:71]
    ds_read_b64_tr_b16 a[4:5], v8 offset:17920
    v_mfma_f32_16x16x32_bf16 v[84:87], a[12:15], a[68:71], v[84:87]
    ds_read_b64_tr_b16 a[6:7], v8 offset:19968
    v_mfma_f32_16x16x32_bf16 v[80:83], a[12:15], a[64:67], v[80:83]
    buffer_load_dwordx4 a[112:115], v3, s[32:35], s53 offen offset:0 sc1
    v_mfma_f32_16x16x32_bf16 v[64:67], a[8:11], a[64:67], v[64:67]
    s_waitcnt lgkmcnt(15)
    v_mfma_f32_16x16x32_bf16 v[96:99], a[16:19], a[64:67], v[96:99]
    ds_read_b64_tr_b16 a[8:9], v9 offset:16896
    v_mfma_f32_16x16x32_bf16 v[112:115], a[20:23], a[64:67], v[112:115]
    ds_read_b64_tr_b16 a[10:11], v9 offset:18944
    v_mfma_f32_16x16x32_bf16 v[116:119], a[20:23], a[68:71], v[116:119]
    buffer_load_dwordx4 v4, s[44:47], s54 offen offset:1024 lds
    v_mfma_f32_16x16x32_bf16 v[100:103], a[16:19], a[68:71], v[100:103]
    v_mfma_f32_16x16x32_bf16 v[104:107], a[16:19], a[72:75], v[104:107]
    ds_read_b64_tr_b16 a[12:13], v9 offset:17920
    v_mfma_f32_16x16x32_bf16 v[120:123], a[20:23], a[72:75], v[120:123]
    ds_read_b64_tr_b16 a[14:15], v9 offset:19968
    v_mfma_f32_16x16x32_bf16 v[124:127], a[20:23], a[76:79], v[124:127]
    buffer_load_dwordx4 a[116:119], v3, s[32:35], s53 offen offset:1024 sc1
    v_mfma_f32_16x16x32_bf16 v[108:111], a[16:19], a[76:79], v[108:111]
    v_mfma_f32_16x16x32_bf16 v[140:143], a[24:27], a[76:79], v[140:143]
    ds_read_b64_tr_b16 a[16:17], v10 offset:16896
    v_mfma_f32_16x16x32_bf16 v[156:159], a[28:31], a[76:79], v[156:159]
    ds_read_b64_tr_b16 a[18:19], v10 offset:18944
    v_mfma_f32_16x16x32_bf16 v[152:155], a[28:31], a[72:75], v[152:155]
    buffer_load_dwordx4 v5, s[36:39], s54 offen offset:2048 lds
    v_mfma_f32_16x16x32_bf16 v[136:139], a[24:27], a[72:75], v[136:139]
    v_mfma_f32_16x16x32_bf16 v[132:135], a[24:27], a[68:71], v[132:135]
    ds_read_b64_tr_b16 a[20:21], v10 offset:17920
    v_mfma_f32_16x16x32_bf16 v[148:151], a[28:31], a[68:71], v[148:151]
    ds_read_b64_tr_b16 a[22:23], v10 offset:19968
    v_mfma_f32_16x16x32_bf16 v[144:147], a[28:31], a[64:67], v[144:147]
    buffer_load_dwordx4 a[120:123], v3, s[32:35], s53 offen offset:2048 sc1
    v_mfma_f32_16x16x32_bf16 v[128:131], a[24:27], a[64:67], v[128:131]
    s_waitcnt lgkmcnt(15)
    v_mfma_f32_16x16x32_bf16 v[160:163], a[32:35], a[64:67], v[160:163]
    ds_read_b64_tr_b16 a[24:25], v11 offset:16896
    v_mfma_f32_16x16x32_bf16 v[176:179], a[36:39], a[64:67], v[176:179]
    ds_read_b64_tr_b16 a[26:27], v11 offset:18944
    v_mfma_f32_16x16x32_bf16 v[180:183], a[36:39], a[68:71], v[180:183]
    buffer_load_dwordx4 v5, s[44:47], s54 offen offset:3072 lds
    v_mfma_f32_16x16x32_bf16 v[164:167], a[32:35], a[68:71], v[164:167]
    v_mfma_f32_16x16x32_bf16 v[168:171], a[32:35], a[72:75], v[168:171]
    ds_read_b64_tr_b16 a[28:29], v11 offset:17920
    v_mfma_f32_16x16x32_bf16 v[184:187], a[36:39], a[72:75], v[184:187]
    ds_read_b64_tr_b16 a[30:31], v11 offset:19968
    v_mfma_f32_16x16x32_bf16 v[188:191], a[36:39], a[76:79], v[188:191]
    buffer_load_dwordx4 a[124:127], v3, s[32:35], s53 offen offset:3072 sc1
    v_mfma_f32_16x16x32_bf16 v[172:175], a[32:35], a[76:79], v[172:175]
    v_mfma_f32_16x16x32_bf16 v[204:207], a[40:43], a[76:79], v[204:207]
    ds_read_b64_tr_b16 a[32:33], v8 offset:17024
    v_mfma_f32_16x16x32_bf16 v[220:223], a[44:47], a[76:79], v[220:223]
    ds_read_b64_tr_b16 a[34:35], v8 offset:19072
    v_mfma_f32_16x16x32_bf16 v[216:219], a[44:47], a[72:75], v[216:219]
    s_add_u32 s59, s59, 1
    s_and_b32 s59, s59, 3
    v_mfma_f32_16x16x32_bf16 v[200:203], a[40:43], a[72:75], v[200:203]
    v_mfma_f32_16x16x32_bf16 v[196:199], a[40:43], a[68:71], v[196:199]
    ds_read_b64_tr_b16 a[36:37], v8 offset:18048
    v_mfma_f32_16x16x32_bf16 v[212:215], a[44:47], a[68:71], v[212:215]
    ds_read_b64_tr_b16 a[38:39], v8 offset:20096
    v_mfma_f32_16x16x32_bf16 v[208:211], a[44:47], a[64:67], v[208:211]
    s_cmp_eq_u32 s59, s60
    s_cselect_b32 s61, 4, 0
    s_add_u32 s58, s58, s61
    v_mfma_f32_16x16x32_bf16 v[192:195], a[40:43], a[64:67], v[192:195]
    s_waitcnt lgkmcnt(15)
    v_mfma_f32_16x16x32_bf16 v[224:227], a[48:51], a[64:67], v[224:227]
    ds_read_b64_tr_b16 a[40:41], v9 offset:17024
    v_mfma_f32_16x16x32_bf16 v[240:243], a[52:55], a[64:67], v[240:243]
    ds_read_b64_tr_b16 a[42:43], v9 offset:19072
    v_mfma_f32_16x16x32_bf16 v[244:247], a[52:55], a[68:71], v[244:247]
    s_sub_u32 s57, s57, 1
    s_cmp_lg_u32 s57, 0
    v_mfma_f32_16x16x32_bf16 v[228:231], a[48:51], a[68:71], v[228:231]
    v_mfma_f32_16x16x32_bf16 v[232:235], a[48:51], a[72:75], v[232:235]
    ds_read_b64_tr_b16 a[44:45], v9 offset:18048
    v_mfma_f32_16x16x32_bf16 v[248:251], a[52:55], a[72:75], v[248:251]
    ds_read_b64_tr_b16 a[46:47], v9 offset:20096
    v_mfma_f32_16x16x32_bf16 v[252:255], a[52:55], a[76:79], v[252:255]
    v_mfma_f32_16x16x32_bf16 v[236:239], a[48:51], a[76:79], v[236:239]
    s_cbranch_scc1 floop_adaLN_cond__linear_kernel_hedgehog__glu_gated_swiglu__prompt_kernel_43
adaLN_cond__linear_kernel_hedgehog__glu_gated_swiglu__prompt_kernel_c2:
    ds_read_b64_tr_b16 a[48:49], v10 offset:17024
    ds_read_b64_tr_b16 a[50:51], v10 offset:19072
    ds_read_b64_tr_b16 a[52:53], v10 offset:18048
    ds_read_b64_tr_b16 a[54:55], v10 offset:20096
    buffer_load_dword a239, v12, s[16:19], 0 offen
    s_lshl_b32 s61, s42, 14
    v_add_u32 v16, s61, v3
    s_mul_i32 s12, s43, 7
    s_add_u32 s12, s12, 1
    s_lshr_b32 s12, s12, 1
    s_lshl_b32 s12, s12, 17
    s_add_u32 s13, s12, 0x20000
    s_add_u32 s14, s12, 0x40000
    s_add_u32 s15, s12, 0x60000
    s_sub_u32 s61, s12, 0x1fe00
    s_cmp_eq_u32 s56, 1
    s_cselect_b32 s15, s61, s15
    v_lshlrev_b32 v17, 3, v1
    v_sub_u32 v17, v16, v17
    s_mov_b32 s10, 3216550459
    s_mov_b32 s11, 3216550459
    s_mov_b32 s8, 1.0
    s_mov_b32 s9, 1.0
    s_waitcnt lgkmcnt(15)
    v_mfma_f32_16x16x32_bf16 v[64:67], a[8:11], a[80:83], v[64:67]
    v_mfma_f32_16x16x32_bf16 v[80:83], a[12:15], a[80:83], v[80:83]
    v_mfma_f32_16x16x32_bf16 v[84:87], a[12:15], a[84:87], v[84:87]
    v_mfma_f32_16x16x32_bf16 v[68:71], a[8:11], a[84:87], v[68:71]
    v_mfma_f32_16x16x32_bf16 v[72:75], a[8:11], a[88:91], v[72:75]
    v_mfma_f32_16x16x32_bf16 v[88:91], a[12:15], a[88:91], v[88:91]
    v_mfma_f32_16x16x32_bf16 v[92:95], a[12:15], a[92:95], v[92:95]
    v_mfma_f32_16x16x32_bf16 v[76:79], a[8:11], a[92:95], v[76:79]
    v_mfma_f32_16x16x32_bf16 v[96:99], a[16:19], a[80:83], v[96:99]
    v_mfma_f32_16x16x32_bf16 v[112:115], a[20:23], a[80:83], v[112:115]
    v_mfma_f32_16x16x32_bf16 v[116:119], a[20:23], a[84:87], v[116:119]
    v_mfma_f32_16x16x32_bf16 v[100:103], a[16:19], a[84:87], v[100:103]
    v_mfma_f32_16x16x32_bf16 v[104:107], a[16:19], a[88:91], v[104:107]
    v_mfma_f32_16x16x32_bf16 v[120:123], a[20:23], a[88:91], v[120:123]
    v_mfma_f32_16x16x32_bf16 v[124:127], a[20:23], a[92:95], v[124:127]
    v_mfma_f32_16x16x32_bf16 v[108:111], a[16:19], a[92:95], v[108:111]
    s_waitcnt vmcnt(1) lgkmcnt(0)
    s_barrier
    v_mfma_f32_16x16x32_bf16 v[32:35], a[0:3], a[80:83], v[32:35]
    ds_read_b64_tr_b16 a[128:129], v8 offset:33792
    v_mfma_f32_16x16x32_bf16 v[48:51], a[4:7], a[80:83], v[48:51]
    ds_read_b64_tr_b16 a[130:131], v8 offset:35840
    v_mfma_f32_16x16x32_bf16 v[52:55], a[4:7], a[84:87], v[52:55]
    ds_read_b64_tr_b16 a[132:133], v8 offset:34816
    v_mfma_f32_16x16x32_bf16 v[36:39], a[0:3], a[84:87], v[36:39]
    ds_read_b64_tr_b16 a[134:135], v8 offset:36864
    v_mfma_f32_16x16x32_bf16 v[40:43], a[0:3], a[88:91], v[40:43]
    ds_read_b64_tr_b16 a[136:137], v8 offset:50688
    v_mfma_f32_16x16x32_bf16 v[56:59], a[4:7], a[88:91], v[56:59]
    ds_read_b64_tr_b16 a[138:139], v8 offset:52736
    v_mfma_f32_16x16x32_bf16 v[60:63], a[4:7], a[92:95], v[60:63]
    ds_read_b64_tr_b16 a[140:141], v8 offset:51712
    v_mfma_f32_16x16x32_bf16 v[44:47], a[0:3], a[92:95], v[44:47]
    ds_read_b64_tr_b16 a[142:143], v8 offset:53760
    s_waitcnt lgkmcnt(0)
    v_mfma_f32_16x16x32_bf16 v[32:35], a[128:131], a[96:99], v[32:35]
    ds_read_b64_tr_b16 a[144:145], v9 offset:33792
    v_mfma_f32_16x16x32_bf16 v[48:51], a[132:135], a[96:99], v[48:51]
    v_mfma_f32_16x16x32_bf16 v[52:55], a[132:135], a[100:103], v[52:55]
    ds_read_b64_tr_b16 a[146:147], v9 offset:35840
    v_mfma_f32_16x16x32_bf16 v[36:39], a[128:131], a[100:103], v[36:39]
    v_mfma_f32_16x16x32_bf16 v[40:43], a[128:131], a[104:107], v[40:43]
    ds_read_b64_tr_b16 a[148:149], v9 offset:34816
    v_mfma_f32_16x16x32_bf16 v[56:59], a[132:135], a[104:107], v[56:59]
    v_mfma_f32_16x16x32_bf16 v[60:63], a[132:135], a[108:111], v[60:63]
    ds_read_b64_tr_b16 a[150:151], v9 offset:36864
    v_mfma_f32_16x16x32_bf16 v[44:47], a[128:131], a[108:111], v[44:47]
    v_mfma_f32_16x16x32_bf16 v[32:35], a[136:139], a[112:115], v[32:35]
    ds_read_b64_tr_b16 a[152:153], v9 offset:50688
    v_mfma_f32_16x16x32_bf16 v[48:51], a[140:143], a[112:115], v[48:51]
    v_mfma_f32_16x16x32_bf16 v[52:55], a[140:143], a[116:119], v[52:55]
    ds_read_b64_tr_b16 a[154:155], v9 offset:52736
    v_mfma_f32_16x16x32_bf16 v[36:39], a[136:139], a[116:119], v[36:39]
    v_mfma_f32_16x16x32_bf16 v[40:43], a[136:139], a[120:123], v[40:43]
    ds_read_b64_tr_b16 a[156:157], v9 offset:51712
    v_mfma_f32_16x16x32_bf16 v[56:59], a[140:143], a[120:123], v[56:59]
    v_mfma_f32_16x16x32_bf16 v[60:63], a[140:143], a[124:127], v[60:63]
    ds_read_b64_tr_b16 a[158:159], v9 offset:53760
    v_mfma_f32_16x16x32_bf16 v[44:47], a[136:139], a[124:127], v[44:47]
    s_waitcnt lgkmcnt(0)
    v_mfma_f32_16x16x32_bf16 v[128:131], a[24:27], a[80:83], v[128:131]
    ds_read_b64_tr_b16 a[128:129], v10 offset:33792
    ds_read_b64_tr_b16 a[130:131], v10 offset:35840
    v_mfma_f32_16x16x32_bf16 v[144:147], a[28:31], a[80:83], v[144:147]
    ds_read_b64_tr_b16 a[132:133], v10 offset:34816
    ds_read_b64_tr_b16 a[134:135], v10 offset:36864
    v_pk_mul_f32 v[20:21], v[32:33], s[10:11]
    v_pk_mul_f32 v[22:23], v[34:35], s[10:11]
    v_pk_mul_f32 v[24:25], v[36:37], s[10:11]
    v_pk_mul_f32 v[26:27], v[38:39], s[10:11]
    v_pk_mul_f32 v[12:13], v[40:41], s[10:11]
    v_pk_mul_f32 v[14:15], v[42:43], s[10:11]
    v_pk_mul_f32 v[4:5], v[44:45], s[10:11]
    v_pk_mul_f32 v[6:7], v[46:47], s[10:11]
    v_mfma_f32_16x16x32_bf16 v[148:151], a[28:31], a[84:87], v[148:151]
    ds_read_b64_tr_b16 a[136:137], v10 offset:50688
    ds_read_b64_tr_b16 a[138:139], v10 offset:52736
    v_mfma_f32_16x16x32_bf16 v[132:135], a[24:27], a[84:87], v[132:135]
    ds_read_b64_tr_b16 a[140:141], v10 offset:51712
    ds_read_b64_tr_b16 a[142:143], v10 offset:53760
    v_mfma_f32_16x16x32_bf16 v[136:139], a[24:27], a[88:91], v[136:139]
    v_exp_f32 v20, v20
    v_exp_f32 v21, v21
    v_mfma_f32_16x16x32_bf16 v[152:155], a[28:31], a[88:91], v[152:155]
    v_exp_f32 v22, v22
    v_exp_f32 v23, v23
    v_mfma_f32_16x16x32_bf16 v[156:159], a[28:31], a[92:95], v[156:159]
    v_exp_f32 v24, v24
    v_exp_f32 v25, v25
    v_mfma_f32_16x16x32_bf16 v[140:143], a[24:27], a[92:95], v[140:143]
    v_exp_f32 v26, v26
    v_mfma_f32_16x16x32_bf16 v[64:67], a[144:147], a[96:99], v[64:67]
    v_exp_f32 v27, v27
    v_exp_f32 v12, v12
    v_mfma_f32_16x16x32_bf16 v[80:83], a[148:151], a[96:99], v[80:83]
    v_exp_f32 v13, v13
    v_exp_f32 v14, v14
    v_mfma_f32_16x16x32_bf16 v[84:87], a[148:151], a[100:103], v[84:87]
    v_exp_f32 v15, v15
    v_exp_f32 v4, v4
    v_mfma_f32_16x16x32_bf16 v[68:71], a[144:147], a[100:103], v[68:71]
    v_exp_f32 v5, v5
    v_exp_f32 v6, v6
    v_mfma_f32_16x16x32_bf16 v[72:75], a[144:147], a[104:107], v[72:75]
    v_exp_f32 v7, v7
    v_pk_mul_f32 v[32:33], v[32:33], v[48:49]
    v_pk_mul_f32 v[34:35], v[34:35], v[50:51]
    v_pk_add_f32 v[20:21], v[20:21], s[8:9]
    v_pk_add_f32 v[22:23], v[22:23], s[8:9]
    v_pk_mul_f32 v[36:37], v[36:37], v[52:53]
    v_pk_mul_f32 v[38:39], v[38:39], v[54:55]
    v_pk_add_f32 v[24:25], v[24:25], s[8:9]
    v_pk_add_f32 v[26:27], v[26:27], s[8:9]
    v_pk_mul_f32 v[40:41], v[40:41], v[56:57]
    v_pk_mul_f32 v[42:43], v[42:43], v[58:59]
    v_pk_add_f32 v[12:13], v[12:13], s[8:9]
    v_pk_add_f32 v[14:15], v[14:15], s[8:9]
    v_pk_mul_f32 v[44:45], v[44:45], v[60:61]
    v_pk_mul_f32 v[46:47], v[46:47], v[62:63]
    v_pk_add_f32 v[4:5], v[4:5], s[8:9]
    v_pk_add_f32 v[6:7], v[6:7], s[8:9]
    v_mfma_f32_16x16x32_bf16 v[88:91], a[148:151], a[104:107], v[88:91]
    v_rcp_f32 v20, v20
    v_rcp_f32 v21, v21
    v_mfma_f32_16x16x32_bf16 v[92:95], a[148:151], a[108:111], v[92:95]
    v_rcp_f32 v22, v22
    v_mfma_f32_16x16x32_bf16 v[76:79], a[144:147], a[108:111], v[76:79]
    v_rcp_f32 v23, v23
    v_rcp_f32 v24, v24
    v_mfma_f32_16x16x32_bf16 v[64:67], a[152:155], a[112:115], v[64:67]
    v_rcp_f32 v25, v25
    v_mfma_f32_16x16x32_bf16 v[80:83], a[156:159], a[112:115], v[80:83]
    v_rcp_f32 v26, v26
    v_rcp_f32 v27, v27
    v_mfma_f32_16x16x32_bf16 v[84:87], a[156:159], a[116:119], v[84:87]
    v_rcp_f32 v12, v12
    v_mfma_f32_16x16x32_bf16 v[68:71], a[152:155], a[116:119], v[68:71]
    v_rcp_f32 v13, v13
    v_rcp_f32 v14, v14
    v_mfma_f32_16x16x32_bf16 v[72:75], a[152:155], a[120:123], v[72:75]
    v_rcp_f32 v15, v15
    v_mfma_f32_16x16x32_bf16 v[88:91], a[156:159], a[120:123], v[88:91]
    v_rcp_f32 v4, v4
    v_rcp_f32 v5, v5
    v_mfma_f32_16x16x32_bf16 v[92:95], a[156:159], a[124:127], v[92:95]
    v_rcp_f32 v6, v6
    v_mfma_f32_16x16x32_bf16 v[76:79], a[152:155], a[124:127], v[76:79]
    v_rcp_f32 v7, v7
    v_pk_mul_f32 v[32:33], v[32:33], v[20:21]
    v_pk_mul_f32 v[34:35], v[34:35], v[22:23]
    v_pk_mul_f32 v[36:37], v[36:37], v[24:25]
    v_pk_mul_f32 v[38:39], v[38:39], v[26:27]
    v_pk_mul_f32 v[40:41], v[40:41], v[12:13]
    v_pk_mul_f32 v[42:43], v[42:43], v[14:15]
    v_pk_mul_f32 v[44:45], v[44:45], v[4:5]
    v_pk_mul_f32 v[46:47], v[46:47], v[6:7]
    v_cvt_pk_bf16_f32 v48, v32, v33
    v_cvt_pk_bf16_f32 v49, v34, v35
    v_cvt_pk_bf16_f32 v52, v36, v37
    v_cvt_pk_bf16_f32 v53, v38, v39
    v_cvt_pk_bf16_f32 v56, v40, v41
    v_cvt_pk_bf16_f32 v57, v42, v43
    v_cvt_pk_bf16_f32 v60, v44, v45
    v_cvt_pk_bf16_f32 v61, v46, v47
    s_waitcnt lgkmcnt(0)
    v_mfma_f32_16x16x32_bf16 v[160:163], a[32:35], a[80:83], v[160:163]
    ds_read_b64_tr_b16 a[144:145], v11 offset:33792
    ds_read_b64_tr_b16 a[146:147], v11 offset:35840
    v_mfma_f32_16x16x32_bf16 v[176:179], a[36:39], a[80:83], v[176:179]
    ds_read_b64_tr_b16 a[148:149], v11 offset:34816
    ds_read_b64_tr_b16 a[150:151], v11 offset:36864
    v_pk_mul_f32 v[20:21], v[64:65], s[10:11]
    v_pk_mul_f32 v[22:23], v[66:67], s[10:11]
    v_pk_mul_f32 v[24:25], v[68:69], s[10:11]
    v_pk_mul_f32 v[26:27], v[70:71], s[10:11]
    v_pk_mul_f32 v[12:13], v[72:73], s[10:11]
    v_pk_mul_f32 v[14:15], v[74:75], s[10:11]
    v_pk_mul_f32 v[4:5], v[76:77], s[10:11]
    v_pk_mul_f32 v[6:7], v[78:79], s[10:11]
    v_mfma_f32_16x16x32_bf16 v[180:183], a[36:39], a[84:87], v[180:183]
    ds_read_b64_tr_b16 a[152:153], v11 offset:50688
    ds_read_b64_tr_b16 a[154:155], v11 offset:52736
    v_mfma_f32_16x16x32_bf16 v[164:167], a[32:35], a[84:87], v[164:167]
    ds_read_b64_tr_b16 a[156:157], v11 offset:51712
    ds_read_b64_tr_b16 a[158:159], v11 offset:53760
    v_mfma_f32_16x16x32_bf16 v[168:171], a[32:35], a[88:91], v[168:171]
    v_exp_f32 v20, v20
    v_exp_f32 v21, v21
    v_mfma_f32_16x16x32_bf16 v[184:187], a[36:39], a[88:91], v[184:187]
    v_exp_f32 v22, v22
    v_exp_f32 v23, v23
    v_mfma_f32_16x16x32_bf16 v[188:191], a[36:39], a[92:95], v[188:191]
    v_exp_f32 v24, v24
    v_exp_f32 v25, v25
    v_mfma_f32_16x16x32_bf16 v[172:175], a[32:35], a[92:95], v[172:175]
    v_exp_f32 v26, v26
    v_mfma_f32_16x16x32_bf16 v[96:99], a[128:131], a[96:99], v[96:99]
    v_exp_f32 v27, v27
    v_exp_f32 v12, v12
    v_mfma_f32_16x16x32_bf16 v[112:115], a[132:135], a[96:99], v[112:115]
    v_exp_f32 v13, v13
    v_exp_f32 v14, v14
    v_mfma_f32_16x16x32_bf16 v[116:119], a[132:135], a[100:103], v[116:119]
    v_exp_f32 v15, v15
    v_exp_f32 v4, v4
    v_mfma_f32_16x16x32_bf16 v[100:103], a[128:131], a[100:103], v[100:103]
    v_exp_f32 v5, v5
    v_exp_f32 v6, v6
    v_mfma_f32_16x16x32_bf16 v[104:107], a[128:131], a[104:107], v[104:107]
    v_exp_f32 v7, v7
    v_pk_mul_f32 v[64:65], v[64:65], v[80:81]
    v_pk_mul_f32 v[66:67], v[66:67], v[82:83]
    v_pk_add_f32 v[20:21], v[20:21], s[8:9]
    v_pk_add_f32 v[22:23], v[22:23], s[8:9]
    v_pk_mul_f32 v[68:69], v[68:69], v[84:85]
    v_pk_mul_f32 v[70:71], v[70:71], v[86:87]
    v_pk_add_f32 v[24:25], v[24:25], s[8:9]
    v_pk_add_f32 v[26:27], v[26:27], s[8:9]
    v_pk_mul_f32 v[72:73], v[72:73], v[88:89]
    v_pk_mul_f32 v[74:75], v[74:75], v[90:91]
    v_pk_add_f32 v[12:13], v[12:13], s[8:9]
    v_pk_add_f32 v[14:15], v[14:15], s[8:9]
    v_pk_mul_f32 v[76:77], v[76:77], v[92:93]
    v_pk_mul_f32 v[78:79], v[78:79], v[94:95]
    v_pk_add_f32 v[4:5], v[4:5], s[8:9]
    v_pk_add_f32 v[6:7], v[6:7], s[8:9]
    v_mfma_f32_16x16x32_bf16 v[120:123], a[132:135], a[104:107], v[120:123]
    v_rcp_f32 v20, v20
    v_rcp_f32 v21, v21
    v_mfma_f32_16x16x32_bf16 v[124:127], a[132:135], a[108:111], v[124:127]
    v_rcp_f32 v22, v22
    v_mfma_f32_16x16x32_bf16 v[108:111], a[128:131], a[108:111], v[108:111]
    v_rcp_f32 v23, v23
    v_rcp_f32 v24, v24
    v_mfma_f32_16x16x32_bf16 v[96:99], a[136:139], a[112:115], v[96:99]
    v_rcp_f32 v25, v25
    v_mfma_f32_16x16x32_bf16 v[112:115], a[140:143], a[112:115], v[112:115]
    v_rcp_f32 v26, v26
    v_rcp_f32 v27, v27
    v_mfma_f32_16x16x32_bf16 v[116:119], a[140:143], a[116:119], v[116:119]
    v_rcp_f32 v12, v12
    v_mfma_f32_16x16x32_bf16 v[100:103], a[136:139], a[116:119], v[100:103]
    v_rcp_f32 v13, v13
    v_rcp_f32 v14, v14
    v_mfma_f32_16x16x32_bf16 v[104:107], a[136:139], a[120:123], v[104:107]
    v_rcp_f32 v15, v15
    v_mfma_f32_16x16x32_bf16 v[120:123], a[140:143], a[120:123], v[120:123]
    v_rcp_f32 v4, v4
    v_rcp_f32 v5, v5
    v_mfma_f32_16x16x32_bf16 v[124:127], a[140:143], a[124:127], v[124:127]
    v_rcp_f32 v6, v6
    v_mfma_f32_16x16x32_bf16 v[108:111], a[136:139], a[124:127], v[108:111]
    v_rcp_f32 v7, v7
    v_pk_mul_f32 v[64:65], v[64:65], v[20:21]
    v_pk_mul_f32 v[66:67], v[66:67], v[22:23]
    v_pk_mul_f32 v[68:69], v[68:69], v[24:25]
    v_pk_mul_f32 v[70:71], v[70:71], v[26:27]
    v_pk_mul_f32 v[72:73], v[72:73], v[12:13]
    v_pk_mul_f32 v[74:75], v[74:75], v[14:15]
    v_pk_mul_f32 v[76:77], v[76:77], v[4:5]
    v_pk_mul_f32 v[78:79], v[78:79], v[6:7]
    v_cvt_pk_bf16_f32 v50, v64, v65
    v_cvt_pk_bf16_f32 v51, v66, v67
    buffer_store_dwordx4 v[48:51], v16, s[48:51], s12 offen offset:0 sc1
    v_cvt_pk_bf16_f32 v54, v68, v69
    v_cvt_pk_bf16_f32 v55, v70, v71
    buffer_store_dwordx4 v[52:55], v16, s[48:51], s12 offen offset:1024 sc1
    v_cvt_pk_bf16_f32 v58, v72, v73
    v_cvt_pk_bf16_f32 v59, v74, v75
    buffer_store_dwordx4 v[56:59], v16, s[48:51], s12 offen offset:2048 sc1
    v_cvt_pk_bf16_f32 v62, v76, v77
    v_cvt_pk_bf16_f32 v63, v78, v79
    buffer_store_dwordx4 v[60:63], v16, s[48:51], s12 offen offset:3072 sc1
    s_waitcnt lgkmcnt(0)
    v_mfma_f32_16x16x32_bf16 v[192:195], a[40:43], a[80:83], v[192:195]
    ds_read_b64_tr_b16 a[128:129], v8 offset:33920
    ds_read_b64_tr_b16 a[130:131], v8 offset:35968
    v_mfma_f32_16x16x32_bf16 v[208:211], a[44:47], a[80:83], v[208:211]
    ds_read_b64_tr_b16 a[132:133], v8 offset:34944
    ds_read_b64_tr_b16 a[134:135], v8 offset:36992
    v_pk_mul_f32 v[20:21], v[96:97], s[10:11]
    v_pk_mul_f32 v[22:23], v[98:99], s[10:11]
    v_pk_mul_f32 v[24:25], v[100:101], s[10:11]
    v_pk_mul_f32 v[26:27], v[102:103], s[10:11]
    v_pk_mul_f32 v[12:13], v[104:105], s[10:11]
    v_pk_mul_f32 v[14:15], v[106:107], s[10:11]
    v_pk_mul_f32 v[4:5], v[108:109], s[10:11]
    v_pk_mul_f32 v[6:7], v[110:111], s[10:11]
    v_mfma_f32_16x16x32_bf16 v[212:215], a[44:47], a[84:87], v[212:215]
    ds_read_b64_tr_b16 a[136:137], v8 offset:50816
    ds_read_b64_tr_b16 a[138:139], v8 offset:52864
    v_mfma_f32_16x16x32_bf16 v[196:199], a[40:43], a[84:87], v[196:199]
    ds_read_b64_tr_b16 a[140:141], v8 offset:51840
    ds_read_b64_tr_b16 a[142:143], v8 offset:53888
    v_mfma_f32_16x16x32_bf16 v[200:203], a[40:43], a[88:91], v[200:203]
    v_exp_f32 v20, v20
    v_exp_f32 v21, v21
    v_mfma_f32_16x16x32_bf16 v[216:219], a[44:47], a[88:91], v[216:219]
    v_exp_f32 v22, v22
    v_exp_f32 v23, v23
    v_mfma_f32_16x16x32_bf16 v[220:223], a[44:47], a[92:95], v[220:223]
    v_exp_f32 v24, v24
    v_exp_f32 v25, v25
    v_mfma_f32_16x16x32_bf16 v[204:207], a[40:43], a[92:95], v[204:207]
    v_exp_f32 v26, v26
    v_mfma_f32_16x16x32_bf16 v[128:131], a[144:147], a[96:99], v[128:131]
    v_exp_f32 v27, v27
    v_exp_f32 v12, v12
    v_mfma_f32_16x16x32_bf16 v[144:147], a[148:151], a[96:99], v[144:147]
    v_exp_f32 v13, v13
    v_exp_f32 v14, v14
    v_mfma_f32_16x16x32_bf16 v[148:151], a[148:151], a[100:103], v[148:151]
    v_exp_f32 v15, v15
    v_exp_f32 v4, v4
    v_mfma_f32_16x16x32_bf16 v[132:135], a[144:147], a[100:103], v[132:135]
    v_exp_f32 v5, v5
    v_exp_f32 v6, v6
    v_mfma_f32_16x16x32_bf16 v[136:139], a[144:147], a[104:107], v[136:139]
    v_exp_f32 v7, v7
    v_pk_mul_f32 v[96:97], v[96:97], v[112:113]
    v_pk_mul_f32 v[98:99], v[98:99], v[114:115]
    v_pk_add_f32 v[20:21], v[20:21], s[8:9]
    v_pk_add_f32 v[22:23], v[22:23], s[8:9]
    v_pk_mul_f32 v[100:101], v[100:101], v[116:117]
    v_pk_mul_f32 v[102:103], v[102:103], v[118:119]
    v_pk_add_f32 v[24:25], v[24:25], s[8:9]
    v_pk_add_f32 v[26:27], v[26:27], s[8:9]
    v_pk_mul_f32 v[104:105], v[104:105], v[120:121]
    v_pk_mul_f32 v[106:107], v[106:107], v[122:123]
    v_pk_add_f32 v[12:13], v[12:13], s[8:9]
    v_pk_add_f32 v[14:15], v[14:15], s[8:9]
    v_pk_mul_f32 v[108:109], v[108:109], v[124:125]
    v_pk_mul_f32 v[110:111], v[110:111], v[126:127]
    v_pk_add_f32 v[4:5], v[4:5], s[8:9]
    v_pk_add_f32 v[6:7], v[6:7], s[8:9]
    v_mfma_f32_16x16x32_bf16 v[152:155], a[148:151], a[104:107], v[152:155]
    v_rcp_f32 v20, v20
    v_rcp_f32 v21, v21
    v_mfma_f32_16x16x32_bf16 v[156:159], a[148:151], a[108:111], v[156:159]
    v_rcp_f32 v22, v22
    v_mfma_f32_16x16x32_bf16 v[140:143], a[144:147], a[108:111], v[140:143]
    v_rcp_f32 v23, v23
    v_rcp_f32 v24, v24
    v_mfma_f32_16x16x32_bf16 v[128:131], a[152:155], a[112:115], v[128:131]
    v_rcp_f32 v25, v25
    v_mfma_f32_16x16x32_bf16 v[144:147], a[156:159], a[112:115], v[144:147]
    v_rcp_f32 v26, v26
    v_rcp_f32 v27, v27
    v_mfma_f32_16x16x32_bf16 v[148:151], a[156:159], a[116:119], v[148:151]
    v_rcp_f32 v12, v12
    v_mfma_f32_16x16x32_bf16 v[132:135], a[152:155], a[116:119], v[132:135]
    v_rcp_f32 v13, v13
    v_rcp_f32 v14, v14
    v_mfma_f32_16x16x32_bf16 v[136:139], a[152:155], a[120:123], v[136:139]
    v_rcp_f32 v15, v15
    v_mfma_f32_16x16x32_bf16 v[152:155], a[156:159], a[120:123], v[152:155]
    v_rcp_f32 v4, v4
    v_rcp_f32 v5, v5
    v_mfma_f32_16x16x32_bf16 v[156:159], a[156:159], a[124:127], v[156:159]
    v_rcp_f32 v6, v6
    v_mfma_f32_16x16x32_bf16 v[140:143], a[152:155], a[124:127], v[140:143]
    v_rcp_f32 v7, v7
    v_pk_mul_f32 v[96:97], v[96:97], v[20:21]
    v_pk_mul_f32 v[98:99], v[98:99], v[22:23]
    v_pk_mul_f32 v[100:101], v[100:101], v[24:25]
    v_pk_mul_f32 v[102:103], v[102:103], v[26:27]
    v_pk_mul_f32 v[104:105], v[104:105], v[12:13]
    v_pk_mul_f32 v[106:107], v[106:107], v[14:15]
    v_pk_mul_f32 v[108:109], v[108:109], v[4:5]
    v_pk_mul_f32 v[110:111], v[110:111], v[6:7]
    v_cvt_pk_bf16_f32 v112, v96, v97
    v_cvt_pk_bf16_f32 v113, v98, v99
    v_cvt_pk_bf16_f32 v116, v100, v101
    v_cvt_pk_bf16_f32 v117, v102, v103
    v_cvt_pk_bf16_f32 v120, v104, v105
    v_cvt_pk_bf16_f32 v121, v106, v107
    v_cvt_pk_bf16_f32 v124, v108, v109
    v_cvt_pk_bf16_f32 v125, v110, v111
    s_waitcnt lgkmcnt(0)
    v_mfma_f32_16x16x32_bf16 v[224:227], a[48:51], a[80:83], v[224:227]
    ds_read_b64_tr_b16 a[144:145], v9 offset:33920
    ds_read_b64_tr_b16 a[146:147], v9 offset:35968
    v_mfma_f32_16x16x32_bf16 v[240:243], a[52:55], a[80:83], v[240:243]
    ds_read_b64_tr_b16 a[148:149], v9 offset:34944
    ds_read_b64_tr_b16 a[150:151], v9 offset:36992
    v_pk_mul_f32 v[20:21], v[128:129], s[10:11]
    v_pk_mul_f32 v[22:23], v[130:131], s[10:11]
    v_pk_mul_f32 v[24:25], v[132:133], s[10:11]
    v_pk_mul_f32 v[26:27], v[134:135], s[10:11]
    v_pk_mul_f32 v[12:13], v[136:137], s[10:11]
    v_pk_mul_f32 v[14:15], v[138:139], s[10:11]
    v_pk_mul_f32 v[4:5], v[140:141], s[10:11]
    v_pk_mul_f32 v[6:7], v[142:143], s[10:11]
    v_mfma_f32_16x16x32_bf16 v[244:247], a[52:55], a[84:87], v[244:247]
    ds_read_b64_tr_b16 a[152:153], v9 offset:50816
    ds_read_b64_tr_b16 a[154:155], v9 offset:52864
    v_mfma_f32_16x16x32_bf16 v[228:231], a[48:51], a[84:87], v[228:231]
    ds_read_b64_tr_b16 a[156:157], v9 offset:51840
    ds_read_b64_tr_b16 a[158:159], v9 offset:53888
    v_mfma_f32_16x16x32_bf16 v[232:235], a[48:51], a[88:91], v[232:235]
    v_exp_f32 v20, v20
    v_exp_f32 v21, v21
    v_mfma_f32_16x16x32_bf16 v[248:251], a[52:55], a[88:91], v[248:251]
    v_exp_f32 v22, v22
    v_exp_f32 v23, v23
    v_mfma_f32_16x16x32_bf16 v[252:255], a[52:55], a[92:95], v[252:255]
    v_exp_f32 v24, v24
    v_exp_f32 v25, v25
    v_mfma_f32_16x16x32_bf16 v[236:239], a[48:51], a[92:95], v[236:239]
    v_exp_f32 v26, v26
    v_mfma_f32_16x16x32_bf16 v[160:163], a[128:131], a[96:99], v[160:163]
    v_exp_f32 v27, v27
    v_exp_f32 v12, v12
    v_mfma_f32_16x16x32_bf16 v[176:179], a[132:135], a[96:99], v[176:179]
    v_exp_f32 v13, v13
    v_exp_f32 v14, v14
    v_mfma_f32_16x16x32_bf16 v[180:183], a[132:135], a[100:103], v[180:183]
    v_exp_f32 v15, v15
    v_exp_f32 v4, v4
    v_mfma_f32_16x16x32_bf16 v[164:167], a[128:131], a[100:103], v[164:167]
    v_exp_f32 v5, v5
    v_exp_f32 v6, v6
    v_mfma_f32_16x16x32_bf16 v[168:171], a[128:131], a[104:107], v[168:171]
    v_exp_f32 v7, v7
    v_pk_mul_f32 v[128:129], v[128:129], v[144:145]
    v_pk_mul_f32 v[130:131], v[130:131], v[146:147]
    v_pk_add_f32 v[20:21], v[20:21], s[8:9]
    v_pk_add_f32 v[22:23], v[22:23], s[8:9]
    v_pk_mul_f32 v[132:133], v[132:133], v[148:149]
    v_pk_mul_f32 v[134:135], v[134:135], v[150:151]
    v_pk_add_f32 v[24:25], v[24:25], s[8:9]
    v_pk_add_f32 v[26:27], v[26:27], s[8:9]
    v_pk_mul_f32 v[136:137], v[136:137], v[152:153]
    v_pk_mul_f32 v[138:139], v[138:139], v[154:155]
    v_pk_add_f32 v[12:13], v[12:13], s[8:9]
    v_pk_add_f32 v[14:15], v[14:15], s[8:9]
    v_pk_mul_f32 v[140:141], v[140:141], v[156:157]
    v_pk_mul_f32 v[142:143], v[142:143], v[158:159]
    v_pk_add_f32 v[4:5], v[4:5], s[8:9]
    v_pk_add_f32 v[6:7], v[6:7], s[8:9]
    v_mfma_f32_16x16x32_bf16 v[184:187], a[132:135], a[104:107], v[184:187]
    v_rcp_f32 v20, v20
    v_rcp_f32 v21, v21
    v_mfma_f32_16x16x32_bf16 v[188:191], a[132:135], a[108:111], v[188:191]
    v_rcp_f32 v22, v22
    v_mfma_f32_16x16x32_bf16 v[172:175], a[128:131], a[108:111], v[172:175]
    v_rcp_f32 v23, v23
    v_rcp_f32 v24, v24
    v_mfma_f32_16x16x32_bf16 v[160:163], a[136:139], a[112:115], v[160:163]
    v_rcp_f32 v25, v25
    v_mfma_f32_16x16x32_bf16 v[176:179], a[140:143], a[112:115], v[176:179]
    v_rcp_f32 v26, v26
    v_rcp_f32 v27, v27
    v_mfma_f32_16x16x32_bf16 v[180:183], a[140:143], a[116:119], v[180:183]
    v_rcp_f32 v12, v12
    v_mfma_f32_16x16x32_bf16 v[164:167], a[136:139], a[116:119], v[164:167]
    v_rcp_f32 v13, v13
    v_rcp_f32 v14, v14
    v_mfma_f32_16x16x32_bf16 v[168:171], a[136:139], a[120:123], v[168:171]
    v_rcp_f32 v15, v15
    v_mfma_f32_16x16x32_bf16 v[184:187], a[140:143], a[120:123], v[184:187]
    v_rcp_f32 v4, v4
    v_rcp_f32 v5, v5
    v_mfma_f32_16x16x32_bf16 v[188:191], a[140:143], a[124:127], v[188:191]
    v_rcp_f32 v6, v6
    v_mfma_f32_16x16x32_bf16 v[172:175], a[136:139], a[124:127], v[172:175]
    v_rcp_f32 v7, v7
    v_pk_mul_f32 v[128:129], v[128:129], v[20:21]
    v_pk_mul_f32 v[130:131], v[130:131], v[22:23]
    v_pk_mul_f32 v[132:133], v[132:133], v[24:25]
    v_pk_mul_f32 v[134:135], v[134:135], v[26:27]
    v_pk_mul_f32 v[136:137], v[136:137], v[12:13]
    v_pk_mul_f32 v[138:139], v[138:139], v[14:15]
    v_pk_mul_f32 v[140:141], v[140:141], v[4:5]
    v_pk_mul_f32 v[142:143], v[142:143], v[6:7]
    v_cvt_pk_bf16_f32 v114, v128, v129
    v_cvt_pk_bf16_f32 v115, v130, v131
    buffer_store_dwordx4 v[112:115], v16, s[48:51], s13 offen offset:0 sc1
    v_cvt_pk_bf16_f32 v118, v132, v133
    v_cvt_pk_bf16_f32 v119, v134, v135
    buffer_store_dwordx4 v[116:119], v16, s[48:51], s13 offen offset:1024 sc1
    v_cvt_pk_bf16_f32 v122, v136, v137
    v_cvt_pk_bf16_f32 v123, v138, v139
    buffer_store_dwordx4 v[120:123], v16, s[48:51], s13 offen offset:2048 sc1
    v_cvt_pk_bf16_f32 v126, v140, v141
    v_cvt_pk_bf16_f32 v127, v142, v143
    buffer_store_dwordx4 v[124:127], v16, s[48:51], s13 offen offset:3072 sc1
    s_waitcnt lgkmcnt(0)
    v_mfma_f32_16x16x32_bf16 v[192:195], a[144:147], a[96:99], v[192:195]
    ds_read_b64_tr_b16 a[128:129], v10 offset:33920
    ds_read_b64_tr_b16 a[130:131], v10 offset:35968
    v_mfma_f32_16x16x32_bf16 v[208:211], a[148:151], a[96:99], v[208:211]
    ds_read_b64_tr_b16 a[132:133], v10 offset:34944
    ds_read_b64_tr_b16 a[134:135], v10 offset:36992
    v_pk_mul_f32 v[20:21], v[160:161], s[10:11]
    v_pk_mul_f32 v[22:23], v[162:163], s[10:11]
    v_pk_mul_f32 v[24:25], v[164:165], s[10:11]
    v_pk_mul_f32 v[26:27], v[166:167], s[10:11]
    v_pk_mul_f32 v[12:13], v[168:169], s[10:11]
    v_pk_mul_f32 v[14:15], v[170:171], s[10:11]
    v_pk_mul_f32 v[4:5], v[172:173], s[10:11]
    v_pk_mul_f32 v[6:7], v[174:175], s[10:11]
    v_mfma_f32_16x16x32_bf16 v[212:215], a[148:151], a[100:103], v[212:215]
    ds_read_b64_tr_b16 a[136:137], v10 offset:50816
    ds_read_b64_tr_b16 a[138:139], v10 offset:52864
    ds_read_b64_tr_b16 a[140:141], v10 offset:51840
    v_mfma_f32_16x16x32_bf16 v[196:199], a[144:147], a[100:103], v[196:199]
    ds_read_b64_tr_b16 a[142:143], v10 offset:53888
    v_exp_f32 v20, v20
    v_exp_f32 v21, v21
    v_mfma_f32_16x16x32_bf16 v[200:203], a[144:147], a[104:107], v[200:203]
    v_exp_f32 v22, v22
    v_exp_f32 v23, v23
    v_exp_f32 v24, v24
    v_mfma_f32_16x16x32_bf16 v[216:219], a[148:151], a[104:107], v[216:219]
    v_exp_f32 v25, v25
    v_exp_f32 v26, v26
    v_exp_f32 v27, v27
    v_mfma_f32_16x16x32_bf16 v[220:223], a[148:151], a[108:111], v[220:223]
    v_exp_f32 v12, v12
    v_exp_f32 v13, v13
    v_exp_f32 v14, v14
    v_mfma_f32_16x16x32_bf16 v[204:207], a[144:147], a[108:111], v[204:207]
    v_exp_f32 v15, v15
    v_exp_f32 v4, v4
    v_exp_f32 v5, v5
    v_mfma_f32_16x16x32_bf16 v[192:195], a[152:155], a[112:115], v[192:195]
    v_exp_f32 v6, v6
    v_exp_f32 v7, v7
    v_pk_mul_f32 v[160:161], v[160:161], v[176:177]
    v_pk_mul_f32 v[162:163], v[162:163], v[178:179]
    v_pk_add_f32 v[20:21], v[20:21], s[8:9]
    v_pk_add_f32 v[22:23], v[22:23], s[8:9]
    v_pk_mul_f32 v[164:165], v[164:165], v[180:181]
    v_pk_mul_f32 v[166:167], v[166:167], v[182:183]
    v_pk_add_f32 v[24:25], v[24:25], s[8:9]
    v_pk_add_f32 v[26:27], v[26:27], s[8:9]
    v_pk_mul_f32 v[168:169], v[168:169], v[184:185]
    v_pk_mul_f32 v[170:171], v[170:171], v[186:187]
    v_pk_add_f32 v[12:13], v[12:13], s[8:9]
    v_pk_add_f32 v[14:15], v[14:15], s[8:9]
    v_pk_mul_f32 v[172:173], v[172:173], v[188:189]
    v_pk_mul_f32 v[174:175], v[174:175], v[190:191]
    v_pk_add_f32 v[4:5], v[4:5], s[8:9]
    v_pk_add_f32 v[6:7], v[6:7], s[8:9]
    v_mfma_f32_16x16x32_bf16 v[208:211], a[156:159], a[112:115], v[208:211]
    v_rcp_f32 v20, v20
    v_rcp_f32 v21, v21
    v_rcp_f32 v22, v22
    v_mfma_f32_16x16x32_bf16 v[212:215], a[156:159], a[116:119], v[212:215]
    v_rcp_f32 v23, v23
    v_rcp_f32 v24, v24
    v_mfma_f32_16x16x32_bf16 v[196:199], a[152:155], a[116:119], v[196:199]
    v_rcp_f32 v25, v25
    v_rcp_f32 v26, v26
    v_mfma_f32_16x16x32_bf16 v[200:203], a[152:155], a[120:123], v[200:203]
    v_rcp_f32 v27, v27
    v_rcp_f32 v12, v12
    v_rcp_f32 v13, v13
    v_mfma_f32_16x16x32_bf16 v[216:219], a[156:159], a[120:123], v[216:219]
    v_rcp_f32 v14, v14
    v_rcp_f32 v15, v15
    v_mfma_f32_16x16x32_bf16 v[220:223], a[156:159], a[124:127], v[220:223]
    v_rcp_f32 v4, v4
    v_rcp_f32 v5, v5
    v_mfma_f32_16x16x32_bf16 v[204:207], a[152:155], a[124:127], v[204:207]
    v_rcp_f32 v6, v6
    v_rcp_f32 v7, v7
    v_pk_mul_f32 v[160:161], v[160:161], v[20:21]
    v_pk_mul_f32 v[162:163], v[162:163], v[22:23]
    v_pk_mul_f32 v[164:165], v[164:165], v[24:25]
    v_pk_mul_f32 v[166:167], v[166:167], v[26:27]
    v_pk_mul_f32 v[168:169], v[168:169], v[12:13]
    v_pk_mul_f32 v[170:171], v[170:171], v[14:15]
    v_pk_mul_f32 v[172:173], v[172:173], v[4:5]
    v_pk_mul_f32 v[174:175], v[174:175], v[6:7]
    v_cvt_pk_bf16_f32 v176, v160, v161
    v_cvt_pk_bf16_f32 v177, v162, v163
    v_cvt_pk_bf16_f32 v180, v164, v165
    v_cvt_pk_bf16_f32 v181, v166, v167
    v_cvt_pk_bf16_f32 v184, v168, v169
    v_cvt_pk_bf16_f32 v185, v170, v171
    v_cvt_pk_bf16_f32 v188, v172, v173
    v_cvt_pk_bf16_f32 v189, v174, v175
    s_waitcnt lgkmcnt(0)
    s_barrier
    v_mfma_f32_16x16x32_bf16 v[224:227], a[128:131], a[96:99], v[224:227]
    v_mfma_f32_16x16x32_bf16 v[240:243], a[132:135], a[96:99], v[240:243]
    v_pk_mul_f32 v[20:21], v[192:193], s[10:11]
    v_pk_mul_f32 v[22:23], v[194:195], s[10:11]
    v_pk_mul_f32 v[24:25], v[196:197], s[10:11]
    v_pk_mul_f32 v[26:27], v[198:199], s[10:11]
    v_pk_mul_f32 v[12:13], v[200:201], s[10:11]
    v_pk_mul_f32 v[14:15], v[202:203], s[10:11]
    v_pk_mul_f32 v[4:5], v[204:205], s[10:11]
    v_pk_mul_f32 v[6:7], v[206:207], s[10:11]
    v_mfma_f32_16x16x32_bf16 v[244:247], a[132:135], a[100:103], v[244:247]
    v_exp_f32 v20, v20
    v_exp_f32 v21, v21
    v_exp_f32 v22, v22
    v_mfma_f32_16x16x32_bf16 v[228:231], a[128:131], a[100:103], v[228:231]
    v_exp_f32 v23, v23
    v_exp_f32 v24, v24
    v_mfma_f32_16x16x32_bf16 v[232:235], a[128:131], a[104:107], v[232:235]
    v_exp_f32 v25, v25
    v_exp_f32 v26, v26
    v_mfma_f32_16x16x32_bf16 v[248:251], a[132:135], a[104:107], v[248:251]
    v_exp_f32 v27, v27
    v_exp_f32 v12, v12
    v_exp_f32 v13, v13
    v_mfma_f32_16x16x32_bf16 v[252:255], a[132:135], a[108:111], v[252:255]
    v_exp_f32 v14, v14
    v_exp_f32 v15, v15
    v_mfma_f32_16x16x32_bf16 v[236:239], a[128:131], a[108:111], v[236:239]
    v_exp_f32 v4, v4
    v_exp_f32 v5, v5
    v_mfma_f32_16x16x32_bf16 v[224:227], a[136:139], a[112:115], v[224:227]
    v_exp_f32 v6, v6
    v_exp_f32 v7, v7
    v_pk_mul_f32 v[192:193], v[192:193], v[208:209]
    v_pk_mul_f32 v[194:195], v[194:195], v[210:211]
    v_pk_add_f32 v[20:21], v[20:21], s[8:9]
    v_pk_add_f32 v[22:23], v[22:23], s[8:9]
    v_pk_mul_f32 v[196:197], v[196:197], v[212:213]
    v_pk_mul_f32 v[198:199], v[198:199], v[214:215]
    v_pk_add_f32 v[24:25], v[24:25], s[8:9]
    v_pk_add_f32 v[26:27], v[26:27], s[8:9]
    v_pk_mul_f32 v[200:201], v[200:201], v[216:217]
    v_pk_mul_f32 v[202:203], v[202:203], v[218:219]
    v_pk_add_f32 v[12:13], v[12:13], s[8:9]
    v_pk_add_f32 v[14:15], v[14:15], s[8:9]
    v_pk_mul_f32 v[204:205], v[204:205], v[220:221]
    v_pk_mul_f32 v[206:207], v[206:207], v[222:223]
    v_pk_add_f32 v[4:5], v[4:5], s[8:9]
    v_pk_add_f32 v[6:7], v[6:7], s[8:9]
    v_mfma_f32_16x16x32_bf16 v[240:243], a[140:143], a[112:115], v[240:243]
    v_rcp_f32 v20, v20
    v_rcp_f32 v21, v21
    v_rcp_f32 v22, v22
    v_mfma_f32_16x16x32_bf16 v[244:247], a[140:143], a[116:119], v[244:247]
    v_rcp_f32 v23, v23
    v_rcp_f32 v24, v24
    v_mfma_f32_16x16x32_bf16 v[228:231], a[136:139], a[116:119], v[228:231]
    v_rcp_f32 v25, v25
    v_rcp_f32 v26, v26
    v_mfma_f32_16x16x32_bf16 v[232:235], a[136:139], a[120:123], v[232:235]
    v_rcp_f32 v27, v27
    v_rcp_f32 v12, v12
    v_rcp_f32 v13, v13
    v_mfma_f32_16x16x32_bf16 v[248:251], a[140:143], a[120:123], v[248:251]
    v_rcp_f32 v14, v14
    v_rcp_f32 v15, v15
    v_mfma_f32_16x16x32_bf16 v[252:255], a[140:143], a[124:127], v[252:255]
    v_rcp_f32 v4, v4
    v_rcp_f32 v5, v5
    v_mfma_f32_16x16x32_bf16 v[236:239], a[136:139], a[124:127], v[236:239]
    v_rcp_f32 v6, v6
    v_rcp_f32 v7, v7
    v_pk_mul_f32 v[192:193], v[192:193], v[20:21]
    v_pk_mul_f32 v[194:195], v[194:195], v[22:23]
    v_pk_mul_f32 v[196:197], v[196:197], v[24:25]
    v_pk_mul_f32 v[198:199], v[198:199], v[26:27]
    v_pk_mul_f32 v[200:201], v[200:201], v[12:13]
    v_pk_mul_f32 v[202:203], v[202:203], v[14:15]
    v_pk_mul_f32 v[204:205], v[204:205], v[4:5]
    v_pk_mul_f32 v[206:207], v[206:207], v[6:7]
    v_cvt_pk_bf16_f32 v178, v192, v193
    v_cvt_pk_bf16_f32 v179, v194, v195
    buffer_store_dwordx4 v[176:179], v16, s[48:51], s14 offen offset:0 sc1
    v_cvt_pk_bf16_f32 v182, v196, v197
    v_cvt_pk_bf16_f32 v183, v198, v199
    buffer_store_dwordx4 v[180:183], v16, s[48:51], s14 offen offset:1024 sc1
    v_cvt_pk_bf16_f32 v186, v200, v201
    v_cvt_pk_bf16_f32 v187, v202, v203
    buffer_store_dwordx4 v[184:187], v16, s[48:51], s14 offen offset:2048 sc1
    v_cvt_pk_bf16_f32 v190, v204, v205
    v_cvt_pk_bf16_f32 v191, v206, v207
    buffer_store_dwordx4 v[188:191], v16, s[48:51], s14 offen offset:3072 sc1
    s_waitcnt lgkmcnt(0)
    s_nop 7
    v_pk_mul_f32 v[20:21], v[224:225], s[10:11]
    v_pk_mul_f32 v[22:23], v[226:227], s[10:11]
    v_pk_mul_f32 v[24:25], v[228:229], s[10:11]
    v_pk_mul_f32 v[26:27], v[230:231], s[10:11]
    v_pk_mul_f32 v[12:13], v[232:233], s[10:11]
    v_pk_mul_f32 v[14:15], v[234:235], s[10:11]
    v_pk_mul_f32 v[4:5], v[236:237], s[10:11]
    v_pk_mul_f32 v[6:7], v[238:239], s[10:11]
    v_exp_f32 v20, v20
    v_exp_f32 v21, v21
    v_exp_f32 v22, v22
    v_exp_f32 v23, v23
    v_exp_f32 v24, v24
    v_exp_f32 v25, v25
    v_exp_f32 v26, v26
    v_exp_f32 v27, v27
    v_exp_f32 v12, v12
    v_exp_f32 v13, v13
    v_exp_f32 v14, v14
    v_exp_f32 v15, v15
    v_exp_f32 v4, v4
    v_exp_f32 v5, v5
    v_exp_f32 v6, v6
    v_exp_f32 v7, v7
    v_pk_mul_f32 v[224:225], v[224:225], v[240:241]
    v_pk_mul_f32 v[226:227], v[226:227], v[242:243]
    v_pk_add_f32 v[20:21], v[20:21], s[8:9]
    v_pk_add_f32 v[22:23], v[22:23], s[8:9]
    v_pk_mul_f32 v[228:229], v[228:229], v[244:245]
    v_pk_mul_f32 v[230:231], v[230:231], v[246:247]
    v_pk_add_f32 v[24:25], v[24:25], s[8:9]
    v_pk_add_f32 v[26:27], v[26:27], s[8:9]
    v_pk_mul_f32 v[232:233], v[232:233], v[248:249]
    v_pk_mul_f32 v[234:235], v[234:235], v[250:251]
    v_pk_add_f32 v[12:13], v[12:13], s[8:9]
    v_pk_add_f32 v[14:15], v[14:15], s[8:9]
    v_pk_mul_f32 v[236:237], v[236:237], v[252:253]
    v_pk_mul_f32 v[238:239], v[238:239], v[254:255]
    v_pk_add_f32 v[4:5], v[4:5], s[8:9]
    v_pk_add_f32 v[6:7], v[6:7], s[8:9]
    v_rcp_f32 v20, v20
    v_rcp_f32 v21, v21
    v_rcp_f32 v22, v22
    v_rcp_f32 v23, v23
    v_rcp_f32 v24, v24
    v_rcp_f32 v25, v25
    v_rcp_f32 v26, v26
    v_rcp_f32 v27, v27
    v_rcp_f32 v12, v12
    v_rcp_f32 v13, v13
    v_rcp_f32 v14, v14
    v_rcp_f32 v15, v15
    v_rcp_f32 v4, v4
    v_rcp_f32 v5, v5
    v_rcp_f32 v6, v6
    v_rcp_f32 v7, v7
    v_pk_mul_f32 v[224:225], v[224:225], v[20:21]
    v_pk_mul_f32 v[226:227], v[226:227], v[22:23]
    v_pk_mul_f32 v[228:229], v[228:229], v[24:25]
    v_pk_mul_f32 v[230:231], v[230:231], v[26:27]
    v_pk_mul_f32 v[232:233], v[232:233], v[12:13]
    v_pk_mul_f32 v[234:235], v[234:235], v[14:15]
    v_pk_mul_f32 v[236:237], v[236:237], v[4:5]
    v_pk_mul_f32 v[238:239], v[238:239], v[6:7]
    v_cvt_pk_bf16_f32 v240, v224, v225
    v_cvt_pk_bf16_f32 v241, v226, v227
    buffer_store_dwordx2 v[240:241], v17, s[48:51], s15 offen offset:0 sc1
    v_cvt_pk_bf16_f32 v244, v228, v229
    v_cvt_pk_bf16_f32 v245, v230, v231
    buffer_store_dwordx2 v[244:245], v17, s[48:51], s15 offen offset:1024 sc1
    v_cvt_pk_bf16_f32 v248, v232, v233
    v_cvt_pk_bf16_f32 v249, v234, v235
    buffer_store_dwordx2 v[248:249], v17, s[48:51], s15 offen offset:2048 sc1
    v_cvt_pk_bf16_f32 v252, v236, v237
    v_cvt_pk_bf16_f32 v253, v238, v239
    buffer_store_dwordx2 v[252:253], v17, s[48:51], s15 offen offset:3072 sc1
    s_and_b32 s56, s40, 1
    s_lshl_b32 s61, s56, 2
    s_add_u32 s61, s61, s3
    s_lshl_b32 s61, s61, 10
    v_add_u32 v4, s61, v2
    s_xor_b32 s61, s61, 4096
    v_add_u32 v5, s61, v2
    v_lshlrev_b32 v3, 3, v1
    v_sub_u32 v6, v4, v3
    v_sub_u32 v7, v5, v3
    v_lshrrev_b32 v12, 4, v1
    v_and_b32 v13, 15, v1
    v_lshlrev_b32 v14, 2, v12
    v_xor_b32 v13, v13, v14
    s_and_b32 s61, s3, 1
    s_lshl_b32 s61, s61, 15
    v_lshlrev_b32 v14, 11, v12
    v_add_u32 v14, s61, v14
    v_lshl_add_u32 v8, v13, 4, v14
    v_xor_b32 v13, 1, v13
    v_lshl_add_u32 v9, v13, 4, v14
    v_add_u32 v10, 14336, v8
    v_add_u32 v11, 21504, v9
    v_add_u32 v9, 7168, v9
    s_lshl_b32 s52, s3, 12
    s_and_b32 s58, s7, 7
    s_lshr_b32 s58, s58, 0
    s_lshr_b32 s59, s7, 3
    s_add_u32 s58, s58, s59
    s_lshl_b32 s59, s56, 3
    s_add_u32 s61, s58, 0
    s_and_b32 s61, s61, 3
    s_add_u32 s60, s61, s59
    s_mul_i32 s64, s60, 917504
    s_add_u32 s68, s64, 3670016
    s_lshl_b32 s61, s61, 1
    s_add_u32 s61, s61, s59
    s_mul_i32 s61, s61, 917504
    s_add_u32 s72, s61, 393216
    s_add_u32 s61, s58, 1
    s_and_b32 s61, s61, 3
    s_add_u32 s60, s61, s59
    s_mul_i32 s65, s60, 917504
    s_add_u32 s69, s65, 3670016
    s_lshl_b32 s61, s61, 1
    s_add_u32 s61, s61, s59
    s_mul_i32 s61, s61, 917504
    s_add_u32 s73, s61, 393216
    s_add_u32 s61, s58, 2
    s_and_b32 s61, s61, 3
    s_add_u32 s60, s61, s59
    s_mul_i32 s66, s60, 917504
    s_add_u32 s70, s66, 3670016
    s_lshl_b32 s61, s61, 1
    s_add_u32 s61, s61, s59
    s_mul_i32 s61, s61, 917504
    s_add_u32 s74, s61, 393216
    s_add_u32 s61, s58, 3
    s_and_b32 s61, s61, 3
    s_add_u32 s60, s61, s59
    s_mul_i32 s67, s60, 917504
    s_add_u32 s71, s67, 3670016
    s_lshl_b32 s61, s61, 1
    s_add_u32 s61, s61, s59
    s_mul_i32 s61, s61, 917504
    s_add_u32 s75, s61, 393216
    s_lshr_b32 s55, s3, 1
    s_lshr_b32 s61, s40, 1
    s_lshl_b32 s61, s61, 13
    s_sub_u32 s53, 14680064, s61
    s_add_u32 s61, s61, 33554432
    s_add_u32 s32, s4, s61
    s_addc_u32 s33, s5, 0
    s_and_b32 s33, s33, 0xffff
    s_mov_b32 s34, s53
    s_mov_b32 s35, 0x20000
    s_lshl_b32 s61, s41, 8
    s_sub_u32 s53, 7340032, s61
    s_add_u32 s36, s78, s61
    s_addc_u32 s37, s79, 0
    s_and_b32 s37, s37, 0xffff
    s_mov_b32 s38, s53
    s_mov_b32 s39, 0x20000
    s_mul_i32 s76, s55, 917504
    s_lshl_b32 s77, s55, 17
    s_lshl_b32 s20, s42, 2
    s_and_b32 s21, s43, 3
    s_add_u32 s20, s20, s21
    s_add_u32 s20, s20, 64
    s_waitcnt vmcnt(0) lgkmcnt(0)
    s_barrier
    s_cmp_lg_u32 s3, 0
    s_cbranch_scc1 arr_adaLN_cond__linear_kernel_hedgehog__glu_gated_swiglu__prompt_kernel_44
    s_lshl_b32 s96, s20, 8
    v_mov_b32 v28, 1
    v_mov_b32 v29, 0
    s_mov_b64 exec, 1
    buffer_atomic_add v28, v29, s[92:95], s96 offen sc1
    s_mov_b64 exec, -1
arr_adaLN_cond__linear_kernel_hedgehog__glu_gated_swiglu__prompt_kernel_44:
    s_add_u32 s54, s72, s76
    s_lshr_b32 s54, s54, 1
    s_add_u32 m0, s52, 0
    s_nop 0
    buffer_load_dwordx4 v8, s[36:39], s54 offen offset:0 lds
    buffer_load_dwordx4 v9, s[36:39], s54 offen offset:1024 lds
    buffer_load_dwordx4 v10, s[36:39], s54 offen offset:2048 lds
    buffer_load_dwordx4 v11, s[36:39], s54 offen offset:3072 lds
    s_add_u32 s54, s73, s76
    s_lshr_b32 s54, s54, 1
    s_add_u32 m0, s52, 16384
    s_nop 0
    buffer_load_dwordx4 v8, s[36:39], s54 offen offset:0 lds
    buffer_load_dwordx4 v9, s[36:39], s54 offen offset:1024 lds
    buffer_load_dwordx4 v10, s[36:39], s54 offen offset:2048 lds
    buffer_load_dwordx4 v11, s[36:39], s54 offen offset:3072 lds
    s_add_u32 s54, s74, s76
    s_lshr_b32 s54, s54, 1
    s_add_u32 m0, s52, 32768
    s_nop 0
    buffer_load_dwordx4 v8, s[36:39], s54 offen offset:0 lds
    buffer_load_dwordx4 v9, s[36:39], s54 offen offset:1024 lds
    buffer_load_dwordx4 v10, s[36:39], s54 offen offset:2048 lds
    buffer_load_dwordx4 v11, s[36:39], s54 offen offset:3072 lds
    s_and_b32 s20, s40, 28
    s_add_u32 s20, s20, 64
    s_add_u32 s54, s75, s76
    s_lshr_b32 s54, s54, 1
    s_add_u32 m0, s52, 49152
    s_nop 0
    buffer_load_dwordx4 v8, s[36:39], s54 offen offset:0 lds
    buffer_load_dwordx4 v9, s[36:39], s54 offen offset:1024 lds
    buffer_load_dwordx4 v10, s[36:39], s54 offen offset:2048 lds
    buffer_load_dwordx4 v11, s[36:39], s54 offen offset:3072 lds
    s_add_u32 s54, s64, s77
    s_lshr_b32 s54, s54, 1
    s_add_u32 m0, s52, 65536
    s_nop 0
    buffer_load_dwordx4 v8, s[36:39], s54 offen offset:0 lds
    buffer_load_dwordx4 v9, s[36:39], s54 offen offset:1024 lds
    buffer_load_dwordx4 v10, s[36:39], s54 offen offset:2048 lds
    buffer_load_dwordx4 v11, s[36:39], s54 offen offset:3072 lds
    s_add_u32 s54, s65, s77
    s_lshr_b32 s54, s54, 1
    s_add_u32 m0, s52, 81920
    s_nop 0
    buffer_load_dwordx4 v8, s[36:39], s54 offen offset:0 lds
    buffer_load_dwordx4 v9, s[36:39], s54 offen offset:1024 lds
    buffer_load_dwordx4 v10, s[36:39], s54 offen offset:2048 lds
    buffer_load_dwordx4 v11, s[36:39], s54 offen offset:3072 lds
    v_lshrrev_b32 v12, 4, v1
    v_bfe_u32 v13, v1, 2, 2
    v_and_b32 v14, 3, v1
    v_and_b32 v15, 1, v12
    v_xor_b32 v15, v15, v14
    v_lshlrev_b32 v15, 4, v15
    v_lshl_add_u32 v15, v12, 10, v15
    v_lshl_add_u32 v15, v13, 8, v15
    v_and_b32 v14, 1, v14
    v_lshl_add_u32 v15, v14, 3, v15
    v_xor_b32 v14, 0, v13
    v_lshl_add_u32 v32, v14, 6, v15
    v_xor_b32 v33, 8, v32
    v_xor_b32 v14, 1, v13
    v_lshl_add_u32 v34, v14, 6, v15
    v_xor_b32 v35, 8, v34
    v_xor_b32 v14, 2, v13
    v_lshl_add_u32 v36, v14, 6, v15
    v_xor_b32 v37, 8, v36
    v_xor_b32 v14, 3, v13
    v_lshl_add_u32 v38, v14, 6, v15
    v_xor_b32 v39, 8, v38
    v_add_u32 v40, 0x10000, v32
    v_add_u32 v41, 0x10000, v33
    v_add_u32 v42, 0x10000, v34
    v_add_u32 v43, 0x10000, v35
    v_add_u32 v44, 0x10000, v36
    v_add_u32 v45, 0x10000, v37
    v_add_u32 v46, 0x10000, v38
    v_add_u32 v47, 0x10000, v39
    v_and_b32 v21, 15, v1
    s_lshl_b32 s12, s3, 4
    v_add_u32 v21, s12, v21
    v_lshlrev_b32 v23, 11, v21
    v_lshl_add_u32 v23, v12, 4, v23
    v_lshlrev_b32 v22, 5, v12
    v_add_u32 v22, 155648, v22
    ds_read_b128 v[192:195], v22 offset:1536
    ds_read_b128 v[196:199], v22 offset:1552
    ds_read_b128 v[200:203], v22 offset:1664
    ds_read_b128 v[204:207], v22 offset:1680
    ds_read_b128 v[208:211], v22 offset:1792
    ds_read_b128 v[212:215], v22 offset:1808
    ds_read_b128 v[216:219], v22 offset:1920
    ds_read_b128 v[220:223], v22 offset:1936
    v_accvgpr_read_b32 v96, a240
    v_accvgpr_read_b32 v97, a241
    v_accvgpr_read_b32 v98, a242
    v_accvgpr_read_b32 v99, a243
    v_accvgpr_read_b32 v100, a244
    v_accvgpr_read_b32 v101, a245
    v_accvgpr_read_b32 v102, a246
    v_accvgpr_read_b32 v103, a247
    v_accvgpr_read_b32 v104, a248
    v_accvgpr_read_b32 v105, a249
    v_accvgpr_read_b32 v106, a250
    v_accvgpr_read_b32 v107, a251
    v_accvgpr_read_b32 v108, a252
    v_accvgpr_read_b32 v109, a253
    v_accvgpr_read_b32 v110, a254
    v_accvgpr_read_b32 v111, a255
    v_lshlrev_b32 v64, 16, v96
    v_and_b32 v65, 0xffff0000, v96
    v_lshlrev_b32 v66, 16, v97
    v_and_b32 v67, 0xffff0000, v97
    v_lshlrev_b32 v68, 16, v98
    v_and_b32 v69, 0xffff0000, v98
    v_lshlrev_b32 v70, 16, v99
    v_and_b32 v71, 0xffff0000, v99
    v_lshlrev_b32 v72, 16, v100
    v_and_b32 v73, 0xffff0000, v100
    v_lshlrev_b32 v74, 16, v101
    v_and_b32 v75, 0xffff0000, v101
    v_lshlrev_b32 v76, 16, v102
    v_and_b32 v77, 0xffff0000, v102
    v_lshlrev_b32 v78, 16, v103
    v_and_b32 v79, 0xffff0000, v103
    v_lshlrev_b32 v80, 16, v104
    v_and_b32 v81, 0xffff0000, v104
    v_lshlrev_b32 v82, 16, v105
    v_and_b32 v83, 0xffff0000, v105
    v_lshlrev_b32 v84, 16, v106
    v_and_b32 v85, 0xffff0000, v106
    v_lshlrev_b32 v86, 16, v107
    v_and_b32 v87, 0xffff0000, v107
    v_lshlrev_b32 v88, 16, v108
    v_and_b32 v89, 0xffff0000, v108
    v_lshlrev_b32 v90, 16, v109
    v_and_b32 v91, 0xffff0000, v109
    v_lshlrev_b32 v92, 16, v110
    v_and_b32 v93, 0xffff0000, v110
    v_lshlrev_b32 v94, 16, v111
    v_and_b32 v95, 0xffff0000, v111
    s_lshl_b32 s12, s40, 17
    s_lshl_b32 s13, s41, 8
    s_add_u32 s12, s12, s13
    s_sub_u32 s13, 4194304, s12
    s_add_u32 s16, s84, s12
    s_addc_u32 s17, s85, 0
    s_and_b32 s17, s17, 0xffff
    s_mov_b32 s18, s13
    s_mov_b32 s19, 0x20000
    s_add_u32 s24, s4, 50331648
    s_addc_u32 s25, s5, 0
    s_and_b32 s25, s25, 0xffff
    s_mov_b32 s26, 4194304
    s_mov_b32 s27, 0x20000
    s_lshl_b32 s12, s40, 3
    s_add_u32 s12, s12, s41
    s_lshl_b32 s12, s12, 14
    s_lshl_b32 s13, s3, 12
    s_add_u32 s12, s12, s13
    s_xor_b32 s13, s12, 0x20000
    s_mov_b32 s44, s72
    s_add_u32 s45, s72, 917504
    s_mov_b32 s46, s73
    s_add_u32 s47, s73, 917504
    s_mov_b32 s48, s74
    s_add_u32 s49, s74, 917504
    s_mov_b32 s50, s75
    s_add_u32 s51, s75, 917504
    s_and_b32 s20, s40, 28
    s_add_u32 s20, s20, 64
    s_waitcnt vmcnt(0) lgkmcnt(0)
    s_cmp_lg_u32 s3, 0
    s_cbranch_scc1 wt_adaLN_cond__linear_kernel_hedgehog__glu_gated_swiglu__prompt_kernel_45
    s_lshl_b32 s96, s20, 8
    v_and_b32 v29, 3, v1
    v_lshlrev_b32 v29, 8, v29
    s_mov_b32 s97, 0
    s_mov_b64 exec, 15
poll_adaLN_cond__linear_kernel_hedgehog__glu_gated_swiglu__prompt_kernel_46:
    buffer_load_dword v28, v29, s[92:95], s96 offen sc1
    s_waitcnt vmcnt(0)
    v_cmp_ne_u32 vcc, 8, v28
    s_cbranch_vccz pdone_adaLN_cond__linear_kernel_hedgehog__glu_gated_swiglu__prompt_kernel_47
    s_add_u32 s97, s97, 1
    s_cmp_lt_u32 s97, 100000
    s_cbranch_scc1 poll_adaLN_cond__linear_kernel_hedgehog__glu_gated_swiglu__prompt_kernel_46
pdone_adaLN_cond__linear_kernel_hedgehog__glu_gated_swiglu__prompt_kernel_47:
    s_mov_b64 exec, -1
wt_adaLN_cond__linear_kernel_hedgehog__glu_gated_swiglu__prompt_kernel_45:
    s_barrier
    buffer_load_dwordx2 a[32:33], v6, s[32:35], s44 offen sc1
    buffer_load_dwordx2 a[34:35], v6, s[32:35], s44 offen offset:512 sc1
    buffer_load_dwordx2 a[36:37], v7, s[32:35], s44 offen sc1
    buffer_load_dwordx2 a[38:39], v7, s[32:35], s44 offen offset:512 sc1
    buffer_load_dwordx2 a[40:41], v6, s[32:35], s45 offen sc1
    buffer_load_dwordx2 a[42:43], v6, s[32:35], s45 offen offset:512 sc1
    buffer_load_dwordx2 a[44:45], v7, s[32:35], s45 offen sc1
    buffer_load_dwordx2 a[46:47], v7, s[32:35], s45 offen offset:512 sc1
    buffer_load_dwordx2 a[48:49], v6, s[32:35], s46 offen sc1
    buffer_load_dwordx2 a[50:51], v6, s[32:35], s46 offen offset:512 sc1
    buffer_load_dwordx2 a[52:53], v7, s[32:35], s46 offen sc1
    buffer_load_dwordx2 a[54:55], v7, s[32:35], s46 offen offset:512 sc1
    buffer_load_dwordx2 a[56:57], v6, s[32:35], s47 offen sc1
    buffer_load_dwordx2 a[58:59], v6, s[32:35], s47 offen offset:512 sc1
    buffer_load_dwordx2 a[60:61], v7, s[32:35], s47 offen sc1
    buffer_load_dwordx2 a[62:63], v7, s[32:35], s47 offen offset:512 sc1
    ds_read_b64_tr_b16 a[0:1], v32 offset:0
    ds_read_b64_tr_b16 a[2:3], v32 offset:4096
    ds_read_b64_tr_b16 a[4:5], v33 offset:0
    ds_read_b64_tr_b16 a[6:7], v33 offset:4096
    ds_read_b64_tr_b16 a[8:9], v34 offset:0
    ds_read_b64_tr_b16 a[10:11], v34 offset:4096
    ds_read_b64_tr_b16 a[12:13], v35 offset:0
    ds_read_b64_tr_b16 a[14:15], v35 offset:4096
    ds_read_b64_tr_b16 a[16:17], v36 offset:0
    ds_read_b64_tr_b16 a[18:19], v36 offset:4096
    ds_read_b64_tr_b16 a[20:21], v37 offset:0
    ds_read_b64_tr_b16 a[22:23], v37 offset:4096
    ds_read_b64_tr_b16 a[24:25], v38 offset:0
    ds_read_b64_tr_b16 a[26:27], v38 offset:4096
    ds_read_b64_tr_b16 a[28:29], v39 offset:0
    ds_read_b64_tr_b16 a[30:31], v39 offset:4096
    s_lshl_b32 s60, s55, 18
    s_add_u32 s60, s60, 262144
    s_lshl_b32 s61, s55, 17
    s_add_u32 s61, s61, 655360
    s_mov_b32 s58, 0
    s_mov_b32 s59, 131072
    s_mov_b32 s57, 3
    s_waitcnt vmcnt(12)
    s_waitcnt lgkmcnt(0)
    v_mfma_f32_16x16x32_bf16 v[128:131], a[0:3], a[32:35], 0
    ds_read_b64_tr_b16 a[96:97], v32 offset:8192
    ds_read_b64_tr_b16 a[98:99], v32 offset:12288
    v_mfma_f32_16x16x32_bf16 v[132:135], a[0:3], a[36:39], 0
    ds_read_b64_tr_b16 a[100:101], v33 offset:8192
    ds_read_b64_tr_b16 a[102:103], v33 offset:12288
    v_mfma_f32_16x16x32_bf16 v[140:143], a[4:7], a[36:39], 0
    buffer_load_dwordx2 a[64:65], v6, s[32:35], s48 offen sc1
    buffer_load_dwordx2 a[66:67], v6, s[32:35], s48 offen offset:512 sc1
    v_mfma_f32_16x16x32_bf16 v[136:139], a[4:7], a[32:35], 0
    ds_read_b64_tr_b16 a[104:105], v34 offset:8192
    ds_read_b64_tr_b16 a[106:107], v34 offset:12288
    v_mfma_f32_16x16x32_bf16 v[144:147], a[8:11], a[32:35], 0
    ds_read_b64_tr_b16 a[108:109], v35 offset:8192
    ds_read_b64_tr_b16 a[110:111], v35 offset:12288
    v_mfma_f32_16x16x32_bf16 v[148:151], a[8:11], a[36:39], 0
    buffer_load_dwordx2 a[68:69], v7, s[32:35], s48 offen sc1
    buffer_load_dwordx2 a[70:71], v7, s[32:35], s48 offen offset:512 sc1
    v_mfma_f32_16x16x32_bf16 v[156:159], a[12:15], a[36:39], 0
    ds_read_b64_tr_b16 a[112:113], v36 offset:8192
    ds_read_b64_tr_b16 a[114:115], v36 offset:12288
    v_mfma_f32_16x16x32_bf16 v[152:155], a[12:15], a[32:35], 0
    ds_read_b64_tr_b16 a[116:117], v37 offset:8192
    ds_read_b64_tr_b16 a[118:119], v37 offset:12288
    v_mfma_f32_16x16x32_bf16 v[160:163], a[16:19], a[32:35], 0
    buffer_load_dwordx2 a[72:73], v6, s[32:35], s49 offen sc1
    buffer_load_dwordx2 a[74:75], v6, s[32:35], s49 offen offset:512 sc1
    v_mfma_f32_16x16x32_bf16 v[164:167], a[16:19], a[36:39], 0
    ds_read_b64_tr_b16 a[120:121], v38 offset:8192
    ds_read_b64_tr_b16 a[122:123], v38 offset:12288
    v_mfma_f32_16x16x32_bf16 v[172:175], a[20:23], a[36:39], 0
    ds_read_b64_tr_b16 a[124:125], v39 offset:8192
    ds_read_b64_tr_b16 a[126:127], v39 offset:12288
    v_mfma_f32_16x16x32_bf16 v[168:171], a[20:23], a[32:35], 0
    buffer_load_dwordx2 a[76:77], v7, s[32:35], s49 offen sc1
    buffer_load_dwordx2 a[78:79], v7, s[32:35], s49 offen offset:512 sc1
    v_mfma_f32_16x16x32_bf16 v[176:179], a[24:27], a[32:35], 0
    v_mfma_f32_16x16x32_bf16 v[180:183], a[24:27], a[36:39], 0
    v_mfma_f32_16x16x32_bf16 v[188:191], a[28:31], a[36:39], 0
    v_mfma_f32_16x16x32_bf16 v[184:187], a[28:31], a[32:35], 0
    s_waitcnt vmcnt(8)
    s_barrier
    s_waitcnt lgkmcnt(0)
    v_mfma_f32_16x16x32_bf16 v[128:131], a[96:99], a[40:43], v[128:131]
    ds_read_b64_tr_b16 a[0:1], v32 offset:16384
    ds_read_b64_tr_b16 a[2:3], v32 offset:20480
    v_mfma_f32_16x16x32_bf16 v[132:135], a[96:99], a[44:47], v[132:135]
    ds_read_b64_tr_b16 a[4:5], v33 offset:16384
    ds_read_b64_tr_b16 a[6:7], v33 offset:20480
    v_mfma_f32_16x16x32_bf16 v[140:143], a[100:103], a[44:47], v[140:143]
    s_add_u32 s54, s66, s77
    s_lshr_b32 s54, s54, 1
    v_mfma_f32_16x16x32_bf16 v[136:139], a[100:103], a[40:43], v[136:139]
    ds_read_b64_tr_b16 a[8:9], v34 offset:16384
    ds_read_b64_tr_b16 a[10:11], v34 offset:20480
    v_mfma_f32_16x16x32_bf16 v[144:147], a[104:107], a[40:43], v[144:147]
    ds_read_b64_tr_b16 a[12:13], v35 offset:16384
    ds_read_b64_tr_b16 a[14:15], v35 offset:20480
    v_mfma_f32_16x16x32_bf16 v[148:151], a[104:107], a[44:47], v[148:151]
    s_add_u32 m0, s52, 98304
    v_mfma_f32_16x16x32_bf16 v[156:159], a[108:111], a[44:47], v[156:159]
    ds_read_b64_tr_b16 a[16:17], v36 offset:16384
    ds_read_b64_tr_b16 a[18:19], v36 offset:20480
    v_mfma_f32_16x16x32_bf16 v[152:155], a[108:111], a[40:43], v[152:155]
    ds_read_b64_tr_b16 a[20:21], v37 offset:16384
    ds_read_b64_tr_b16 a[22:23], v37 offset:20480
    v_mfma_f32_16x16x32_bf16 v[160:163], a[112:115], a[40:43], v[160:163]
    buffer_load_dwordx2 a[80:81], v6, s[32:35], s50 offen sc1
    buffer_load_dwordx2 a[82:83], v6, s[32:35], s50 offen offset:512 sc1
    v_mfma_f32_16x16x32_bf16 v[164:167], a[112:115], a[44:47], v[164:167]
    ds_read_b64_tr_b16 a[24:25], v38 offset:16384
    ds_read_b64_tr_b16 a[26:27], v38 offset:20480
    v_mfma_f32_16x16x32_bf16 v[172:175], a[116:119], a[44:47], v[172:175]
    ds_read_b64_tr_b16 a[28:29], v39 offset:16384
    ds_read_b64_tr_b16 a[30:31], v39 offset:20480
    v_mfma_f32_16x16x32_bf16 v[168:171], a[116:119], a[40:43], v[168:171]
    buffer_load_dwordx4 v8, s[36:39], s54 offen offset:0 lds
    v_mfma_f32_16x16x32_bf16 v[176:179], a[120:123], a[40:43], v[176:179]
    buffer_load_dwordx2 a[84:85], v7, s[32:35], s50 offen sc1
    buffer_load_dwordx2 a[86:87], v7, s[32:35], s50 offen offset:512 sc1
    v_mfma_f32_16x16x32_bf16 v[180:183], a[120:123], a[44:47], v[180:183]
    buffer_load_dwordx4 v9, s[36:39], s54 offen offset:1024 lds
    v_mfma_f32_16x16x32_bf16 v[188:191], a[124:127], a[44:47], v[188:191]
    v_mfma_f32_16x16x32_bf16 v[184:187], a[124:127], a[40:43], v[184:187]
    s_waitcnt lgkmcnt(0)
    v_mfma_f32_16x16x32_bf16 v[128:131], a[0:3], a[48:51], v[128:131]
    ds_read_b64_tr_b16 a[96:97], v32 offset:24576
    ds_read_b64_tr_b16 a[98:99], v32 offset:28672
    v_mfma_f32_16x16x32_bf16 v[132:135], a[0:3], a[52:55], v[132:135]
    ds_read_b64_tr_b16 a[100:101], v33 offset:24576
    ds_read_b64_tr_b16 a[102:103], v33 offset:28672
    v_mfma_f32_16x16x32_bf16 v[140:143], a[4:7], a[52:55], v[140:143]
    buffer_load_dwordx4 v10, s[36:39], s54 offen offset:2048 lds
    v_mfma_f32_16x16x32_bf16 v[136:139], a[4:7], a[48:51], v[136:139]
    ds_read_b64_tr_b16 a[104:105], v34 offset:24576
    ds_read_b64_tr_b16 a[106:107], v34 offset:28672
    v_mfma_f32_16x16x32_bf16 v[144:147], a[8:11], a[48:51], v[144:147]
    ds_read_b64_tr_b16 a[108:109], v35 offset:24576
    ds_read_b64_tr_b16 a[110:111], v35 offset:28672
    v_mfma_f32_16x16x32_bf16 v[148:151], a[8:11], a[52:55], v[148:151]
    buffer_load_dwordx2 a[88:89], v6, s[32:35], s51 offen sc1
    buffer_load_dwordx2 a[90:91], v6, s[32:35], s51 offen offset:512 sc1
    v_mfma_f32_16x16x32_bf16 v[156:159], a[12:15], a[52:55], v[156:159]
    ds_read_b64_tr_b16 a[112:113], v36 offset:24576
    ds_read_b64_tr_b16 a[114:115], v36 offset:28672
    v_mfma_f32_16x16x32_bf16 v[152:155], a[12:15], a[48:51], v[152:155]
    ds_read_b64_tr_b16 a[116:117], v37 offset:24576
    ds_read_b64_tr_b16 a[118:119], v37 offset:28672
    v_mfma_f32_16x16x32_bf16 v[160:163], a[16:19], a[48:51], v[160:163]
    buffer_load_dwordx4 v11, s[36:39], s54 offen offset:3072 lds
    v_mfma_f32_16x16x32_bf16 v[164:167], a[16:19], a[52:55], v[164:167]
    ds_read_b64_tr_b16 a[120:121], v38 offset:24576
    ds_read_b64_tr_b16 a[122:123], v38 offset:28672
    v_mfma_f32_16x16x32_bf16 v[172:175], a[20:23], a[52:55], v[172:175]
    ds_read_b64_tr_b16 a[124:125], v39 offset:24576
    ds_read_b64_tr_b16 a[126:127], v39 offset:28672
    v_mfma_f32_16x16x32_bf16 v[168:171], a[20:23], a[48:51], v[168:171]
    buffer_load_dwordx2 a[92:93], v7, s[32:35], s51 offen sc1
    buffer_load_dwordx2 a[94:95], v7, s[32:35], s51 offen offset:512 sc1
    v_mfma_f32_16x16x32_bf16 v[176:179], a[24:27], a[48:51], v[176:179]
    v_mfma_f32_16x16x32_bf16 v[180:183], a[24:27], a[52:55], v[180:183]
    v_mfma_f32_16x16x32_bf16 v[188:191], a[28:31], a[52:55], v[188:191]
    v_mfma_f32_16x16x32_bf16 v[184:187], a[28:31], a[48:51], v[184:187]
    s_mov_b32 s46, 262144
    s_mov_b32 s47, 524288
    s_mov_b32 s48, 655360
    s_mov_b32 s49, 786432
    .p2align 6
f2loop_adaLN_cond__linear_kernel_hedgehog__glu_gated_swiglu__prompt_kernel_48:
    s_waitcnt vmcnt(8)
    s_waitcnt lgkmcnt(0)
    v_mfma_f32_16x16x32_bf16 v[128:131], a[96:99], a[56:59], v[128:131]
    ds_read_b64_tr_b16 a[0:1], v32 offset:32768
    ds_read_b64_tr_b16 a[2:3], v32 offset:36864
    v_mfma_f32_16x16x32_bf16 v[132:135], a[96:99], a[60:63], v[132:135]
    ds_read_b64_tr_b16 a[4:5], v33 offset:32768
    ds_read_b64_tr_b16 a[6:7], v33 offset:36864
    v_mfma_f32_16x16x32_bf16 v[140:143], a[100:103], a[60:63], v[140:143]
    s_add_u32 s54, s67, s77
    s_lshr_b32 s54, s54, 1
    v_mfma_f32_16x16x32_bf16 v[136:139], a[100:103], a[56:59], v[136:139]
    ds_read_b64_tr_b16 a[8:9], v34 offset:32768
    ds_read_b64_tr_b16 a[10:11], v34 offset:36864
    v_mfma_f32_16x16x32_bf16 v[144:147], a[104:107], a[56:59], v[144:147]
    ds_read_b64_tr_b16 a[12:13], v35 offset:32768
    ds_read_b64_tr_b16 a[14:15], v35 offset:36864
    v_mfma_f32_16x16x32_bf16 v[148:151], a[104:107], a[60:63], v[148:151]
    s_add_u32 m0, s52, 114688
    s_add_u32 s44, s64, s58
    v_mfma_f32_16x16x32_bf16 v[156:159], a[108:111], a[60:63], v[156:159]
    ds_read_b64_tr_b16 a[16:17], v36 offset:32768
    ds_read_b64_tr_b16 a[18:19], v36 offset:36864
    v_mfma_f32_16x16x32_bf16 v[152:155], a[108:111], a[56:59], v[152:155]
    ds_read_b64_tr_b16 a[20:21], v37 offset:32768
    ds_read_b64_tr_b16 a[22:23], v37 offset:36864
    v_mfma_f32_16x16x32_bf16 v[160:163], a[112:115], a[56:59], v[160:163]
    buffer_load_dwordx4 v8, s[36:39], s54 offen offset:0 lds
    v_mfma_f32_16x16x32_bf16 v[164:167], a[112:115], a[60:63], v[164:167]
    ds_read_b64_tr_b16 a[24:25], v38 offset:32768
    ds_read_b64_tr_b16 a[26:27], v38 offset:36864
    v_mfma_f32_16x16x32_bf16 v[172:175], a[116:119], a[60:63], v[172:175]
    ds_read_b64_tr_b16 a[28:29], v39 offset:32768
    ds_read_b64_tr_b16 a[30:31], v39 offset:36864
    v_mfma_f32_16x16x32_bf16 v[168:171], a[116:119], a[56:59], v[168:171]
    s_add_u32 s45, s64, s59
    v_mfma_f32_16x16x32_bf16 v[176:179], a[120:123], a[56:59], v[176:179]
    buffer_load_dwordx4 a[32:35], v4, s[32:35], s44 offen sc1
    v_mfma_f32_16x16x32_bf16 v[180:183], a[120:123], a[60:63], v[180:183]
    buffer_load_dwordx4 v9, s[36:39], s54 offen offset:1024 lds
    v_mfma_f32_16x16x32_bf16 v[188:191], a[124:127], a[60:63], v[188:191]
    buffer_load_dwordx4 a[36:39], v5, s[32:35], s44 offen sc1
    v_mfma_f32_16x16x32_bf16 v[184:187], a[124:127], a[56:59], v[184:187]
    s_waitcnt lgkmcnt(0)
    v_mfma_f32_16x16x32_bf16 v[128:131], a[0:3], a[64:67], v[128:131]
    ds_read_b64_tr_b16 a[96:97], v32 offset:40960
    ds_read_b64_tr_b16 a[98:99], v32 offset:45056
    v_mfma_f32_16x16x32_bf16 v[132:135], a[0:3], a[68:71], v[132:135]
    ds_read_b64_tr_b16 a[100:101], v33 offset:40960
    ds_read_b64_tr_b16 a[102:103], v33 offset:45056
    v_mfma_f32_16x16x32_bf16 v[140:143], a[4:7], a[68:71], v[140:143]
    buffer_load_dwordx4 v10, s[36:39], s54 offen offset:2048 lds
    v_mfma_f32_16x16x32_bf16 v[136:139], a[4:7], a[64:67], v[136:139]
    ds_read_b64_tr_b16 a[104:105], v34 offset:40960
    ds_read_b64_tr_b16 a[106:107], v34 offset:45056
    v_mfma_f32_16x16x32_bf16 v[144:147], a[8:11], a[64:67], v[144:147]
    ds_read_b64_tr_b16 a[108:109], v35 offset:40960
    ds_read_b64_tr_b16 a[110:111], v35 offset:45056
    v_mfma_f32_16x16x32_bf16 v[148:151], a[8:11], a[68:71], v[148:151]
    buffer_load_dwordx4 a[40:43], v4, s[32:35], s45 offen sc1
    v_mfma_f32_16x16x32_bf16 v[156:159], a[12:15], a[68:71], v[156:159]
    ds_read_b64_tr_b16 a[112:113], v36 offset:40960
    ds_read_b64_tr_b16 a[114:115], v36 offset:45056
    v_mfma_f32_16x16x32_bf16 v[152:155], a[12:15], a[64:67], v[152:155]
    ds_read_b64_tr_b16 a[116:117], v37 offset:40960
    ds_read_b64_tr_b16 a[118:119], v37 offset:45056
    v_mfma_f32_16x16x32_bf16 v[160:163], a[16:19], a[64:67], v[160:163]
    buffer_load_dwordx4 v11, s[36:39], s54 offen offset:3072 lds
    v_mfma_f32_16x16x32_bf16 v[164:167], a[16:19], a[68:71], v[164:167]
    ds_read_b64_tr_b16 a[120:121], v38 offset:40960
    ds_read_b64_tr_b16 a[122:123], v38 offset:45056
    v_mfma_f32_16x16x32_bf16 v[172:175], a[20:23], a[68:71], v[172:175]
    ds_read_b64_tr_b16 a[124:125], v39 offset:40960
    ds_read_b64_tr_b16 a[126:127], v39 offset:45056
    v_mfma_f32_16x16x32_bf16 v[168:171], a[20:23], a[64:67], v[168:171]
    buffer_load_dwordx4 a[44:47], v5, s[32:35], s45 offen sc1
    v_mfma_f32_16x16x32_bf16 v[176:179], a[24:27], a[64:67], v[176:179]
    v_mfma_f32_16x16x32_bf16 v[180:183], a[24:27], a[68:71], v[180:183]
    v_mfma_f32_16x16x32_bf16 v[188:191], a[28:31], a[68:71], v[188:191]
    v_mfma_f32_16x16x32_bf16 v[184:187], a[28:31], a[64:67], v[184:187]
    s_waitcnt vmcnt(8)
    s_barrier
    s_waitcnt lgkmcnt(0)
    v_mfma_f32_16x16x32_bf16 v[128:131], a[96:99], a[72:75], v[128:131]
    ds_read_b64_tr_b16 a[0:1], v32 offset:49152
    ds_read_b64_tr_b16 a[2:3], v32 offset:53248
    v_mfma_f32_16x16x32_bf16 v[132:135], a[96:99], a[76:79], v[132:135]
    ds_read_b64_tr_b16 a[4:5], v33 offset:49152
    ds_read_b64_tr_b16 a[6:7], v33 offset:53248
    v_mfma_f32_16x16x32_bf16 v[140:143], a[100:103], a[76:79], v[140:143]
    s_add_u32 s54, s68, s77
    s_lshr_b32 s54, s54, 1
    v_mfma_f32_16x16x32_bf16 v[136:139], a[100:103], a[72:75], v[136:139]
    ds_read_b64_tr_b16 a[8:9], v34 offset:49152
    ds_read_b64_tr_b16 a[10:11], v34 offset:53248
    v_mfma_f32_16x16x32_bf16 v[144:147], a[104:107], a[72:75], v[144:147]
    ds_read_b64_tr_b16 a[12:13], v35 offset:49152
    ds_read_b64_tr_b16 a[14:15], v35 offset:53248
    v_mfma_f32_16x16x32_bf16 v[148:151], a[104:107], a[76:79], v[148:151]
    s_add_u32 m0, s52, 0
    s_add_u32 s44, s65, s58
    v_mfma_f32_16x16x32_bf16 v[156:159], a[108:111], a[76:79], v[156:159]
    ds_read_b64_tr_b16 a[16:17], v36 offset:49152
    ds_read_b64_tr_b16 a[18:19], v36 offset:53248
    v_mfma_f32_16x16x32_bf16 v[152:155], a[108:111], a[72:75], v[152:155]
    ds_read_b64_tr_b16 a[20:21], v37 offset:49152
    ds_read_b64_tr_b16 a[22:23], v37 offset:53248
    v_mfma_f32_16x16x32_bf16 v[160:163], a[112:115], a[72:75], v[160:163]
    buffer_load_dwordx4 v8, s[36:39], s54 offen offset:0 lds
    v_mfma_f32_16x16x32_bf16 v[164:167], a[112:115], a[76:79], v[164:167]
    ds_read_b64_tr_b16 a[24:25], v38 offset:49152
    ds_read_b64_tr_b16 a[26:27], v38 offset:53248
    v_mfma_f32_16x16x32_bf16 v[172:175], a[116:119], a[76:79], v[172:175]
    ds_read_b64_tr_b16 a[28:29], v39 offset:49152
    ds_read_b64_tr_b16 a[30:31], v39 offset:53248
    v_mfma_f32_16x16x32_bf16 v[168:171], a[116:119], a[72:75], v[168:171]
    s_add_u32 s45, s65, s59
    v_mfma_f32_16x16x32_bf16 v[176:179], a[120:123], a[72:75], v[176:179]
    buffer_load_dwordx4 a[48:51], v4, s[32:35], s44 offen sc1
    v_mfma_f32_16x16x32_bf16 v[180:183], a[120:123], a[76:79], v[180:183]
    buffer_load_dwordx4 v9, s[36:39], s54 offen offset:1024 lds
    v_mfma_f32_16x16x32_bf16 v[188:191], a[124:127], a[76:79], v[188:191]
    buffer_load_dwordx4 a[52:55], v5, s[32:35], s44 offen sc1
    v_mfma_f32_16x16x32_bf16 v[184:187], a[124:127], a[72:75], v[184:187]
    s_waitcnt lgkmcnt(0)
    v_mfma_f32_16x16x32_bf16 v[128:131], a[0:3], a[80:83], v[128:131]
    ds_read_b64_tr_b16 a[96:97], v32 offset:57344
    ds_read_b64_tr_b16 a[98:99], v32 offset:61440
    v_mfma_f32_16x16x32_bf16 v[132:135], a[0:3], a[84:87], v[132:135]
    ds_read_b64_tr_b16 a[100:101], v33 offset:57344
    ds_read_b64_tr_b16 a[102:103], v33 offset:61440
    v_mfma_f32_16x16x32_bf16 v[140:143], a[4:7], a[84:87], v[140:143]
    buffer_load_dwordx4 v10, s[36:39], s54 offen offset:2048 lds
    v_mfma_f32_16x16x32_bf16 v[136:139], a[4:7], a[80:83], v[136:139]
    ds_read_b64_tr_b16 a[104:105], v34 offset:57344
    ds_read_b64_tr_b16 a[106:107], v34 offset:61440
    v_mfma_f32_16x16x32_bf16 v[144:147], a[8:11], a[80:83], v[144:147]
    ds_read_b64_tr_b16 a[108:109], v35 offset:57344
    ds_read_b64_tr_b16 a[110:111], v35 offset:61440
    v_mfma_f32_16x16x32_bf16 v[148:151], a[8:11], a[84:87], v[148:151]
    buffer_load_dwordx4 a[56:59], v4, s[32:35], s45 offen sc1
    v_mfma_f32_16x16x32_bf16 v[156:159], a[12:15], a[84:87], v[156:159]
    ds_read_b64_tr_b16 a[112:113], v36 offset:57344
    ds_read_b64_tr_b16 a[114:115], v36 offset:61440
    v_mfma_f32_16x16x32_bf16 v[152:155], a[12:15], a[80:83], v[152:155]
    ds_read_b64_tr_b16 a[116:117], v37 offset:57344
    ds_read_b64_tr_b16 a[118:119], v37 offset:61440
    v_mfma_f32_16x16x32_bf16 v[160:163], a[16:19], a[80:83], v[160:163]
    buffer_load_dwordx4 v11, s[36:39], s54 offen offset:3072 lds
    v_mfma_f32_16x16x32_bf16 v[164:167], a[16:19], a[84:87], v[164:167]
    ds_read_b64_tr_b16 a[120:121], v38 offset:57344
    ds_read_b64_tr_b16 a[122:123], v38 offset:61440
    v_mfma_f32_16x16x32_bf16 v[172:175], a[20:23], a[84:87], v[172:175]
    ds_read_b64_tr_b16 a[124:125], v39 offset:57344
    ds_read_b64_tr_b16 a[126:127], v39 offset:61440
    v_mfma_f32_16x16x32_bf16 v[168:171], a[20:23], a[80:83], v[168:171]
    buffer_load_dwordx4 a[60:63], v5, s[32:35], s45 offen sc1
    v_mfma_f32_16x16x32_bf16 v[176:179], a[24:27], a[80:83], v[176:179]
    v_mfma_f32_16x16x32_bf16 v[180:183], a[24:27], a[84:87], v[180:183]
    v_mfma_f32_16x16x32_bf16 v[188:191], a[28:31], a[84:87], v[188:191]
    v_mfma_f32_16x16x32_bf16 v[184:187], a[28:31], a[80:83], v[184:187]
    s_waitcnt vmcnt(8)
    s_waitcnt lgkmcnt(0)
    v_mfma_f32_16x16x32_bf16 v[128:131], a[96:99], a[88:91], v[128:131]
    ds_read_b64_tr_b16 a[0:1], v40 offset:0
    ds_read_b64_tr_b16 a[2:3], v40 offset:4096
    v_mfma_f32_16x16x32_bf16 v[132:135], a[96:99], a[92:95], v[132:135]
    ds_read_b64_tr_b16 a[4:5], v41 offset:0
    ds_read_b64_tr_b16 a[6:7], v41 offset:4096
    v_mfma_f32_16x16x32_bf16 v[140:143], a[100:103], a[92:95], v[140:143]
    s_add_u32 s54, s69, s77
    s_lshr_b32 s54, s54, 1
    v_mfma_f32_16x16x32_bf16 v[136:139], a[100:103], a[88:91], v[136:139]
    ds_read_b64_tr_b16 a[8:9], v42 offset:0
    ds_read_b64_tr_b16 a[10:11], v42 offset:4096
    v_mfma_f32_16x16x32_bf16 v[144:147], a[104:107], a[88:91], v[144:147]
    ds_read_b64_tr_b16 a[12:13], v43 offset:0
    ds_read_b64_tr_b16 a[14:15], v43 offset:4096
    v_mfma_f32_16x16x32_bf16 v[148:151], a[104:107], a[92:95], v[148:151]
    s_add_u32 m0, s52, 16384
    s_add_u32 s44, s66, s58
    v_mfma_f32_16x16x32_bf16 v[156:159], a[108:111], a[92:95], v[156:159]
    ds_read_b64_tr_b16 a[16:17], v44 offset:0
    ds_read_b64_tr_b16 a[18:19], v44 offset:4096
    v_mfma_f32_16x16x32_bf16 v[152:155], a[108:111], a[88:91], v[152:155]
    ds_read_b64_tr_b16 a[20:21], v45 offset:0
    ds_read_b64_tr_b16 a[22:23], v45 offset:4096
    v_mfma_f32_16x16x32_bf16 v[160:163], a[112:115], a[88:91], v[160:163]
    buffer_load_dwordx4 v8, s[36:39], s54 offen offset:0 lds
    v_mfma_f32_16x16x32_bf16 v[164:167], a[112:115], a[92:95], v[164:167]
    ds_read_b64_tr_b16 a[24:25], v46 offset:0
    ds_read_b64_tr_b16 a[26:27], v46 offset:4096
    v_mfma_f32_16x16x32_bf16 v[172:175], a[116:119], a[92:95], v[172:175]
    ds_read_b64_tr_b16 a[28:29], v47 offset:0
    ds_read_b64_tr_b16 a[30:31], v47 offset:4096
    v_mfma_f32_16x16x32_bf16 v[168:171], a[116:119], a[88:91], v[168:171]
    s_add_u32 s45, s66, s59
    v_mfma_f32_16x16x32_bf16 v[176:179], a[120:123], a[88:91], v[176:179]
    buffer_load_dwordx4 a[64:67], v4, s[32:35], s44 offen sc1
    v_mfma_f32_16x16x32_bf16 v[180:183], a[120:123], a[92:95], v[180:183]
    buffer_load_dwordx4 v9, s[36:39], s54 offen offset:1024 lds
    v_mfma_f32_16x16x32_bf16 v[188:191], a[124:127], a[92:95], v[188:191]
    buffer_load_dwordx4 a[68:71], v5, s[32:35], s44 offen sc1
    v_mfma_f32_16x16x32_bf16 v[184:187], a[124:127], a[88:91], v[184:187]
    s_waitcnt lgkmcnt(0)
    v_mfma_f32_16x16x32_bf16 v[128:131], a[0:3], a[32:35], v[128:131]
    ds_read_b64_tr_b16 a[96:97], v40 offset:8192
    ds_read_b64_tr_b16 a[98:99], v40 offset:12288
    v_mfma_f32_16x16x32_bf16 v[132:135], a[0:3], a[36:39], v[132:135]
    ds_read_b64_tr_b16 a[100:101], v41 offset:8192
    ds_read_b64_tr_b16 a[102:103], v41 offset:12288
    v_mfma_f32_16x16x32_bf16 v[140:143], a[4:7], a[36:39], v[140:143]
    buffer_load_dwordx4 v10, s[36:39], s54 offen offset:2048 lds
    v_mfma_f32_16x16x32_bf16 v[136:139], a[4:7], a[32:35], v[136:139]
    ds_read_b64_tr_b16 a[104:105], v42 offset:8192
    ds_read_b64_tr_b16 a[106:107], v42 offset:12288
    v_mfma_f32_16x16x32_bf16 v[144:147], a[8:11], a[32:35], v[144:147]
    ds_read_b64_tr_b16 a[108:109], v43 offset:8192
    ds_read_b64_tr_b16 a[110:111], v43 offset:12288
    v_mfma_f32_16x16x32_bf16 v[148:151], a[8:11], a[36:39], v[148:151]
    buffer_load_dwordx4 a[72:75], v4, s[32:35], s45 offen sc1
    v_mfma_f32_16x16x32_bf16 v[156:159], a[12:15], a[36:39], v[156:159]
    ds_read_b64_tr_b16 a[112:113], v44 offset:8192
    ds_read_b64_tr_b16 a[114:115], v44 offset:12288
    v_mfma_f32_16x16x32_bf16 v[152:155], a[12:15], a[32:35], v[152:155]
    ds_read_b64_tr_b16 a[116:117], v45 offset:8192
    ds_read_b64_tr_b16 a[118:119], v45 offset:12288
    v_mfma_f32_16x16x32_bf16 v[160:163], a[16:19], a[32:35], v[160:163]
    buffer_load_dwordx4 v11, s[36:39], s54 offen offset:3072 lds
    v_mfma_f32_16x16x32_bf16 v[164:167], a[16:19], a[36:39], v[164:167]
    ds_read_b64_tr_b16 a[120:121], v46 offset:8192
    ds_read_b64_tr_b16 a[122:123], v46 offset:12288
    v_mfma_f32_16x16x32_bf16 v[172:175], a[20:23], a[36:39], v[172:175]
    ds_read_b64_tr_b16 a[124:125], v47 offset:8192
    ds_read_b64_tr_b16 a[126:127], v47 offset:12288
    v_mfma_f32_16x16x32_bf16 v[168:171], a[20:23], a[32:35], v[168:171]
    buffer_load_dwordx4 a[76:79], v5, s[32:35], s45 offen sc1
    v_mfma_f32_16x16x32_bf16 v[176:179], a[24:27], a[32:35], v[176:179]
    v_mfma_f32_16x16x32_bf16 v[180:183], a[24:27], a[36:39], v[180:183]
    v_mfma_f32_16x16x32_bf16 v[188:191], a[28:31], a[36:39], v[188:191]
    v_mfma_f32_16x16x32_bf16 v[184:187], a[28:31], a[32:35], v[184:187]
    s_waitcnt vmcnt(8)
    s_barrier
    s_waitcnt lgkmcnt(0)
    v_mfma_f32_16x16x32_bf16 v[128:131], a[96:99], a[40:43], v[128:131]
    ds_read_b64_tr_b16 a[0:1], v40 offset:16384
    ds_read_b64_tr_b16 a[2:3], v40 offset:20480
    v_mfma_f32_16x16x32_bf16 v[132:135], a[96:99], a[44:47], v[132:135]
    ds_read_b64_tr_b16 a[4:5], v41 offset:16384
    ds_read_b64_tr_b16 a[6:7], v41 offset:20480
    v_mfma_f32_16x16x32_bf16 v[140:143], a[100:103], a[44:47], v[140:143]
    s_add_u32 s54, s70, s77
    s_lshr_b32 s54, s54, 1
    v_mfma_f32_16x16x32_bf16 v[136:139], a[100:103], a[40:43], v[136:139]
    ds_read_b64_tr_b16 a[8:9], v42 offset:16384
    ds_read_b64_tr_b16 a[10:11], v42 offset:20480
    v_mfma_f32_16x16x32_bf16 v[144:147], a[104:107], a[40:43], v[144:147]
    ds_read_b64_tr_b16 a[12:13], v43 offset:16384
    ds_read_b64_tr_b16 a[14:15], v43 offset:20480
    v_mfma_f32_16x16x32_bf16 v[148:151], a[104:107], a[44:47], v[148:151]
    s_add_u32 m0, s52, 32768
    s_add_u32 s44, s67, s58
    v_mfma_f32_16x16x32_bf16 v[156:159], a[108:111], a[44:47], v[156:159]
    ds_read_b64_tr_b16 a[16:17], v44 offset:16384
    ds_read_b64_tr_b16 a[18:19], v44 offset:20480
    v_mfma_f32_16x16x32_bf16 v[152:155], a[108:111], a[40:43], v[152:155]
    ds_read_b64_tr_b16 a[20:21], v45 offset:16384
    ds_read_b64_tr_b16 a[22:23], v45 offset:20480
    v_mfma_f32_16x16x32_bf16 v[160:163], a[112:115], a[40:43], v[160:163]
    buffer_load_dwordx4 v8, s[36:39], s54 offen offset:0 lds
    v_mfma_f32_16x16x32_bf16 v[164:167], a[112:115], a[44:47], v[164:167]
    ds_read_b64_tr_b16 a[24:25], v46 offset:16384
    ds_read_b64_tr_b16 a[26:27], v46 offset:20480
    v_mfma_f32_16x16x32_bf16 v[172:175], a[116:119], a[44:47], v[172:175]
    ds_read_b64_tr_b16 a[28:29], v47 offset:16384
    ds_read_b64_tr_b16 a[30:31], v47 offset:20480
    v_mfma_f32_16x16x32_bf16 v[168:171], a[116:119], a[40:43], v[168:171]
    s_add_u32 s45, s67, s59
    v_mfma_f32_16x16x32_bf16 v[176:179], a[120:123], a[40:43], v[176:179]
    buffer_load_dwordx4 a[80:83], v4, s[32:35], s44 offen sc1
    v_mfma_f32_16x16x32_bf16 v[180:183], a[120:123], a[44:47], v[180:183]
    buffer_load_dwordx4 v9, s[36:39], s54 offen offset:1024 lds
    v_mfma_f32_16x16x32_bf16 v[188:191], a[124:127], a[44:47], v[188:191]
    buffer_load_dwordx4 a[84:87], v5, s[32:35], s44 offen sc1
    v_mfma_f32_16x16x32_bf16 v[184:187], a[124:127], a[40:43], v[184:187]
    s_waitcnt lgkmcnt(0)
    v_mfma_f32_16x16x32_bf16 v[128:131], a[0:3], a[48:51], v[128:131]
    ds_read_b64_tr_b16 a[96:97], v40 offset:24576
    ds_read_b64_tr_b16 a[98:99], v40 offset:28672
    v_mfma_f32_16x16x32_bf16 v[132:135], a[0:3], a[52:55], v[132:135]
    ds_read_b64_tr_b16 a[100:101], v41 offset:24576
    ds_read_b64_tr_b16 a[102:103], v41 offset:28672
    v_mfma_f32_16x16x32_bf16 v[140:143], a[4:7], a[52:55], v[140:143]
    buffer_load_dwordx4 v10, s[36:39], s54 offen offset:2048 lds
    v_mfma_f32_16x16x32_bf16 v[136:139], a[4:7], a[48:51], v[136:139]
    ds_read_b64_tr_b16 a[104:105], v42 offset:24576
    ds_read_b64_tr_b16 a[106:107], v42 offset:28672
    v_mfma_f32_16x16x32_bf16 v[144:147], a[8:11], a[48:51], v[144:147]
    ds_read_b64_tr_b16 a[108:109], v43 offset:24576
    ds_read_b64_tr_b16 a[110:111], v43 offset:28672
    v_mfma_f32_16x16x32_bf16 v[148:151], a[8:11], a[52:55], v[148:151]
    buffer_load_dwordx4 a[88:91], v4, s[32:35], s45 offen sc1
    v_mfma_f32_16x16x32_bf16 v[156:159], a[12:15], a[52:55], v[156:159]
    ds_read_b64_tr_b16 a[112:113], v44 offset:24576
    ds_read_b64_tr_b16 a[114:115], v44 offset:28672
    v_mfma_f32_16x16x32_bf16 v[152:155], a[12:15], a[48:51], v[152:155]
    ds_read_b64_tr_b16 a[116:117], v45 offset:24576
    ds_read_b64_tr_b16 a[118:119], v45 offset:28672
    v_mfma_f32_16x16x32_bf16 v[160:163], a[16:19], a[48:51], v[160:163]
    buffer_load_dwordx4 v11, s[36:39], s54 offen offset:3072 lds
    v_mfma_f32_16x16x32_bf16 v[164:167], a[16:19], a[52:55], v[164:167]
    ds_read_b64_tr_b16 a[120:121], v46 offset:24576
    ds_read_b64_tr_b16 a[122:123], v46 offset:28672
    v_mfma_f32_16x16x32_bf16 v[172:175], a[20:23], a[52:55], v[172:175]
    ds_read_b64_tr_b16 a[124:125], v47 offset:24576
    ds_read_b64_tr_b16 a[126:127], v47 offset:28672
    v_mfma_f32_16x16x32_bf16 v[168:171], a[20:23], a[48:51], v[168:171]
    buffer_load_dwordx4 a[92:95], v5, s[32:35], s45 offen sc1
    v_mfma_f32_16x16x32_bf16 v[176:179], a[24:27], a[48:51], v[176:179]
    v_mfma_f32_16x16x32_bf16 v[180:183], a[24:27], a[52:55], v[180:183]
    v_mfma_f32_16x16x32_bf16 v[188:191], a[28:31], a[52:55], v[188:191]
    v_mfma_f32_16x16x32_bf16 v[184:187], a[28:31], a[48:51], v[184:187]
    s_waitcnt vmcnt(8)
    s_waitcnt lgkmcnt(0)
    v_mfma_f32_16x16x32_bf16 v[128:131], a[96:99], a[56:59], v[128:131]
    ds_read_b64_tr_b16 a[0:1], v40 offset:32768
    ds_read_b64_tr_b16 a[2:3], v40 offset:36864
    v_mfma_f32_16x16x32_bf16 v[132:135], a[96:99], a[60:63], v[132:135]
    ds_read_b64_tr_b16 a[4:5], v41 offset:32768
    ds_read_b64_tr_b16 a[6:7], v41 offset:36864
    v_mfma_f32_16x16x32_bf16 v[140:143], a[100:103], a[60:63], v[140:143]
    s_add_u32 s54, s71, s77
    s_lshr_b32 s54, s54, 1
    v_mfma_f32_16x16x32_bf16 v[136:139], a[100:103], a[56:59], v[136:139]
    ds_read_b64_tr_b16 a[8:9], v42 offset:32768
    ds_read_b64_tr_b16 a[10:11], v42 offset:36864
    v_mfma_f32_16x16x32_bf16 v[144:147], a[104:107], a[56:59], v[144:147]
    ds_read_b64_tr_b16 a[12:13], v43 offset:32768
    ds_read_b64_tr_b16 a[14:15], v43 offset:36864
    v_mfma_f32_16x16x32_bf16 v[148:151], a[104:107], a[60:63], v[148:151]
    s_add_u32 m0, s52, 49152
    s_add_u32 s44, s68, s58
    v_mfma_f32_16x16x32_bf16 v[156:159], a[108:111], a[60:63], v[156:159]
    ds_read_b64_tr_b16 a[16:17], v44 offset:32768
    ds_read_b64_tr_b16 a[18:19], v44 offset:36864
    v_mfma_f32_16x16x32_bf16 v[152:155], a[108:111], a[56:59], v[152:155]
    ds_read_b64_tr_b16 a[20:21], v45 offset:32768
    ds_read_b64_tr_b16 a[22:23], v45 offset:36864
    v_mfma_f32_16x16x32_bf16 v[160:163], a[112:115], a[56:59], v[160:163]
    buffer_load_dwordx4 v8, s[36:39], s54 offen offset:0 lds
    v_mfma_f32_16x16x32_bf16 v[164:167], a[112:115], a[60:63], v[164:167]
    ds_read_b64_tr_b16 a[24:25], v46 offset:32768
    ds_read_b64_tr_b16 a[26:27], v46 offset:36864
    v_mfma_f32_16x16x32_bf16 v[172:175], a[116:119], a[60:63], v[172:175]
    ds_read_b64_tr_b16 a[28:29], v47 offset:32768
    ds_read_b64_tr_b16 a[30:31], v47 offset:36864
    v_mfma_f32_16x16x32_bf16 v[168:171], a[116:119], a[56:59], v[168:171]
    s_add_u32 s45, s68, s59
    v_mfma_f32_16x16x32_bf16 v[176:179], a[120:123], a[56:59], v[176:179]
    buffer_load_dwordx4 a[32:35], v4, s[32:35], s44 offen sc1
    v_mfma_f32_16x16x32_bf16 v[180:183], a[120:123], a[60:63], v[180:183]
    buffer_load_dwordx4 v9, s[36:39], s54 offen offset:1024 lds
    v_mfma_f32_16x16x32_bf16 v[188:191], a[124:127], a[60:63], v[188:191]
    buffer_load_dwordx4 a[36:39], v5, s[32:35], s44 offen sc1
    v_mfma_f32_16x16x32_bf16 v[184:187], a[124:127], a[56:59], v[184:187]
    s_waitcnt lgkmcnt(0)
    v_mfma_f32_16x16x32_bf16 v[128:131], a[0:3], a[64:67], v[128:131]
    ds_read_b64_tr_b16 a[96:97], v40 offset:40960
    ds_read_b64_tr_b16 a[98:99], v40 offset:45056
    v_mfma_f32_16x16x32_bf16 v[132:135], a[0:3], a[68:71], v[132:135]
    ds_read_b64_tr_b16 a[100:101], v41 offset:40960
    ds_read_b64_tr_b16 a[102:103], v41 offset:45056
    v_mfma_f32_16x16x32_bf16 v[140:143], a[4:7], a[68:71], v[140:143]
    buffer_load_dwordx4 v10, s[36:39], s54 offen offset:2048 lds
    v_mfma_f32_16x16x32_bf16 v[136:139], a[4:7], a[64:67], v[136:139]
    ds_read_b64_tr_b16 a[104:105], v42 offset:40960
    ds_read_b64_tr_b16 a[106:107], v42 offset:45056
    v_mfma_f32_16x16x32_bf16 v[144:147], a[8:11], a[64:67], v[144:147]
    ds_read_b64_tr_b16 a[108:109], v43 offset:40960
    ds_read_b64_tr_b16 a[110:111], v43 offset:45056
    v_mfma_f32_16x16x32_bf16 v[148:151], a[8:11], a[68:71], v[148:151]
    buffer_load_dwordx4 a[40:43], v4, s[32:35], s45 offen sc1
    v_mfma_f32_16x16x32_bf16 v[156:159], a[12:15], a[68:71], v[156:159]
    ds_read_b64_tr_b16 a[112:113], v44 offset:40960
    ds_read_b64_tr_b16 a[114:115], v44 offset:45056
    v_mfma_f32_16x16x32_bf16 v[152:155], a[12:15], a[64:67], v[152:155]
    ds_read_b64_tr_b16 a[116:117], v45 offset:40960
    ds_read_b64_tr_b16 a[118:119], v45 offset:45056
    v_mfma_f32_16x16x32_bf16 v[160:163], a[16:19], a[64:67], v[160:163]
    buffer_load_dwordx4 v11, s[36:39], s54 offen offset:3072 lds
    v_mfma_f32_16x16x32_bf16 v[164:167], a[16:19], a[68:71], v[164:167]
    ds_read_b64_tr_b16 a[120:121], v46 offset:40960
    ds_read_b64_tr_b16 a[122:123], v46 offset:45056
    v_mfma_f32_16x16x32_bf16 v[172:175], a[20:23], a[68:71], v[172:175]
    ds_read_b64_tr_b16 a[124:125], v47 offset:40960
    ds_read_b64_tr_b16 a[126:127], v47 offset:45056
    v_mfma_f32_16x16x32_bf16 v[168:171], a[20:23], a[64:67], v[168:171]
    buffer_load_dwordx4 a[44:47], v5, s[32:35], s45 offen sc1
    v_mfma_f32_16x16x32_bf16 v[176:179], a[24:27], a[64:67], v[176:179]
    s_mov_b32 s77, s60
    s_mov_b32 s60, s61
    s_mov_b32 s61, 0x20000000
    v_mfma_f32_16x16x32_bf16 v[180:183], a[24:27], a[68:71], v[180:183]
    v_mfma_f32_16x16x32_bf16 v[188:191], a[28:31], a[68:71], v[188:191]
    v_mfma_f32_16x16x32_bf16 v[184:187], a[28:31], a[64:67], v[184:187]
    s_waitcnt vmcnt(8)
    s_barrier
    s_waitcnt lgkmcnt(0)
    v_mfma_f32_16x16x32_bf16 v[128:131], a[96:99], a[72:75], v[128:131]
    ds_read_b64_tr_b16 a[0:1], v40 offset:49152
    ds_read_b64_tr_b16 a[2:3], v40 offset:53248
    v_mfma_f32_16x16x32_bf16 v[132:135], a[96:99], a[76:79], v[132:135]
    ds_read_b64_tr_b16 a[4:5], v41 offset:49152
    ds_read_b64_tr_b16 a[6:7], v41 offset:53248
    v_mfma_f32_16x16x32_bf16 v[140:143], a[100:103], a[76:79], v[140:143]
    s_add_u32 s54, s64, s77
    s_lshr_b32 s54, s54, 1
    v_mfma_f32_16x16x32_bf16 v[136:139], a[100:103], a[72:75], v[136:139]
    ds_read_b64_tr_b16 a[8:9], v42 offset:49152
    ds_read_b64_tr_b16 a[10:11], v42 offset:53248
    v_mfma_f32_16x16x32_bf16 v[144:147], a[104:107], a[72:75], v[144:147]
    ds_read_b64_tr_b16 a[12:13], v43 offset:49152
    ds_read_b64_tr_b16 a[14:15], v43 offset:53248
    v_mfma_f32_16x16x32_bf16 v[148:151], a[104:107], a[76:79], v[148:151]
    s_add_u32 m0, s52, 65536
    s_add_u32 s44, s69, s58
    v_mfma_f32_16x16x32_bf16 v[156:159], a[108:111], a[76:79], v[156:159]
    ds_read_b64_tr_b16 a[16:17], v44 offset:49152
    ds_read_b64_tr_b16 a[18:19], v44 offset:53248
    v_mfma_f32_16x16x32_bf16 v[152:155], a[108:111], a[72:75], v[152:155]
    ds_read_b64_tr_b16 a[20:21], v45 offset:49152
    ds_read_b64_tr_b16 a[22:23], v45 offset:53248
    v_mfma_f32_16x16x32_bf16 v[160:163], a[112:115], a[72:75], v[160:163]
    buffer_load_dwordx4 v8, s[36:39], s54 offen offset:0 lds
    v_mfma_f32_16x16x32_bf16 v[164:167], a[112:115], a[76:79], v[164:167]
    ds_read_b64_tr_b16 a[24:25], v46 offset:49152
    ds_read_b64_tr_b16 a[26:27], v46 offset:53248
    v_mfma_f32_16x16x32_bf16 v[172:175], a[116:119], a[76:79], v[172:175]
    ds_read_b64_tr_b16 a[28:29], v47 offset:49152
    ds_read_b64_tr_b16 a[30:31], v47 offset:53248
    v_mfma_f32_16x16x32_bf16 v[168:171], a[116:119], a[72:75], v[168:171]
    s_add_u32 s45, s69, s59
    v_mfma_f32_16x16x32_bf16 v[176:179], a[120:123], a[72:75], v[176:179]
    buffer_load_dwordx4 a[48:51], v4, s[32:35], s44 offen sc1
    v_mfma_f32_16x16x32_bf16 v[180:183], a[120:123], a[76:79], v[180:183]
    buffer_load_dwordx4 v9, s[36:39], s54 offen offset:1024 lds
    v_mfma_f32_16x16x32_bf16 v[188:191], a[124:127], a[76:79], v[188:191]
    buffer_load_dwordx4 a[52:55], v5, s[32:35], s44 offen sc1
    v_mfma_f32_16x16x32_bf16 v[184:187], a[124:127], a[72:75], v[184:187]
    s_waitcnt lgkmcnt(0)
    v_mfma_f32_16x16x32_bf16 v[128:131], a[0:3], a[80:83], v[128:131]
    ds_read_b64_tr_b16 a[96:97], v40 offset:57344
    ds_read_b64_tr_b16 a[98:99], v40 offset:61440
    v_mfma_f32_16x16x32_bf16 v[132:135], a[0:3], a[84:87], v[132:135]
    ds_read_b64_tr_b16 a[100:101], v41 offset:57344
    ds_read_b64_tr_b16 a[102:103], v41 offset:61440
    v_mfma_f32_16x16x32_bf16 v[140:143], a[4:7], a[84:87], v[140:143]
    buffer_load_dwordx4 v10, s[36:39], s54 offen offset:2048 lds
    v_mfma_f32_16x16x32_bf16 v[136:139], a[4:7], a[80:83], v[136:139]
    ds_read_b64_tr_b16 a[104:105], v42 offset:57344
    ds_read_b64_tr_b16 a[106:107], v42 offset:61440
    v_mfma_f32_16x16x32_bf16 v[144:147], a[8:11], a[80:83], v[144:147]
    ds_read_b64_tr_b16 a[108:109], v43 offset:57344
    ds_read_b64_tr_b16 a[110:111], v43 offset:61440
    v_mfma_f32_16x16x32_bf16 v[148:151], a[8:11], a[84:87], v[148:151]
    buffer_load_dwordx4 a[56:59], v4, s[32:35], s45 offen sc1
    v_mfma_f32_16x16x32_bf16 v[156:159], a[12:15], a[84:87], v[156:159]
    ds_read_b64_tr_b16 a[112:113], v44 offset:57344
    ds_read_b64_tr_b16 a[114:115], v44 offset:61440
    v_mfma_f32_16x16x32_bf16 v[152:155], a[12:15], a[80:83], v[152:155]
    ds_read_b64_tr_b16 a[116:117], v45 offset:57344
    ds_read_b64_tr_b16 a[118:119], v45 offset:61440
    v_mfma_f32_16x16x32_bf16 v[160:163], a[16:19], a[80:83], v[160:163]
    buffer_load_dwordx4 v11, s[36:39], s54 offen offset:3072 lds
    v_mfma_f32_16x16x32_bf16 v[164:167], a[16:19], a[84:87], v[164:167]
    ds_read_b64_tr_b16 a[120:121], v46 offset:57344
    ds_read_b64_tr_b16 a[122:123], v46 offset:61440
    v_mfma_f32_16x16x32_bf16 v[172:175], a[20:23], a[84:87], v[172:175]
    ds_read_b64_tr_b16 a[124:125], v47 offset:57344
    ds_read_b64_tr_b16 a[126:127], v47 offset:61440
    v_mfma_f32_16x16x32_bf16 v[168:171], a[20:23], a[80:83], v[168:171]
    buffer_load_dwordx4 a[60:63], v5, s[32:35], s45 offen sc1
    v_mfma_f32_16x16x32_bf16 v[176:179], a[24:27], a[80:83], v[176:179]
    v_mfma_f32_16x16x32_bf16 v[180:183], a[24:27], a[84:87], v[180:183]
    v_mfma_f32_16x16x32_bf16 v[188:191], a[28:31], a[84:87], v[188:191]
    v_mfma_f32_16x16x32_bf16 v[184:187], a[28:31], a[80:83], v[184:187]
    s_waitcnt vmcnt(8)
    s_waitcnt lgkmcnt(0)
    v_mfma_f32_16x16x32_bf16 v[128:131], a[96:99], a[88:91], v[128:131]
    ds_read_b64_tr_b16 a[0:1], v32 offset:0
    ds_read_b64_tr_b16 a[2:3], v32 offset:4096
    v_mfma_f32_16x16x32_bf16 v[132:135], a[96:99], a[92:95], v[132:135]
    ds_read_b64_tr_b16 a[4:5], v33 offset:0
    ds_read_b64_tr_b16 a[6:7], v33 offset:4096
    v_mfma_f32_16x16x32_bf16 v[140:143], a[100:103], a[92:95], v[140:143]
    s_add_u32 s54, s65, s77
    s_lshr_b32 s54, s54, 1
    v_mfma_f32_16x16x32_bf16 v[136:139], a[100:103], a[88:91], v[136:139]
    ds_read_b64_tr_b16 a[8:9], v34 offset:0
    ds_read_b64_tr_b16 a[10:11], v34 offset:4096
    v_mfma_f32_16x16x32_bf16 v[144:147], a[104:107], a[88:91], v[144:147]
    ds_read_b64_tr_b16 a[12:13], v35 offset:0
    ds_read_b64_tr_b16 a[14:15], v35 offset:4096
    v_mfma_f32_16x16x32_bf16 v[148:151], a[104:107], a[92:95], v[148:151]
    s_add_u32 m0, s52, 81920
    s_add_u32 s44, s70, s58
    v_mfma_f32_16x16x32_bf16 v[156:159], a[108:111], a[92:95], v[156:159]
    ds_read_b64_tr_b16 a[16:17], v36 offset:0
    ds_read_b64_tr_b16 a[18:19], v36 offset:4096
    v_mfma_f32_16x16x32_bf16 v[152:155], a[108:111], a[88:91], v[152:155]
    ds_read_b64_tr_b16 a[20:21], v37 offset:0
    ds_read_b64_tr_b16 a[22:23], v37 offset:4096
    v_mfma_f32_16x16x32_bf16 v[160:163], a[112:115], a[88:91], v[160:163]
    buffer_load_dwordx4 v8, s[36:39], s54 offen offset:0 lds
    v_mfma_f32_16x16x32_bf16 v[164:167], a[112:115], a[92:95], v[164:167]
    ds_read_b64_tr_b16 a[24:25], v38 offset:0
    ds_read_b64_tr_b16 a[26:27], v38 offset:4096
    v_mfma_f32_16x16x32_bf16 v[172:175], a[116:119], a[92:95], v[172:175]
    ds_read_b64_tr_b16 a[28:29], v39 offset:0
    ds_read_b64_tr_b16 a[30:31], v39 offset:4096
    v_mfma_f32_16x16x32_bf16 v[168:171], a[116:119], a[88:91], v[168:171]
    s_add_u32 s45, s70, s59
    v_mfma_f32_16x16x32_bf16 v[176:179], a[120:123], a[88:91], v[176:179]
    buffer_load_dwordx4 a[64:67], v4, s[32:35], s44 offen sc1
    v_mfma_f32_16x16x32_bf16 v[180:183], a[120:123], a[92:95], v[180:183]
    buffer_load_dwordx4 v9, s[36:39], s54 offen offset:1024 lds
    v_mfma_f32_16x16x32_bf16 v[188:191], a[124:127], a[92:95], v[188:191]
    buffer_load_dwordx4 a[68:71], v5, s[32:35], s44 offen sc1
    v_mfma_f32_16x16x32_bf16 v[184:187], a[124:127], a[88:91], v[184:187]
    s_waitcnt lgkmcnt(0)
    v_mfma_f32_16x16x32_bf16 v[128:131], a[0:3], a[32:35], v[128:131]
    ds_read_b64_tr_b16 a[96:97], v32 offset:8192
    ds_read_b64_tr_b16 a[98:99], v32 offset:12288
    v_mfma_f32_16x16x32_bf16 v[132:135], a[0:3], a[36:39], v[132:135]
    ds_read_b64_tr_b16 a[100:101], v33 offset:8192
    ds_read_b64_tr_b16 a[102:103], v33 offset:12288
    v_mfma_f32_16x16x32_bf16 v[140:143], a[4:7], a[36:39], v[140:143]
    buffer_load_dwordx4 v10, s[36:39], s54 offen offset:2048 lds
    v_mfma_f32_16x16x32_bf16 v[136:139], a[4:7], a[32:35], v[136:139]
    ds_read_b64_tr_b16 a[104:105], v34 offset:8192
    ds_read_b64_tr_b16 a[106:107], v34 offset:12288
    v_mfma_f32_16x16x32_bf16 v[144:147], a[8:11], a[32:35], v[144:147]
    ds_read_b64_tr_b16 a[108:109], v35 offset:8192
    ds_read_b64_tr_b16 a[110:111], v35 offset:12288
    v_mfma_f32_16x16x32_bf16 v[148:151], a[8:11], a[36:39], v[148:151]
    buffer_load_dwordx4 a[72:75], v4, s[32:35], s45 offen sc1
    v_mfma_f32_16x16x32_bf16 v[156:159], a[12:15], a[36:39], v[156:159]
    ds_read_b64_tr_b16 a[112:113], v36 offset:8192
    ds_read_b64_tr_b16 a[114:115], v36 offset:12288
    v_mfma_f32_16x16x32_bf16 v[152:155], a[12:15], a[32:35], v[152:155]
    ds_read_b64_tr_b16 a[116:117], v37 offset:8192
    ds_read_b64_tr_b16 a[118:119], v37 offset:12288
    v_mfma_f32_16x16x32_bf16 v[160:163], a[16:19], a[32:35], v[160:163]
    buffer_load_dwordx4 v11, s[36:39], s54 offen offset:3072 lds
    v_mfma_f32_16x16x32_bf16 v[164:167], a[16:19], a[36:39], v[164:167]
    ds_read_b64_tr_b16 a[120:121], v38 offset:8192
    ds_read_b64_tr_b16 a[122:123], v38 offset:12288
    v_mfma_f32_16x16x32_bf16 v[172:175], a[20:23], a[36:39], v[172:175]
    ds_read_b64_tr_b16 a[124:125], v39 offset:8192
    ds_read_b64_tr_b16 a[126:127], v39 offset:12288
    v_mfma_f32_16x16x32_bf16 v[168:171], a[20:23], a[32:35], v[168:171]
    buffer_load_dwordx4 a[76:79], v5, s[32:35], s45 offen sc1
    v_mfma_f32_16x16x32_bf16 v[176:179], a[24:27], a[32:35], v[176:179]
    v_mfma_f32_16x16x32_bf16 v[180:183], a[24:27], a[36:39], v[180:183]
    v_mfma_f32_16x16x32_bf16 v[188:191], a[28:31], a[36:39], v[188:191]
    v_mfma_f32_16x16x32_bf16 v[184:187], a[28:31], a[32:35], v[184:187]
    s_waitcnt vmcnt(8)
    s_barrier
    s_waitcnt lgkmcnt(0)
    v_mfma_f32_16x16x32_bf16 v[128:131], a[96:99], a[40:43], v[128:131]
    ds_read_b64_tr_b16 a[0:1], v32 offset:16384
    ds_read_b64_tr_b16 a[2:3], v32 offset:20480
    v_mfma_f32_16x16x32_bf16 v[132:135], a[96:99], a[44:47], v[132:135]
    ds_read_b64_tr_b16 a[4:5], v33 offset:16384
    ds_read_b64_tr_b16 a[6:7], v33 offset:20480
    v_mfma_f32_16x16x32_bf16 v[140:143], a[100:103], a[44:47], v[140:143]
    s_add_u32 s54, s66, s77
    s_lshr_b32 s54, s54, 1
    v_mfma_f32_16x16x32_bf16 v[136:139], a[100:103], a[40:43], v[136:139]
    ds_read_b64_tr_b16 a[8:9], v34 offset:16384
    ds_read_b64_tr_b16 a[10:11], v34 offset:20480
    v_mfma_f32_16x16x32_bf16 v[144:147], a[104:107], a[40:43], v[144:147]
    ds_read_b64_tr_b16 a[12:13], v35 offset:16384
    ds_read_b64_tr_b16 a[14:15], v35 offset:20480
    v_mfma_f32_16x16x32_bf16 v[148:151], a[104:107], a[44:47], v[148:151]
    s_add_u32 m0, s52, 98304
    s_add_u32 s44, s71, s58
    v_mfma_f32_16x16x32_bf16 v[156:159], a[108:111], a[44:47], v[156:159]
    ds_read_b64_tr_b16 a[16:17], v36 offset:16384
    ds_read_b64_tr_b16 a[18:19], v36 offset:20480
    v_mfma_f32_16x16x32_bf16 v[152:155], a[108:111], a[40:43], v[152:155]
    ds_read_b64_tr_b16 a[20:21], v37 offset:16384
    ds_read_b64_tr_b16 a[22:23], v37 offset:20480
    v_mfma_f32_16x16x32_bf16 v[160:163], a[112:115], a[40:43], v[160:163]
    buffer_load_dwordx4 v8, s[36:39], s54 offen offset:0 lds
    v_mfma_f32_16x16x32_bf16 v[164:167], a[112:115], a[44:47], v[164:167]
    ds_read_b64_tr_b16 a[24:25], v38 offset:16384
    ds_read_b64_tr_b16 a[26:27], v38 offset:20480
    v_mfma_f32_16x16x32_bf16 v[172:175], a[116:119], a[44:47], v[172:175]
    ds_read_b64_tr_b16 a[28:29], v39 offset:16384
    ds_read_b64_tr_b16 a[30:31], v39 offset:20480
    v_mfma_f32_16x16x32_bf16 v[168:171], a[116:119], a[40:43], v[168:171]
    s_add_u32 s45, s71, s59
    v_mfma_f32_16x16x32_bf16 v[176:179], a[120:123], a[40:43], v[176:179]
    buffer_load_dwordx4 a[80:83], v4, s[32:35], s44 offen sc1
    v_mfma_f32_16x16x32_bf16 v[180:183], a[120:123], a[44:47], v[180:183]
    buffer_load_dwordx4 v9, s[36:39], s54 offen offset:1024 lds
    v_mfma_f32_16x16x32_bf16 v[188:191], a[124:127], a[44:47], v[188:191]
    buffer_load_dwordx4 a[84:87], v5, s[32:35], s44 offen sc1
    v_mfma_f32_16x16x32_bf16 v[184:187], a[124:127], a[40:43], v[184:187]
    s_waitcnt lgkmcnt(0)
    v_mfma_f32_16x16x32_bf16 v[128:131], a[0:3], a[48:51], v[128:131]
    ds_read_b64_tr_b16 a[96:97], v32 offset:24576
    ds_read_b64_tr_b16 a[98:99], v32 offset:28672
    v_mfma_f32_16x16x32_bf16 v[132:135], a[0:3], a[52:55], v[132:135]
    ds_read_b64_tr_b16 a[100:101], v33 offset:24576
    ds_read_b64_tr_b16 a[102:103], v33 offset:28672
    v_mfma_f32_16x16x32_bf16 v[140:143], a[4:7], a[52:55], v[140:143]
    buffer_load_dwordx4 v10, s[36:39], s54 offen offset:2048 lds
    v_mfma_f32_16x16x32_bf16 v[136:139], a[4:7], a[48:51], v[136:139]
    ds_read_b64_tr_b16 a[104:105], v34 offset:24576
    ds_read_b64_tr_b16 a[106:107], v34 offset:28672
    v_mfma_f32_16x16x32_bf16 v[144:147], a[8:11], a[48:51], v[144:147]
    ds_read_b64_tr_b16 a[108:109], v35 offset:24576
    ds_read_b64_tr_b16 a[110:111], v35 offset:28672
    v_mfma_f32_16x16x32_bf16 v[148:151], a[8:11], a[52:55], v[148:151]
    buffer_load_dwordx4 a[88:91], v4, s[32:35], s45 offen sc1
    v_mfma_f32_16x16x32_bf16 v[156:159], a[12:15], a[52:55], v[156:159]
    ds_read_b64_tr_b16 a[112:113], v36 offset:24576
    ds_read_b64_tr_b16 a[114:115], v36 offset:28672
    v_mfma_f32_16x16x32_bf16 v[152:155], a[12:15], a[48:51], v[152:155]
    ds_read_b64_tr_b16 a[116:117], v37 offset:24576
    ds_read_b64_tr_b16 a[118:119], v37 offset:28672
    v_mfma_f32_16x16x32_bf16 v[160:163], a[16:19], a[48:51], v[160:163]
    buffer_load_dwordx4 v11, s[36:39], s54 offen offset:3072 lds
    v_mfma_f32_16x16x32_bf16 v[164:167], a[16:19], a[52:55], v[164:167]
    ds_read_b64_tr_b16 a[120:121], v38 offset:24576
    ds_read_b64_tr_b16 a[122:123], v38 offset:28672
    v_mfma_f32_16x16x32_bf16 v[172:175], a[20:23], a[52:55], v[172:175]
    ds_read_b64_tr_b16 a[124:125], v39 offset:24576
    ds_read_b64_tr_b16 a[126:127], v39 offset:28672
    v_mfma_f32_16x16x32_bf16 v[168:171], a[20:23], a[48:51], v[168:171]
    buffer_load_dwordx4 a[92:95], v5, s[32:35], s45 offen sc1
    v_mfma_f32_16x16x32_bf16 v[176:179], a[24:27], a[48:51], v[176:179]
    s_mov_b32 s58, s46
    s_mov_b32 s59, s47
    s_mov_b32 s46, s48
    s_mov_b32 s47, s49
    s_sub_u32 s57, s57, 1
    s_cmp_lg_u32 s57, 0
    v_mfma_f32_16x16x32_bf16 v[180:183], a[24:27], a[52:55], v[180:183]
    v_mfma_f32_16x16x32_bf16 v[188:191], a[28:31], a[52:55], v[188:191]
    v_mfma_f32_16x16x32_bf16 v[184:187], a[28:31], a[48:51], v[184:187]
    s_cbranch_scc1 f2loop_adaLN_cond__linear_kernel_hedgehog__glu_gated_swiglu__prompt_kernel_48
    s_waitcnt vmcnt(8)
    s_waitcnt lgkmcnt(0)
    v_mfma_f32_16x16x32_bf16 v[128:131], a[96:99], a[56:59], v[128:131]
    ds_read_b64_tr_b16 a[0:1], v32 offset:32768
    ds_read_b64_tr_b16 a[2:3], v32 offset:36864
    v_mfma_f32_16x16x32_bf16 v[132:135], a[96:99], a[60:63], v[132:135]
    ds_read_b64_tr_b16 a[4:5], v33 offset:32768
    ds_read_b64_tr_b16 a[6:7], v33 offset:36864
    v_mfma_f32_16x16x32_bf16 v[140:143], a[100:103], a[60:63], v[140:143]
    v_mfma_f32_16x16x32_bf16 v[136:139], a[100:103], a[56:59], v[136:139]
    ds_read_b64_tr_b16 a[8:9], v34 offset:32768
    ds_read_b64_tr_b16 a[10:11], v34 offset:36864
    v_mfma_f32_16x16x32_bf16 v[144:147], a[104:107], a[56:59], v[144:147]
    ds_read_b64_tr_b16 a[12:13], v35 offset:32768
    ds_read_b64_tr_b16 a[14:15], v35 offset:36864
    v_mfma_f32_16x16x32_bf16 v[148:151], a[104:107], a[60:63], v[148:151]
    v_mfma_f32_16x16x32_bf16 v[156:159], a[108:111], a[60:63], v[156:159]
    ds_read_b64_tr_b16 a[16:17], v36 offset:32768
    ds_read_b64_tr_b16 a[18:19], v36 offset:36864
    v_mfma_f32_16x16x32_bf16 v[152:155], a[108:111], a[56:59], v[152:155]
    ds_read_b64_tr_b16 a[20:21], v37 offset:32768
    ds_read_b64_tr_b16 a[22:23], v37 offset:36864
    v_mfma_f32_16x16x32_bf16 v[160:163], a[112:115], a[56:59], v[160:163]
    v_mfma_f32_16x16x32_bf16 v[164:167], a[112:115], a[60:63], v[164:167]
    ds_read_b64_tr_b16 a[24:25], v38 offset:32768
    ds_read_b64_tr_b16 a[26:27], v38 offset:36864
    v_mfma_f32_16x16x32_bf16 v[172:175], a[116:119], a[60:63], v[172:175]
    ds_read_b64_tr_b16 a[28:29], v39 offset:32768
    ds_read_b64_tr_b16 a[30:31], v39 offset:36864
    v_mfma_f32_16x16x32_bf16 v[168:171], a[116:119], a[56:59], v[168:171]
    v_mfma_f32_16x16x32_bf16 v[176:179], a[120:123], a[56:59], v[176:179]
    v_mfma_f32_16x16x32_bf16 v[180:183], a[120:123], a[60:63], v[180:183]
    v_mfma_f32_16x16x32_bf16 v[188:191], a[124:127], a[60:63], v[188:191]
    v_mfma_f32_16x16x32_bf16 v[184:187], a[124:127], a[56:59], v[184:187]
    s_waitcnt lgkmcnt(0)
    v_mfma_f32_16x16x32_bf16 v[128:131], a[0:3], a[64:67], v[128:131]
    ds_read_b64_tr_b16 a[96:97], v32 offset:40960
    ds_read_b64_tr_b16 a[98:99], v32 offset:45056
    v_mfma_f32_16x16x32_bf16 v[132:135], a[0:3], a[68:71], v[132:135]
    ds_read_b64_tr_b16 a[100:101], v33 offset:40960
    ds_read_b64_tr_b16 a[102:103], v33 offset:45056
    v_mfma_f32_16x16x32_bf16 v[140:143], a[4:7], a[68:71], v[140:143]
    v_mfma_f32_16x16x32_bf16 v[136:139], a[4:7], a[64:67], v[136:139]
    ds_read_b64_tr_b16 a[104:105], v34 offset:40960
    ds_read_b64_tr_b16 a[106:107], v34 offset:45056
    v_mfma_f32_16x16x32_bf16 v[144:147], a[8:11], a[64:67], v[144:147]
    ds_read_b64_tr_b16 a[108:109], v35 offset:40960
    ds_read_b64_tr_b16 a[110:111], v35 offset:45056
    v_mfma_f32_16x16x32_bf16 v[148:151], a[8:11], a[68:71], v[148:151]
    v_mfma_f32_16x16x32_bf16 v[156:159], a[12:15], a[68:71], v[156:159]
    ds_read_b64_tr_b16 a[112:113], v36 offset:40960
    ds_read_b64_tr_b16 a[114:115], v36 offset:45056
    v_mfma_f32_16x16x32_bf16 v[152:155], a[12:15], a[64:67], v[152:155]
    ds_read_b64_tr_b16 a[116:117], v37 offset:40960
    ds_read_b64_tr_b16 a[118:119], v37 offset:45056
    v_mfma_f32_16x16x32_bf16 v[160:163], a[16:19], a[64:67], v[160:163]
    v_mfma_f32_16x16x32_bf16 v[164:167], a[16:19], a[68:71], v[164:167]
    ds_read_b64_tr_b16 a[120:121], v38 offset:40960
    ds_read_b64_tr_b16 a[122:123], v38 offset:45056
    v_mfma_f32_16x16x32_bf16 v[172:175], a[20:23], a[68:71], v[172:175]
    ds_read_b64_tr_b16 a[124:125], v39 offset:40960
    ds_read_b64_tr_b16 a[126:127], v39 offset:45056
    v_mfma_f32_16x16x32_bf16 v[168:171], a[20:23], a[64:67], v[168:171]
    v_mfma_f32_16x16x32_bf16 v[176:179], a[24:27], a[64:67], v[176:179]
    v_mfma_f32_16x16x32_bf16 v[180:183], a[24:27], a[68:71], v[180:183]
    v_mfma_f32_16x16x32_bf16 v[188:191], a[28:31], a[68:71], v[188:191]
    v_mfma_f32_16x16x32_bf16 v[184:187], a[28:31], a[64:67], v[184:187]
    s_waitcnt vmcnt(0)
    s_barrier
    s_waitcnt lgkmcnt(0)
    v_mfma_f32_16x16x32_bf16 v[128:131], a[96:99], a[72:75], v[128:131]
    ds_read_b64_tr_b16 a[0:1], v32 offset:49152
    ds_read_b64_tr_b16 a[2:3], v32 offset:53248
    v_mfma_f32_16x16x32_bf16 v[132:135], a[96:99], a[76:79], v[132:135]
    ds_read_b64_tr_b16 a[4:5], v33 offset:49152
    ds_read_b64_tr_b16 a[6:7], v33 offset:53248
    v_mfma_f32_16x16x32_bf16 v[140:143], a[100:103], a[76:79], v[140:143]
    v_mfma_f32_16x16x32_bf16 v[136:139], a[100:103], a[72:75], v[136:139]
    ds_read_b64_tr_b16 a[8:9], v34 offset:49152
    ds_read_b64_tr_b16 a[10:11], v34 offset:53248
    v_mfma_f32_16x16x32_bf16 v[144:147], a[104:107], a[72:75], v[144:147]
    ds_read_b64_tr_b16 a[12:13], v35 offset:49152
    ds_read_b64_tr_b16 a[14:15], v35 offset:53248
    v_mfma_f32_16x16x32_bf16 v[148:151], a[104:107], a[76:79], v[148:151]
    v_mfma_f32_16x16x32_bf16 v[156:159], a[108:111], a[76:79], v[156:159]
    ds_read_b64_tr_b16 a[16:17], v36 offset:49152
    ds_read_b64_tr_b16 a[18:19], v36 offset:53248
    v_mfma_f32_16x16x32_bf16 v[152:155], a[108:111], a[72:75], v[152:155]
    ds_read_b64_tr_b16 a[20:21], v37 offset:49152
    ds_read_b64_tr_b16 a[22:23], v37 offset:53248
    v_mfma_f32_16x16x32_bf16 v[160:163], a[112:115], a[72:75], v[160:163]
    v_mfma_f32_16x16x32_bf16 v[164:167], a[112:115], a[76:79], v[164:167]
    ds_read_b64_tr_b16 a[24:25], v38 offset:49152
    ds_read_b64_tr_b16 a[26:27], v38 offset:53248
    v_mfma_f32_16x16x32_bf16 v[172:175], a[116:119], a[76:79], v[172:175]
    ds_read_b64_tr_b16 a[28:29], v39 offset:49152
    ds_read_b64_tr_b16 a[30:31], v39 offset:53248
    v_mfma_f32_16x16x32_bf16 v[168:171], a[116:119], a[72:75], v[168:171]
    v_mfma_f32_16x16x32_bf16 v[176:179], a[120:123], a[72:75], v[176:179]
    v_mfma_f32_16x16x32_bf16 v[180:183], a[120:123], a[76:79], v[180:183]
    v_mfma_f32_16x16x32_bf16 v[188:191], a[124:127], a[76:79], v[188:191]
    v_mfma_f32_16x16x32_bf16 v[184:187], a[124:127], a[72:75], v[184:187]
    s_waitcnt lgkmcnt(0)
    v_mfma_f32_16x16x32_bf16 v[128:131], a[0:3], a[80:83], v[128:131]
    ds_read_b64_tr_b16 a[96:97], v32 offset:57344
    ds_read_b64_tr_b16 a[98:99], v32 offset:61440
    v_mfma_f32_16x16x32_bf16 v[132:135], a[0:3], a[84:87], v[132:135]
    ds_read_b64_tr_b16 a[100:101], v33 offset:57344
    ds_read_b64_tr_b16 a[102:103], v33 offset:61440
    v_mfma_f32_16x16x32_bf16 v[140:143], a[4:7], a[84:87], v[140:143]
    v_mfma_f32_16x16x32_bf16 v[136:139], a[4:7], a[80:83], v[136:139]
    ds_read_b64_tr_b16 a[104:105], v34 offset:57344
    ds_read_b64_tr_b16 a[106:107], v34 offset:61440
    v_mfma_f32_16x16x32_bf16 v[144:147], a[8:11], a[80:83], v[144:147]
    ds_read_b64_tr_b16 a[108:109], v35 offset:57344
    ds_read_b64_tr_b16 a[110:111], v35 offset:61440
    v_mfma_f32_16x16x32_bf16 v[148:151], a[8:11], a[84:87], v[148:151]
    v_mfma_f32_16x16x32_bf16 v[156:159], a[12:15], a[84:87], v[156:159]
    ds_read_b64_tr_b16 a[112:113], v36 offset:57344
    ds_read_b64_tr_b16 a[114:115], v36 offset:61440
    v_mfma_f32_16x16x32_bf16 v[152:155], a[12:15], a[80:83], v[152:155]
    ds_read_b64_tr_b16 a[116:117], v37 offset:57344
    ds_read_b64_tr_b16 a[118:119], v37 offset:61440
    v_mfma_f32_16x16x32_bf16 v[160:163], a[16:19], a[80:83], v[160:163]
    v_mfma_f32_16x16x32_bf16 v[164:167], a[16:19], a[84:87], v[164:167]
    ds_read_b64_tr_b16 a[120:121], v38 offset:57344
    ds_read_b64_tr_b16 a[122:123], v38 offset:61440
    v_mfma_f32_16x16x32_bf16 v[172:175], a[20:23], a[84:87], v[172:175]
    ds_read_b64_tr_b16 a[124:125], v39 offset:57344
    ds_read_b64_tr_b16 a[126:127], v39 offset:61440
    v_mfma_f32_16x16x32_bf16 v[168:171], a[20:23], a[80:83], v[168:171]
    v_mfma_f32_16x16x32_bf16 v[176:179], a[24:27], a[80:83], v[176:179]
    v_mfma_f32_16x16x32_bf16 v[180:183], a[24:27], a[84:87], v[180:183]
    v_mfma_f32_16x16x32_bf16 v[188:191], a[28:31], a[84:87], v[188:191]
    v_mfma_f32_16x16x32_bf16 v[184:187], a[28:31], a[80:83], v[184:187]
    s_waitcnt lgkmcnt(0)
    v_mfma_f32_16x16x32_bf16 v[128:131], a[96:99], a[88:91], v[128:131]
    v_mfma_f32_16x16x32_bf16 v[132:135], a[96:99], a[92:95], v[132:135]
    v_mfma_f32_16x16x32_bf16 v[140:143], a[100:103], a[92:95], v[140:143]
    v_mfma_f32_16x16x32_bf16 v[136:139], a[100:103], a[88:91], v[136:139]
    v_mfma_f32_16x16x32_bf16 v[144:147], a[104:107], a[88:91], v[144:147]
    v_mfma_f32_16x16x32_bf16 v[148:151], a[104:107], a[92:95], v[148:151]
    v_mfma_f32_16x16x32_bf16 v[156:159], a[108:111], a[92:95], v[156:159]
    v_mfma_f32_16x16x32_bf16 v[152:155], a[108:111], a[88:91], v[152:155]
    v_mfma_f32_16x16x32_bf16 v[160:163], a[112:115], a[88:91], v[160:163]
    v_mfma_f32_16x16x32_bf16 v[164:167], a[112:115], a[92:95], v[164:167]
    v_mfma_f32_16x16x32_bf16 v[172:175], a[116:119], a[92:95], v[172:175]
    v_mfma_f32_16x16x32_bf16 v[168:171], a[116:119], a[88:91], v[168:171]
    v_mfma_f32_16x16x32_bf16 v[176:179], a[120:123], a[88:91], v[176:179]
    v_mfma_f32_16x16x32_bf16 v[180:183], a[120:123], a[92:95], v[180:183]
    v_mfma_f32_16x16x32_bf16 v[188:191], a[124:127], a[92:95], v[188:191]
    v_mfma_f32_16x16x32_bf16 v[184:187], a[124:127], a[88:91], v[184:187]
    v_cvt_pk_bf16_f32 v224, v132, v133
    v_cvt_pk_bf16_f32 v225, v134, v135
    v_cvt_pk_bf16_f32 v226, v140, v141
    v_cvt_pk_bf16_f32 v227, v142, v143
    buffer_store_dwordx4 v[224:227], v2, s[24:27], s13 offen offset:0 sc1
    v_cvt_pk_bf16_f32 v228, v148, v149
    v_cvt_pk_bf16_f32 v229, v150, v151
    v_cvt_pk_bf16_f32 v230, v156, v157
    v_cvt_pk_bf16_f32 v231, v158, v159
    buffer_store_dwordx4 v[228:231], v2, s[24:27], s13 offen offset:1024 sc1
    v_cvt_pk_bf16_f32 v232, v164, v165
    v_cvt_pk_bf16_f32 v233, v166, v167
    v_cvt_pk_bf16_f32 v234, v172, v173
    v_cvt_pk_bf16_f32 v235, v174, v175
    buffer_store_dwordx4 v[232:235], v2, s[24:27], s13 offen offset:2048 sc1
    s_nop 3
    v_cvt_pk_bf16_f32 v236, v180, v181
    v_cvt_pk_bf16_f32 v237, v182, v183
    v_cvt_pk_bf16_f32 v238, v188, v189
    v_cvt_pk_bf16_f32 v239, v190, v191
    buffer_store_dwordx4 v[236:239], v2, s[24:27], s13 offen offset:3072 sc1
    s_mov_b32 s97, 0
xpoll_adaLN_cond__linear_kernel_hedgehog__glu_gated_swiglu__prompt_kernel_49:
    buffer_load_dwordx4 v[240:243], v2, s[24:27], s12 offen offset:0 sc1
    buffer_load_dwordx4 v[244:247], v2, s[24:27], s12 offen offset:1024 sc1
    buffer_load_dwordx4 v[248:251], v2, s[24:27], s12 offen offset:2048 sc1
    buffer_load_dwordx4 v[252:255], v2, s[24:27], s12 offen offset:3072 sc1
    s_waitcnt vmcnt(0)
    v_max3_u32 v48, v240, v241, v242
    v_max3_u32 v49, v243, v244, v245
    v_max3_u32 v48, v48, v246, v247
    v_max3_u32 v49, v49, v248, v249
    v_max3_u32 v48, v48, v250, v251
    v_max3_u32 v49, v49, v252, v253
    v_max3_u32 v48, v48, v254, v255
    v_max_u32 v48, v48, v49
    v_cmp_eq_u32 vcc, -1, v48
    s_cbranch_vccz xdone_adaLN_cond__linear_kernel_hedgehog__glu_gated_swiglu__prompt_kernel_50
    s_add_u32 s97, s97, 1
    s_cmp_lt_u32 s97, 20000
    s_cbranch_scc1 xpoll_adaLN_cond__linear_kernel_hedgehog__glu_gated_swiglu__prompt_kernel_49
xdone_adaLN_cond__linear_kernel_hedgehog__glu_gated_swiglu__prompt_kernel_50:
    s_mov_b32 s20, 0xffff0000
    s_mov_b32 s21, 0xffff0000
    v_lshlrev_b32 v132, 16, v240
    v_and_b32 v133, 0xffff0000, v240
    v_pk_add_f32 v[128:129], v[128:129], v[132:133]
    v_lshlrev_b32 v134, 16, v241
    v_and_b32 v135, 0xffff0000, v241
    v_pk_add_f32 v[130:131], v[130:131], v[134:135]
    v_lshlrev_b32 v140, 16, v242
    v_and_b32 v141, 0xffff0000, v242
    v_pk_add_f32 v[136:137], v[136:137], v[140:141]
    v_lshlrev_b32 v142, 16, v243
    v_and_b32 v143, 0xffff0000, v243
    v_pk_add_f32 v[138:139], v[138:139], v[142:143]
    s_mov_b64 exec, s[20:21]
    v_swap_b32 v128, v136
    v_swap_b32 v129, v137
    v_swap_b32 v130, v138
    v_swap_b32 v131, v139
    s_mov_b64 exec, -1
    v_pk_fma_f32 v[64:65], v[192:193], v[128:129], v[64:65]
    v_pk_fma_f32 v[66:67], v[194:195], v[130:131], v[66:67]
    v_pk_fma_f32 v[68:69], v[196:197], v[136:137], v[68:69]
    v_pk_fma_f32 v[70:71], v[198:199], v[138:139], v[70:71]
    v_cvt_pk_bf16_f32 v96, v64, v65
    v_cvt_pk_bf16_f32 v97, v66, v67
    v_cvt_pk_bf16_f32 v98, v68, v69
    v_cvt_pk_bf16_f32 v99, v70, v71
    buffer_store_dwordx4 v[96:99], v23, s[16:19], 0 offen offset:0 sc1
    v_lshlrev_b32 v148, 16, v244
    v_and_b32 v149, 0xffff0000, v244
    v_pk_add_f32 v[144:145], v[144:145], v[148:149]
    v_lshlrev_b32 v150, 16, v245
    v_and_b32 v151, 0xffff0000, v245
    v_pk_add_f32 v[146:147], v[146:147], v[150:151]
    v_lshlrev_b32 v156, 16, v246
    v_and_b32 v157, 0xffff0000, v246
    v_pk_add_f32 v[152:153], v[152:153], v[156:157]
    v_lshlrev_b32 v158, 16, v247
    v_and_b32 v159, 0xffff0000, v247
    v_pk_add_f32 v[154:155], v[154:155], v[158:159]
    s_mov_b64 exec, s[20:21]
    v_swap_b32 v144, v152
    v_swap_b32 v145, v153
    v_swap_b32 v146, v154
    v_swap_b32 v147, v155
    s_mov_b64 exec, -1
    v_pk_fma_f32 v[72:73], v[200:201], v[144:145], v[72:73]
    v_pk_fma_f32 v[74:75], v[202:203], v[146:147], v[74:75]
    v_pk_fma_f32 v[76:77], v[204:205], v[152:153], v[76:77]
    v_pk_fma_f32 v[78:79], v[206:207], v[154:155], v[78:79]
    v_cvt_pk_bf16_f32 v100, v72, v73
    v_cvt_pk_bf16_f32 v101, v74, v75
    v_cvt_pk_bf16_f32 v102, v76, v77
    v_cvt_pk_bf16_f32 v103, v78, v79
    buffer_store_dwordx4 v[100:103], v23, s[16:19], 0 offen offset:64 sc1
    v_lshlrev_b32 v164, 16, v248
    v_and_b32 v165, 0xffff0000, v248
    v_pk_add_f32 v[160:161], v[160:161], v[164:165]
    v_lshlrev_b32 v166, 16, v249
    v_and_b32 v167, 0xffff0000, v249
    v_pk_add_f32 v[162:163], v[162:163], v[166:167]
    v_lshlrev_b32 v172, 16, v250
    v_and_b32 v173, 0xffff0000, v250
    v_pk_add_f32 v[168:169], v[168:169], v[172:173]
    v_lshlrev_b32 v174, 16, v251
    v_and_b32 v175, 0xffff0000, v251
    v_pk_add_f32 v[170:171], v[170:171], v[174:175]
    s_mov_b64 exec, s[20:21]
    v_swap_b32 v160, v168
    v_swap_b32 v161, v169
    v_swap_b32 v162, v170
    v_swap_b32 v163, v171
    s_mov_b64 exec, -1
    v_pk_fma_f32 v[80:81], v[208:209], v[160:161], v[80:81]
    v_pk_fma_f32 v[82:83], v[210:211], v[162:163], v[82:83]
    v_pk_fma_f32 v[84:85], v[212:213], v[168:169], v[84:85]
    v_pk_fma_f32 v[86:87], v[214:215], v[170:171], v[86:87]
    v_cvt_pk_bf16_f32 v104, v80, v81
    v_cvt_pk_bf16_f32 v105, v82, v83
    v_cvt_pk_bf16_f32 v106, v84, v85
    v_cvt_pk_bf16_f32 v107, v86, v87
    buffer_store_dwordx4 v[104:107], v23, s[16:19], 0 offen offset:128 sc1
    v_lshlrev_b32 v180, 16, v252
    v_and_b32 v181, 0xffff0000, v252
    v_pk_add_f32 v[176:177], v[176:177], v[180:181]
    v_lshlrev_b32 v182, 16, v253
    v_and_b32 v183, 0xffff0000, v253
    v_pk_add_f32 v[178:179], v[178:179], v[182:183]
    v_lshlrev_b32 v188, 16, v254
    v_and_b32 v189, 0xffff0000, v254
    v_pk_add_f32 v[184:185], v[184:185], v[188:189]
    v_lshlrev_b32 v190, 16, v255
    v_and_b32 v191, 0xffff0000, v255
    v_pk_add_f32 v[186:187], v[186:187], v[190:191]
    s_mov_b64 exec, s[20:21]
    v_swap_b32 v176, v184
    v_swap_b32 v177, v185
    v_swap_b32 v178, v186
    v_swap_b32 v179, v187
    s_mov_b64 exec, -1
    v_pk_fma_f32 v[88:89], v[216:217], v[176:177], v[88:89]
    v_pk_fma_f32 v[90:91], v[218:219], v[178:179], v[90:91]
    v_pk_fma_f32 v[92:93], v[220:221], v[184:185], v[92:93]
    v_pk_fma_f32 v[94:95], v[222:223], v[186:187], v[94:95]
    v_cvt_pk_bf16_f32 v108, v88, v89
    v_cvt_pk_bf16_f32 v109, v90, v91
    v_cvt_pk_bf16_f32 v110, v92, v93
    v_cvt_pk_bf16_f32 v111, v94, v95
    buffer_store_dwordx4 v[108:111], v23, s[16:19], 0 offen offset:192 sc1
end_adaLN_cond__linear_kernel_hedgehog__glu_gated_swiglu__prompt_kernel_1:
    s_endpgm
.section .rodata,"a"
.p2align 6
.amdhsa_kernel adaLN_cond__linear_kernel_hedgehog__glu_gated_swiglu__prompt_kernel
  .amdhsa_next_free_vgpr 512
  .amdhsa_next_free_sgpr 102
  .amdhsa_accum_offset 256
  .amdhsa_group_segment_fixed_size 0
  .amdhsa_kernarg_size 104
  .amdhsa_user_sgpr_count 2
  .amdhsa_user_sgpr_kernarg_segment_ptr 1
  .amdhsa_system_sgpr_workgroup_id_x 1
.end_amdhsa_kernel
```
